```python
import torch

def _softmax(x, axis=-1):
    return torch.softmax(x, dim=axis)

def _gelu(x):
    return torch.nn.functional.gelu(x, approximate='tanh')

def _silu(x):
    return torch.nn.functional.silu(x)

def _sigmoid(x):
    return torch.sigmoid(x)

def _layernorm(x, axis=-1, eps=1e-05):
    m = x.mean(dim=axis, keepdim=True)
    v = x.var(dim=axis, keepdim=True, unbiased=False)
    return (x - m) / torch.sqrt(v + eps)

def _scatter_add(tgt, idx, src, axis=0):
    return tgt.clone().index_add_(axis, idx, src)

def _segment_sum(src, seg, n):
    out = torch.zeros((n,) + src.shape[1:], dtype=src.dtype)
    return out.index_add_(0, seg, src)

def _pad(x, pw):
    flat = tuple((v for pair in reversed(pw) for v in pair))
    return torch.nn.functional.pad(x, flat)
kernel_name = 'sequential_preLN__memory_aug_recurrent_mem_tr__glu_gated_swiglu__prompt'

def setup_inputs():

    _w = lambda a: (lambda t: t.to(torch.bfloat16) if t.is_floating_point() else t)(torch.as_tensor(a))

    def _A_setup():
        B, S, Dm = (1, 2048, 512)
        H, Dh = (32, 128)
        M, seg = (8, 32)
        seg = min(seg, S)
        S = S // seg * seg
        return {'x': _w((lambda *s: torch.randn(*s, dtype=torch.bfloat16) * 0.05)(B, S, Dm)), 'mem0': _w((lambda *s: torch.randn(*s, dtype=torch.bfloat16) * 0.2)(B, M, Dm)), 'Wq': _w((lambda *s: torch.randn(*s, dtype=torch.bfloat16) * 1.6)(Dm, H, Dh) * Dm ** (-0.5)), 'Wk': _w((lambda *s: torch.randn(*s, dtype=torch.bfloat16) * 1.6)(Dm, H, Dh) * Dm ** (-0.5)), 'Wv': _w((lambda *s: torch.randn(*s, dtype=torch.bfloat16) * 0.2)(Dm, H, Dh) * Dm ** (-0.5)), 'Wo': _w((lambda *s: torch.randn(*s, dtype=torch.bfloat16) * 0.2)(H, Dh, Dm) * (H * Dh) ** (-0.5)), 'seg_len': seg}
    _A_in = _A_setup()

    def _B_setup():
        B, S, D, F = (1, 2048, 512, 1792)
        return {'x': _w((lambda *s: torch.randn(*s, dtype=torch.bfloat16) * 0.05)(B, S, D)), 'w1': _w((lambda *s: torch.randn(*s, dtype=torch.bfloat16) * 0.2)(D, F) * (2.0 / D) ** 0.5), 'w3': _w((lambda *s: torch.randn(*s, dtype=torch.bfloat16) * 0.2)(D, F) * (2.0 / D) ** 0.5), 'w2': _w((lambda *s: torch.randn(*s, dtype=torch.bfloat16) * 0.2)(F, D) * (2.0 / F) ** 0.5)}
    _B_in = _B_setup()
    return {'A_x': _A_in['x'], 'A_mem0': _A_in['mem0'], 'A_Wq': _A_in['Wq'], 'A_Wk': _A_in['Wk'], 'A_Wv': _A_in['Wv'], 'A_Wo': _A_in['Wo'], 'A_seg_len': _A_in['seg_len'], 'B_x': _B_in['x'], 'B_w1': _B_in['w1'], 'B_w3': _B_in['w3'], 'B_w2': _B_in['w2']}

def reference(A_x, A_mem0, A_Wq, A_Wk, A_Wv, A_Wo, A_seg_len, B_x, B_w1, B_w3, B_w2):

    def _A_ref(x, mem0, Wq, Wk, Wv, Wo, seg_len):
        B, S, Dm = x.shape
        H, Dh = (Wq.shape[1], Wq.shape[2])
        M = mem0.shape[1]
        scale = Dh ** (-0.5)
        n_seg = S // seg_len
        L = M + seg_len
        idx = torch.arange(L)
        mask = (idx[:, None] < M) | (idx[:, None] >= idx[None, :])
        mem = mem0
        outs = []
        for s in range(n_seg):
            xs = x[:, s * seg_len:(s + 1) * seg_len, :].clone()
            h = torch.concatenate([mem, xs], axis=1)
            q = torch.einsum('btd,dhe->bhte', h, Wq)
            k = torch.einsum('btd,dhe->bhte', h, Wk)
            v = torch.einsum('btd,dhe->bhte', h, Wv)
            scores = torch.einsum('bhqe,bhke->bhqk', q, k) * scale
            scores = torch.where(mask[None, None], scores, -1000000000.0)
            p = _softmax(scores, axis=-1)
            o = torch.einsum('bhqk,bhke->bhqe', p, v)
            o = torch.einsum('bhte,hed->btd', o, Wo)
            mem = o[:, :M, :].clone()
            outs.append(o[:, M:, :])
        return torch.concatenate(outs, axis=1)

    def _B_ref(x, w1, w3, w2):
        gate = torch.einsum('bsd,df->bsf', x, w1)
        up = torch.einsum('bsd,df->bsf', x, w3)
        h = _silu(gate) * up
        out = torch.einsum('bsf,fd->bsd', h, w2)
        return out
    x = A_x
    h = x + _A_ref(_layernorm(x, axis=-1), A_mem0, A_Wq, A_Wk, A_Wv, A_Wo, A_seg_len)
    h2 = h + _B_ref(_layernorm(h, axis=-1), B_w1, B_w3, B_w2)
    return h2
```

```asm
; @launch grid=(256,1,1) block=(256,1,1) lds=163840
.amdgcn_target "amdgcn-amd-amdhsa--gfx950"
.text
.globl sequential_preLN__memory_aug_recurrent_mem_tr__glu_gated_swiglu__prompt_kernel
.p2align 8
.type sequential_preLN__memory_aug_recurrent_mem_tr__glu_gated_swiglu__prompt_kernel,@function
sequential_preLN__memory_aug_recurrent_mem_tr__glu_gated_swiglu__prompt_kernel:
  s_cmp_ge_u32 s2, 256
  s_cbranch_scc1 L_bail
  s_load_dwordx2 s[4:5], s[0:1], 104
  s_load_dwordx2 s[92:93], s[0:1], 96
  s_load_dwordx2 s[8:9], s[0:1], 0
  s_load_dwordx2 s[96:97], s[0:1], 8
  s_load_dwordx2 s[44:45], s[0:1], 16
  s_load_dwordx2 s[48:49], s[0:1], 24
  s_load_dwordx2 s[52:53], s[0:1], 32
  s_load_dwordx2 s[56:57], s[0:1], 40
  s_load_dwordx2 s[60:61], s[0:1], 64
  s_load_dwordx2 s[64:65], s[0:1], 72
  s_load_dwordx2 s[68:69], s[0:1], 80
  s_load_dwordx2 s[72:73], s[0:1], 88
  s_getreg_b32 s3, hwreg(HW_REG_XCC_ID)
  s_and_b32 s3, s3, 15
  s_and_b32 s18, s3, 7
  s_lshl_b32 s18, s18, 5
  s_and_b32 s19, s3, 8
  s_lshl_b32 s19, s19, 1
  s_add_u32 s18, s18, s19
  v_mov_b32 v2, 1
  v_mov_b32 v3, 0
  s_mov_b32 s24, 0
  s_waitcnt lgkmcnt(0)
  s_mov_b32 s94, 256
  s_mov_b32 s95, 0x20000
  s_mov_b32 s6, 268435456
  s_mov_b32 s7, 0x20000
  s_mov_b32 s10, 0x200000
  s_mov_b32 s11, 0x20000
  s_mov_b32 s46, 4194304
  s_mov_b32 s47, 0x20000
  s_mov_b32 s50, 4194304
  s_mov_b32 s51, 0x20000
  s_mov_b32 s54, 4194304
  s_mov_b32 s55, 0x20000
  s_mov_b32 s58, 4194304
  s_mov_b32 s59, 0x20000
  s_mov_b32 s62, 1835008
  s_mov_b32 s63, 0x20000
  s_mov_b32 s66, 1835008
  s_mov_b32 s67, 0x20000
  s_mov_b32 s70, 1835008
  s_mov_b32 s71, 0x20000
  s_mov_b32 s74, 2097152
  s_mov_b32 s75, 0x20000
  v_cmp_gt_u32 vcc, 64, v0
  s_cbranch_vccz L_r1
  s_mov_b64 exec, 1
  buffer_atomic_add v2, off, s[92:95], s18 sc0
  s_mov_b64 exec, -1
  s_waitcnt vmcnt(0)
  v_readfirstlane_b32 s12, v2
  s_mov_b32 s14, s3
  s_cmp_lt_u32 s3, 8
  s_cbranch_scc0 L_over
  s_cmp_lt_u32 s12, 32
  s_cbranch_scc0 L_over
L_role:
  s_lshl_b32 s18, s14, 5
  s_add_u32 s18, s18, s12
  v_mov_b32 v2, s18
  ds_write_b32 v3, v2
  s_waitcnt lgkmcnt(0)
L_r1:
  s_barrier
  ds_read_b32 v2, v3
  s_waitcnt lgkmcnt(0)
  v_readfirstlane_b32 s18, v2
  s_nop 0
  s_and_b32 s12, s18, 31
  s_lshr_b32 s14, s18, 5
  s_barrier
  s_cmp_gt_u32 s14, 7
  s_cbranch_scc1 L_bail
  s_cmp_eq_u32 s14, 0
  s_cbranch_scc1 L_chain
  v_lshrrev_b32 v1, 6, v0
  v_and_b32 v0, 63, v0
  v_readfirstlane_b32 s13, v1
  v_lshlrev_b32 v0, 4, v0
  s_mov_b32 s22, 1040356334
  s_mov_b32 s40, 0x05040100
  s_mov_b32 s41, 0x07060302
  s_mov_b32 s24, 0
  s_cmp_eq_u32 s14, 1
  s_cselect_b32 s15, 10, 9
  s_add_u32 s18, s13, 0
  s_mul_i32 s19, s18, 7
  s_add_u32 s19, s19, s14
  s_sub_u32 s19, s19, 1
  s_lshl_b32 s19, s19, 5
  s_add_u32 s19, s19, s12
  s_lshl_b32 s19, s19, 10
  s_cmp_lt_u32 s18, s15
  s_cselect_b32 s26, s19, 0x20000000
  buffer_load_dwordx4 v[4:7], v0, s[8:11], s26 offen
  s_add_u32 s18, s13, 4
  s_mul_i32 s19, s18, 7
  s_add_u32 s19, s19, s14
  s_sub_u32 s19, s19, 1
  s_lshl_b32 s19, s19, 5
  s_add_u32 s19, s19, s12
  s_lshl_b32 s19, s19, 10
  s_cmp_lt_u32 s18, s15
  s_cselect_b32 s27, s19, 0x20000000
  buffer_load_dwordx4 v[8:11], v0, s[8:11], s27 offen
  s_add_u32 s18, s13, 8
  s_mul_i32 s19, s18, 7
  s_add_u32 s19, s19, s14
  s_sub_u32 s19, s19, 1
  s_lshl_b32 s19, s19, 5
  s_add_u32 s19, s19, s12
  s_lshl_b32 s19, s19, 10
  s_cmp_lt_u32 s18, s15
  s_cselect_b32 s28, s19, 0x20000000
  buffer_load_dwordx4 v[12:15], v0, s[8:11], s28 offen
  v_lshrrev_b32 v32, 4, v0
  s_mul_i32 s35, s13, 24576
  s_add_u32 s35, s35, 65536
  v_and_b32 v30, 32, v32
  v_lshlrev_b32 v30, 11, v30
  v_and_b32 v31, 16, v32
  v_lshlrev_b32 v31, 10, v31
  v_add_u32 v30, v30, v31
  v_and_b32 v31, 8, v32
  v_lshlrev_b32 v31, 10, v31
  v_add_u32 v30, v30, v31
  v_lshrrev_b32 v31, 3, v32
  v_and_b32 v31, 6, v31
  v_xor_b32 v31, v31, v32
  v_and_b32 v31, 7, v31
  v_lshlrev_b32 v31, 4, v31
  v_add_u32 v30, v30, v31
  s_lshl_b32 s18, s12, 8
  s_and_b32 s19, s13, 2
  s_lshl_b32 s19, s19, 6
  s_add_u32 s18, s18, s19
  v_add_u32 v28, s18, v30
  s_and_b32 s19, s13, 1
  s_lshl_b32 s18, s19, 17
  v_add_u32 v28, s18, v28
  s_mul_i32 s19, s19, 24576
  v_lshrrev_b32 v31, 5, v32
  v_mul_u32_u24 v31, 24576, v31
  v_subrev_u32 v31, s19, v31
  v_bfe_u32 v30, v32, 2, 3
  v_lshlrev_b32 v30, 7, v30
  v_add_u32 v30, v30, v31
  v_bfe_u32 v31, v32, 3, 2
  s_and_b32 s19, s13, 1
  s_lshl_b32 s19, s19, 1
  v_xor_b32 v31, s19, v31
  v_lshlrev_b32 v31, 5, v31
  v_add_u32 v30, v30, v31
  v_and_b32 v31, 3, v32
  v_lshlrev_b32 v31, 3, v31
  v_add_u32 v30, v30, v31
  v_add_u32 v29, s35, v30
  v_xor_b32 v33, 32, v29
  s_barrier
  s_mov_b32 s18, 0
  s_add_u32 m0, s35, 0
  s_nop 0
  buffer_load_dwordx4 v28, s[48:51], s18 offen lds
  s_mov_b32 s18, 32768
  s_add_u32 m0, s35, 1024
  s_nop 0
  buffer_load_dwordx4 v28, s[48:51], s18 offen lds
  s_mov_b32 s18, 262144
  s_add_u32 m0, s35, 2048
  s_nop 0
  buffer_load_dwordx4 v28, s[48:51], s18 offen lds
  s_mov_b32 s18, 294912
  s_add_u32 m0, s35, 3072
  s_nop 0
  buffer_load_dwordx4 v28, s[48:51], s18 offen lds
  s_mov_b32 s18, 524288
  s_add_u32 m0, s35, 4096
  s_nop 0
  buffer_load_dwordx4 v28, s[48:51], s18 offen lds
  s_mov_b32 s18, 557056
  s_add_u32 m0, s35, 5120
  s_nop 0
  buffer_load_dwordx4 v28, s[48:51], s18 offen lds
  s_mov_b32 s18, 786432
  s_add_u32 m0, s35, 6144
  s_nop 0
  buffer_load_dwordx4 v28, s[48:51], s18 offen lds
  s_mov_b32 s18, 819200
  s_add_u32 m0, s35, 7168
  s_nop 0
  buffer_load_dwordx4 v28, s[48:51], s18 offen lds
  s_waitcnt vmcnt(10)
  v_lshlrev_b32 v16, 16, v4
  v_and_b32 v17, 0xffff0000, v4
  v_lshlrev_b32 v18, 16, v5
  v_and_b32 v19, 0xffff0000, v5
  v_lshlrev_b32 v20, 16, v6
  v_and_b32 v21, 0xffff0000, v6
  v_lshlrev_b32 v22, 16, v7
  v_and_b32 v23, 0xffff0000, v7
  v_add_f32 v24, v16, v17
  v_add_f32 v24, v24, v18
  v_add_f32 v24, v24, v19
  v_add_f32 v24, v24, v20
  v_add_f32 v24, v24, v21
  v_add_f32 v24, v24, v22
  v_add_f32 v24, v24, v23
  s_nop 1
  v_add_f32_dpp v24, v24, v24 row_ror:8 row_mask:0xf bank_mask:0xf
  s_nop 1
  v_add_f32_dpp v24, v24, v24 row_ror:4 row_mask:0xf bank_mask:0xf
  s_nop 1
  v_add_f32_dpp v24, v24, v24 row_ror:2 row_mask:0xf bank_mask:0xf
  s_nop 1
  v_add_f32_dpp v24, v24, v24 row_ror:1 row_mask:0xf bank_mask:0xf
  v_mov_b32 v25, v24
  s_nop 1
  v_permlane16_swap_b32 v24, v25
  v_add_f32 v24, v24, v25
  v_mov_b32 v25, v24
  s_nop 1
  v_permlane32_swap_b32 v24, v25
  v_add_f32 v24, v24, v25
  v_mul_f32 v24, 989855744, v24
  v_sub_f32 v25, v16, v24
  v_mul_f32 v26, v25, v25
  v_sub_f32 v25, v17, v24
  v_fmac_f32 v26, v25, v25
  v_sub_f32 v25, v18, v24
  v_fmac_f32 v26, v25, v25
  v_sub_f32 v25, v19, v24
  v_fmac_f32 v26, v25, v25
  v_sub_f32 v25, v20, v24
  v_fmac_f32 v26, v25, v25
  v_sub_f32 v25, v21, v24
  v_fmac_f32 v26, v25, v25
  v_sub_f32 v25, v22, v24
  v_fmac_f32 v26, v25, v25
  v_sub_f32 v25, v23, v24
  v_fmac_f32 v26, v25, v25
  s_nop 1
  v_add_f32_dpp v26, v26, v26 row_ror:8 row_mask:0xf bank_mask:0xf
  s_nop 1
  v_add_f32_dpp v26, v26, v26 row_ror:4 row_mask:0xf bank_mask:0xf
  s_nop 1
  v_add_f32_dpp v26, v26, v26 row_ror:2 row_mask:0xf bank_mask:0xf
  s_nop 1
  v_add_f32_dpp v26, v26, v26 row_ror:1 row_mask:0xf bank_mask:0xf
  v_mov_b32 v25, v26
  s_nop 1
  v_permlane16_swap_b32 v26, v25
  v_add_f32 v26, v26, v25
  v_mov_b32 v25, v26
  s_nop 1
  v_permlane32_swap_b32 v26, v25
  v_add_f32 v26, v26, v25
  v_mul_f32 v26, 989855744, v26
  v_cvt_pk_bf16_f32 v26, v26, v26
  v_and_b32 v26, 0xffff0000, v26
  v_add_f32 v26, 925353388, v26
  v_cvt_pk_bf16_f32 v26, v26, v26
  v_and_b32 v26, 0xffff0000, v26
  v_sqrt_f32 v26, v26
  s_nop 0
  v_cvt_pk_bf16_f32 v26, v26, v26
  v_and_b32 v26, 0xffff0000, v26
  v_rcp_f32 v26, v26
  v_cvt_pk_bf16_f32 v24, v24, v24
  v_and_b32 v24, 0xffff0000, v24
  v_sub_f32 v16, v16, v24
  v_cvt_pk_bf16_f32 v16, v16, v16
  v_and_b32 v16, 0xffff0000, v16
  v_mul_f32 v16, v16, v26
  v_sub_f32 v17, v17, v24
  v_cvt_pk_bf16_f32 v17, v17, v17
  v_and_b32 v17, 0xffff0000, v17
  v_mul_f32 v17, v17, v26
  v_sub_f32 v18, v18, v24
  v_cvt_pk_bf16_f32 v18, v18, v18
  v_and_b32 v18, 0xffff0000, v18
  v_mul_f32 v18, v18, v26
  v_sub_f32 v19, v19, v24
  v_cvt_pk_bf16_f32 v19, v19, v19
  v_and_b32 v19, 0xffff0000, v19
  v_mul_f32 v19, v19, v26
  v_sub_f32 v20, v20, v24
  v_cvt_pk_bf16_f32 v20, v20, v20
  v_and_b32 v20, 0xffff0000, v20
  v_mul_f32 v20, v20, v26
  v_sub_f32 v21, v21, v24
  v_cvt_pk_bf16_f32 v21, v21, v21
  v_and_b32 v21, 0xffff0000, v21
  v_mul_f32 v21, v21, v26
  v_sub_f32 v22, v22, v24
  v_cvt_pk_bf16_f32 v22, v22, v22
  v_and_b32 v22, 0xffff0000, v22
  v_mul_f32 v22, v22, v26
  v_sub_f32 v23, v23, v24
  v_cvt_pk_bf16_f32 v23, v23, v23
  v_and_b32 v23, 0xffff0000, v23
  v_mul_f32 v23, v23, v26
  v_cvt_pk_bf16_f32 v4, v16, v17
  v_cvt_pk_bf16_f32 v5, v18, v19
  v_cvt_pk_bf16_f32 v6, v20, v21
  v_cvt_pk_bf16_f32 v7, v22, v23
  s_add_u32 s18, s26, 87031808
  buffer_store_dwordx4 v[4:7], v0, s[4:7], s18 offen sc1
  s_waitcnt vmcnt(10)
  v_lshlrev_b32 v16, 16, v8
  v_and_b32 v17, 0xffff0000, v8
  v_lshlrev_b32 v18, 16, v9
  v_and_b32 v19, 0xffff0000, v9
  v_lshlrev_b32 v20, 16, v10
  v_and_b32 v21, 0xffff0000, v10
  v_lshlrev_b32 v22, 16, v11
  v_and_b32 v23, 0xffff0000, v11
  v_add_f32 v24, v16, v17
  v_add_f32 v24, v24, v18
  v_add_f32 v24, v24, v19
  v_add_f32 v24, v24, v20
  v_add_f32 v24, v24, v21
  v_add_f32 v24, v24, v22
  v_add_f32 v24, v24, v23
  s_nop 1
  v_add_f32_dpp v24, v24, v24 row_ror:8 row_mask:0xf bank_mask:0xf
  s_nop 1
  v_add_f32_dpp v24, v24, v24 row_ror:4 row_mask:0xf bank_mask:0xf
  s_nop 1
  v_add_f32_dpp v24, v24, v24 row_ror:2 row_mask:0xf bank_mask:0xf
  s_nop 1
  v_add_f32_dpp v24, v24, v24 row_ror:1 row_mask:0xf bank_mask:0xf
  v_mov_b32 v25, v24
  s_nop 1
  v_permlane16_swap_b32 v24, v25
  v_add_f32 v24, v24, v25
  v_mov_b32 v25, v24
  s_nop 1
  v_permlane32_swap_b32 v24, v25
  v_add_f32 v24, v24, v25
  v_mul_f32 v24, 989855744, v24
  v_sub_f32 v25, v16, v24
  v_mul_f32 v26, v25, v25
  v_sub_f32 v25, v17, v24
  v_fmac_f32 v26, v25, v25
  v_sub_f32 v25, v18, v24
  v_fmac_f32 v26, v25, v25
  v_sub_f32 v25, v19, v24
  v_fmac_f32 v26, v25, v25
  v_sub_f32 v25, v20, v24
  v_fmac_f32 v26, v25, v25
  v_sub_f32 v25, v21, v24
  v_fmac_f32 v26, v25, v25
  v_sub_f32 v25, v22, v24
  v_fmac_f32 v26, v25, v25
  v_sub_f32 v25, v23, v24
  v_fmac_f32 v26, v25, v25
  s_nop 1
  v_add_f32_dpp v26, v26, v26 row_ror:8 row_mask:0xf bank_mask:0xf
  s_nop 1
  v_add_f32_dpp v26, v26, v26 row_ror:4 row_mask:0xf bank_mask:0xf
  s_nop 1
  v_add_f32_dpp v26, v26, v26 row_ror:2 row_mask:0xf bank_mask:0xf
  s_nop 1
  v_add_f32_dpp v26, v26, v26 row_ror:1 row_mask:0xf bank_mask:0xf
  v_mov_b32 v25, v26
  s_nop 1
  v_permlane16_swap_b32 v26, v25
  v_add_f32 v26, v26, v25
  v_mov_b32 v25, v26
  s_nop 1
  v_permlane32_swap_b32 v26, v25
  v_add_f32 v26, v26, v25
  v_mul_f32 v26, 989855744, v26
  v_cvt_pk_bf16_f32 v26, v26, v26
  v_and_b32 v26, 0xffff0000, v26
  v_add_f32 v26, 925353388, v26
  v_cvt_pk_bf16_f32 v26, v26, v26
  v_and_b32 v26, 0xffff0000, v26
  v_sqrt_f32 v26, v26
  s_nop 0
  v_cvt_pk_bf16_f32 v26, v26, v26
  v_and_b32 v26, 0xffff0000, v26
  v_rcp_f32 v26, v26
  v_cvt_pk_bf16_f32 v24, v24, v24
  v_and_b32 v24, 0xffff0000, v24
  v_sub_f32 v16, v16, v24
  v_cvt_pk_bf16_f32 v16, v16, v16
  v_and_b32 v16, 0xffff0000, v16
  v_mul_f32 v16, v16, v26
  v_sub_f32 v17, v17, v24
  v_cvt_pk_bf16_f32 v17, v17, v17
  v_and_b32 v17, 0xffff0000, v17
  v_mul_f32 v17, v17, v26
  v_sub_f32 v18, v18, v24
  v_cvt_pk_bf16_f32 v18, v18, v18
  v_and_b32 v18, 0xffff0000, v18
  v_mul_f32 v18, v18, v26
  v_sub_f32 v19, v19, v24
  v_cvt_pk_bf16_f32 v19, v19, v19
  v_and_b32 v19, 0xffff0000, v19
  v_mul_f32 v19, v19, v26
  v_sub_f32 v20, v20, v24
  v_cvt_pk_bf16_f32 v20, v20, v20
  v_and_b32 v20, 0xffff0000, v20
  v_mul_f32 v20, v20, v26
  v_sub_f32 v21, v21, v24
  v_cvt_pk_bf16_f32 v21, v21, v21
  v_and_b32 v21, 0xffff0000, v21
  v_mul_f32 v21, v21, v26
  v_sub_f32 v22, v22, v24
  v_cvt_pk_bf16_f32 v22, v22, v22
  v_and_b32 v22, 0xffff0000, v22
  v_mul_f32 v22, v22, v26
  v_sub_f32 v23, v23, v24
  v_cvt_pk_bf16_f32 v23, v23, v23
  v_and_b32 v23, 0xffff0000, v23
  v_mul_f32 v23, v23, v26
  v_cvt_pk_bf16_f32 v8, v16, v17
  v_cvt_pk_bf16_f32 v9, v18, v19
  v_cvt_pk_bf16_f32 v10, v20, v21
  v_cvt_pk_bf16_f32 v11, v22, v23
  s_add_u32 s18, s27, 87031808
  buffer_store_dwordx4 v[8:11], v0, s[4:7], s18 offen sc1
  s_waitcnt vmcnt(10)
  v_lshlrev_b32 v16, 16, v12
  v_and_b32 v17, 0xffff0000, v12
  v_lshlrev_b32 v18, 16, v13
  v_and_b32 v19, 0xffff0000, v13
  v_lshlrev_b32 v20, 16, v14
  v_and_b32 v21, 0xffff0000, v14
  v_lshlrev_b32 v22, 16, v15
  v_and_b32 v23, 0xffff0000, v15
  v_add_f32 v24, v16, v17
  v_add_f32 v24, v24, v18
  v_add_f32 v24, v24, v19
  v_add_f32 v24, v24, v20
  v_add_f32 v24, v24, v21
  v_add_f32 v24, v24, v22
  v_add_f32 v24, v24, v23
  s_nop 1
  v_add_f32_dpp v24, v24, v24 row_ror:8 row_mask:0xf bank_mask:0xf
  s_nop 1
  v_add_f32_dpp v24, v24, v24 row_ror:4 row_mask:0xf bank_mask:0xf
  s_nop 1
  v_add_f32_dpp v24, v24, v24 row_ror:2 row_mask:0xf bank_mask:0xf
  s_nop 1
  v_add_f32_dpp v24, v24, v24 row_ror:1 row_mask:0xf bank_mask:0xf
  v_mov_b32 v25, v24
  s_nop 1
  v_permlane16_swap_b32 v24, v25
  v_add_f32 v24, v24, v25
  v_mov_b32 v25, v24
  s_nop 1
  v_permlane32_swap_b32 v24, v25
  v_add_f32 v24, v24, v25
  v_mul_f32 v24, 989855744, v24
  v_sub_f32 v25, v16, v24
  v_mul_f32 v26, v25, v25
  v_sub_f32 v25, v17, v24
  v_fmac_f32 v26, v25, v25
  v_sub_f32 v25, v18, v24
  v_fmac_f32 v26, v25, v25
  v_sub_f32 v25, v19, v24
  v_fmac_f32 v26, v25, v25
  v_sub_f32 v25, v20, v24
  v_fmac_f32 v26, v25, v25
  v_sub_f32 v25, v21, v24
  v_fmac_f32 v26, v25, v25
  v_sub_f32 v25, v22, v24
  v_fmac_f32 v26, v25, v25
  v_sub_f32 v25, v23, v24
  v_fmac_f32 v26, v25, v25
  s_nop 1
  v_add_f32_dpp v26, v26, v26 row_ror:8 row_mask:0xf bank_mask:0xf
  s_nop 1
  v_add_f32_dpp v26, v26, v26 row_ror:4 row_mask:0xf bank_mask:0xf
  s_nop 1
  v_add_f32_dpp v26, v26, v26 row_ror:2 row_mask:0xf bank_mask:0xf
  s_nop 1
  v_add_f32_dpp v26, v26, v26 row_ror:1 row_mask:0xf bank_mask:0xf
  v_mov_b32 v25, v26
  s_nop 1
  v_permlane16_swap_b32 v26, v25
  v_add_f32 v26, v26, v25
  v_mov_b32 v25, v26
  s_nop 1
  v_permlane32_swap_b32 v26, v25
  v_add_f32 v26, v26, v25
  v_mul_f32 v26, 989855744, v26
  v_cvt_pk_bf16_f32 v26, v26, v26
  v_and_b32 v26, 0xffff0000, v26
  v_add_f32 v26, 925353388, v26
  v_cvt_pk_bf16_f32 v26, v26, v26
  v_and_b32 v26, 0xffff0000, v26
  v_sqrt_f32 v26, v26
  s_nop 0
  v_cvt_pk_bf16_f32 v26, v26, v26
  v_and_b32 v26, 0xffff0000, v26
  v_rcp_f32 v26, v26
  v_cvt_pk_bf16_f32 v24, v24, v24
  v_and_b32 v24, 0xffff0000, v24
  v_sub_f32 v16, v16, v24
  v_cvt_pk_bf16_f32 v16, v16, v16
  v_and_b32 v16, 0xffff0000, v16
  v_mul_f32 v16, v16, v26
  v_sub_f32 v17, v17, v24
  v_cvt_pk_bf16_f32 v17, v17, v17
  v_and_b32 v17, 0xffff0000, v17
  v_mul_f32 v17, v17, v26
  v_sub_f32 v18, v18, v24
  v_cvt_pk_bf16_f32 v18, v18, v18
  v_and_b32 v18, 0xffff0000, v18
  v_mul_f32 v18, v18, v26
  v_sub_f32 v19, v19, v24
  v_cvt_pk_bf16_f32 v19, v19, v19
  v_and_b32 v19, 0xffff0000, v19
  v_mul_f32 v19, v19, v26
  v_sub_f32 v20, v20, v24
  v_cvt_pk_bf16_f32 v20, v20, v20
  v_and_b32 v20, 0xffff0000, v20
  v_mul_f32 v20, v20, v26
  v_sub_f32 v21, v21, v24
  v_cvt_pk_bf16_f32 v21, v21, v21
  v_and_b32 v21, 0xffff0000, v21
  v_mul_f32 v21, v21, v26
  v_sub_f32 v22, v22, v24
  v_cvt_pk_bf16_f32 v22, v22, v22
  v_and_b32 v22, 0xffff0000, v22
  v_mul_f32 v22, v22, v26
  v_sub_f32 v23, v23, v24
  v_cvt_pk_bf16_f32 v23, v23, v23
  v_and_b32 v23, 0xffff0000, v23
  v_mul_f32 v23, v23, v26
  v_cvt_pk_bf16_f32 v12, v16, v17
  v_cvt_pk_bf16_f32 v13, v18, v19
  v_cvt_pk_bf16_f32 v14, v20, v21
  v_cvt_pk_bf16_f32 v15, v22, v23
  s_add_u32 s18, s28, 87031808
  buffer_store_dwordx4 v[12:15], v0, s[4:7], s18 offen sc1
  v_mov_b32 v16, 0
  s_lshl_b32 s18, s12, 9
  s_lshl_b32 s19, s13, 7
  s_add_u32 s18, s18, s19
  s_lshl_b32 s19, s14, 4
  s_add_u32 s18, s18, s19
  s_add_u32 s29, s18, 589824
  buffer_store_dword v16, off, s[4:7], s29 sc1
  s_mul_i32 s18, s14, 1536
  s_add_u32 s18, s18, 577536
  s_lshl_b32 s19, s13, 7
  s_add_u32 s30, s18, s19
  s_lshl_b32 s19, s12, 2
  s_add_u32 s31, s30, s19
  s_lshl_b32 s19, s12, 4
  s_add_u32 s32, s18, s19
  s_lshl_b32 s19, s13, 2
  s_add_u32 s32, s32, s19
  buffer_store_dword v16, off, s[4:7], s31 sc1
  buffer_store_dword v16, off, s[4:7], s32 offset:512 sc1
  buffer_store_dword v16, off, s[4:7], s31 offset:1024 sc1
  s_waitcnt vmcnt(11)
  s_waitcnt lgkmcnt(0)
  s_barrier
  ds_read_b64_tr_b16 a[0:1], v29 offset:0
  ds_read_b64_tr_b16 a[4:5], v33 offset:0
  ds_read_b64_tr_b16 a[2:3], v29 offset:1024
  ds_read_b64_tr_b16 a[6:7], v33 offset:1024
  ds_read_b64_tr_b16 a[8:9], v29 offset:2048
  ds_read_b64_tr_b16 a[12:13], v33 offset:2048
  s_sub_u32 s25, s14, 1
  s_lshl_b32 s25, s25, 5
  s_add_u32 s25, s25, s12
  s_lshl_b32 s25, s25, 2
  s_add_u32 s25, s25, s13
  s_mul_i32 s25, s25, 5120
  s_add_u32 s18, s25, 0
  buffer_load_dwordx4 v[36:39], v0, s[44:47], s18 offen
  s_add_u32 s18, s25, 1024
  buffer_load_dwordx4 v[36:39], v0, s[44:47], s18 offen
  s_add_u32 s18, s25, 2048
  buffer_load_dwordx4 v[36:39], v0, s[44:47], s18 offen
  s_add_u32 s18, s25, 3072
  buffer_load_dwordx4 v[36:39], v0, s[44:47], s18 offen
  s_add_u32 s18, s25, 4096
  buffer_load_dwordx4 v[36:39], v0, s[44:47], s18 offen
  ds_read_b64_tr_b16 a[10:11], v29 offset:3072
  ds_read_b64_tr_b16 a[14:15], v33 offset:3072
  s_waitcnt vmcnt(12)
  s_waitcnt lgkmcnt(0)
  s_barrier
  s_mov_b32 s18, 1048576
  s_add_u32 m0, s35, 0
  s_nop 0
  buffer_load_dwordx4 v28, s[48:51], s18 offen lds
  s_mov_b32 s18, 1081344
  s_add_u32 m0, s35, 1024
  s_nop 0
  buffer_load_dwordx4 v28, s[48:51], s18 offen lds
  s_mov_b32 s18, 1310720
  s_add_u32 m0, s35, 2048
  s_nop 0
  buffer_load_dwordx4 v28, s[48:51], s18 offen lds
  s_mov_b32 s18, 1343488
  s_add_u32 m0, s35, 3072
  s_nop 0
  buffer_load_dwordx4 v28, s[48:51], s18 offen lds
  ds_read_b64_tr_b16 a[16:17], v29 offset:4096
  ds_read_b64_tr_b16 a[20:21], v33 offset:4096
  ds_read_b64_tr_b16 a[18:19], v29 offset:5120
  ds_read_b64_tr_b16 a[22:23], v33 offset:5120
  ds_read_b64_tr_b16 a[24:25], v29 offset:6144
  ds_read_b64_tr_b16 a[28:29], v33 offset:6144
  ds_read_b64_tr_b16 a[26:27], v29 offset:7168
  ds_read_b64_tr_b16 a[30:31], v33 offset:7168
  s_waitcnt vmcnt(0)
  s_waitcnt lgkmcnt(0)
  s_barrier
  s_mov_b32 s18, 1572864
  s_add_u32 m0, s35, 4096
  s_nop 0
  buffer_load_dwordx4 v28, s[48:51], s18 offen lds
  s_mov_b32 s18, 1605632
  s_add_u32 m0, s35, 5120
  s_nop 0
  buffer_load_dwordx4 v28, s[48:51], s18 offen lds
  s_mov_b32 s18, 1835008
  s_add_u32 m0, s35, 6144
  s_nop 0
  buffer_load_dwordx4 v28, s[48:51], s18 offen lds
  s_mov_b32 s18, 1867776
  s_add_u32 m0, s35, 7168
  s_nop 0
  buffer_load_dwordx4 v28, s[48:51], s18 offen lds
  ds_read_b64_tr_b16 a[32:33], v29 offset:0
  ds_read_b64_tr_b16 a[36:37], v33 offset:0
  ds_read_b64_tr_b16 a[34:35], v29 offset:1024
  ds_read_b64_tr_b16 a[38:39], v33 offset:1024
  ds_read_b64_tr_b16 a[40:41], v29 offset:2048
  ds_read_b64_tr_b16 a[44:45], v33 offset:2048
  ds_read_b64_tr_b16 a[42:43], v29 offset:3072
  ds_read_b64_tr_b16 a[46:47], v33 offset:3072
  s_lshl_b32 s25, s14, 5
  s_barrier
  s_cmp_lg_u32 s13, 0
  s_cbranch_scc1 L_ao_e
  v_mov_b32 v27, 1
  s_mov_b64 exec, 1
  buffer_atomic_add v27, off, s[92:95], s25 offset:4
  s_mov_b64 exec, -1
  s_branch L_ad_e
L_ao_e:
  buffer_load_dword v27, off, s[4:7], 0
L_ad_e:
  s_waitcnt vmcnt(1)
  s_waitcnt lgkmcnt(0)
  s_barrier
  s_mov_b32 s18, 2097152
  s_add_u32 m0, s35, 0
  s_nop 0
  buffer_load_dwordx4 v28, s[48:51], s18 offen lds
  s_mov_b32 s18, 2129920
  s_add_u32 m0, s35, 1024
  s_nop 0
  buffer_load_dwordx4 v28, s[48:51], s18 offen lds
  s_mov_b32 s18, 2359296
  s_add_u32 m0, s35, 2048
  s_nop 0
  buffer_load_dwordx4 v28, s[48:51], s18 offen lds
  s_mov_b32 s18, 2392064
  s_add_u32 m0, s35, 3072
  s_nop 0
  buffer_load_dwordx4 v28, s[48:51], s18 offen lds
  ds_read_b64_tr_b16 a[48:49], v29 offset:4096
  ds_read_b64_tr_b16 a[52:53], v33 offset:4096
  ds_read_b64_tr_b16 a[50:51], v29 offset:5120
  ds_read_b64_tr_b16 a[54:55], v33 offset:5120
  ds_read_b64_tr_b16 a[56:57], v29 offset:6144
  ds_read_b64_tr_b16 a[60:61], v33 offset:6144
  ds_read_b64_tr_b16 a[58:59], v29 offset:7168
  ds_read_b64_tr_b16 a[62:63], v33 offset:7168
  s_waitcnt vmcnt(0)
  s_waitcnt lgkmcnt(0)
  s_barrier
  s_mov_b32 s18, 2621440
  s_add_u32 m0, s35, 4096
  s_nop 0
  buffer_load_dwordx4 v28, s[48:51], s18 offen lds
  s_mov_b32 s18, 2654208
  s_add_u32 m0, s35, 5120
  s_nop 0
  buffer_load_dwordx4 v28, s[48:51], s18 offen lds
  s_mov_b32 s18, 2883584
  s_add_u32 m0, s35, 6144
  s_nop 0
  buffer_load_dwordx4 v28, s[48:51], s18 offen lds
  s_mov_b32 s18, 2916352
  s_add_u32 m0, s35, 7168
  s_nop 0
  buffer_load_dwordx4 v28, s[48:51], s18 offen lds
  ds_read_b64_tr_b16 a[64:65], v29 offset:0
  ds_read_b64_tr_b16 a[68:69], v33 offset:0
  ds_read_b64_tr_b16 a[66:67], v29 offset:1024
  ds_read_b64_tr_b16 a[70:71], v33 offset:1024
  ds_read_b64_tr_b16 a[72:73], v29 offset:2048
  ds_read_b64_tr_b16 a[76:77], v33 offset:2048
  ds_read_b64_tr_b16 a[74:75], v29 offset:3072
  ds_read_b64_tr_b16 a[78:79], v33 offset:3072
  s_waitcnt vmcnt(0)
  s_waitcnt lgkmcnt(0)
  s_barrier
  s_mov_b32 s18, 3145728
  s_add_u32 m0, s35, 0
  s_nop 0
  buffer_load_dwordx4 v28, s[48:51], s18 offen lds
  s_mov_b32 s18, 3178496
  s_add_u32 m0, s35, 1024
  s_nop 0
  buffer_load_dwordx4 v28, s[48:51], s18 offen lds
  s_mov_b32 s18, 3407872
  s_add_u32 m0, s35, 2048
  s_nop 0
  buffer_load_dwordx4 v28, s[48:51], s18 offen lds
  s_mov_b32 s18, 3440640
  s_add_u32 m0, s35, 3072
  s_nop 0
  buffer_load_dwordx4 v28, s[48:51], s18 offen lds
  ds_read_b64_tr_b16 a[80:81], v29 offset:4096
  ds_read_b64_tr_b16 a[84:85], v33 offset:4096
  ds_read_b64_tr_b16 a[82:83], v29 offset:5120
  ds_read_b64_tr_b16 a[86:87], v33 offset:5120
  ds_read_b64_tr_b16 a[88:89], v29 offset:6144
  ds_read_b64_tr_b16 a[92:93], v33 offset:6144
  ds_read_b64_tr_b16 a[90:91], v29 offset:7168
  ds_read_b64_tr_b16 a[94:95], v33 offset:7168
  s_waitcnt vmcnt(0)
  s_waitcnt lgkmcnt(0)
  s_barrier
  s_mov_b32 s18, 3670016
  s_add_u32 m0, s35, 4096
  s_nop 0
  buffer_load_dwordx4 v28, s[48:51], s18 offen lds
  s_mov_b32 s18, 3702784
  s_add_u32 m0, s35, 5120
  s_nop 0
  buffer_load_dwordx4 v28, s[48:51], s18 offen lds
  s_mov_b32 s18, 3932160
  s_add_u32 m0, s35, 6144
  s_nop 0
  buffer_load_dwordx4 v28, s[48:51], s18 offen lds
  s_mov_b32 s18, 3964928
  s_add_u32 m0, s35, 7168
  s_nop 0
  buffer_load_dwordx4 v28, s[48:51], s18 offen lds
  ds_read_b64_tr_b16 a[96:97], v29 offset:0
  ds_read_b64_tr_b16 a[100:101], v33 offset:0
  ds_read_b64_tr_b16 a[98:99], v29 offset:1024
  ds_read_b64_tr_b16 a[102:103], v33 offset:1024
  ds_read_b64_tr_b16 a[104:105], v29 offset:2048
  ds_read_b64_tr_b16 a[108:109], v33 offset:2048
  ds_read_b64_tr_b16 a[106:107], v29 offset:3072
  ds_read_b64_tr_b16 a[110:111], v33 offset:3072
  s_waitcnt vmcnt(0)
  s_waitcnt lgkmcnt(0)
  s_barrier
  s_mov_b32 s18, 0
  s_add_u32 m0, s35, 0
  s_nop 0
  buffer_load_dwordx4 v28, s[52:55], s18 offen lds
  s_mov_b32 s18, 32768
  s_add_u32 m0, s35, 1024
  s_nop 0
  buffer_load_dwordx4 v28, s[52:55], s18 offen lds
  s_mov_b32 s18, 262144
  s_add_u32 m0, s35, 2048
  s_nop 0
  buffer_load_dwordx4 v28, s[52:55], s18 offen lds
  s_mov_b32 s18, 294912
  s_add_u32 m0, s35, 3072
  s_nop 0
  buffer_load_dwordx4 v28, s[52:55], s18 offen lds
  ds_read_b64_tr_b16 a[112:113], v29 offset:4096
  ds_read_b64_tr_b16 a[116:117], v33 offset:4096
  ds_read_b64_tr_b16 a[114:115], v29 offset:5120
  ds_read_b64_tr_b16 a[118:119], v33 offset:5120
  ds_read_b64_tr_b16 a[120:121], v29 offset:6144
  ds_read_b64_tr_b16 a[124:125], v33 offset:6144
  ds_read_b64_tr_b16 a[122:123], v29 offset:7168
  ds_read_b64_tr_b16 a[126:127], v33 offset:7168
  s_waitcnt vmcnt(0)
  s_waitcnt lgkmcnt(0)
  s_barrier
  s_mov_b32 s18, 524288
  s_add_u32 m0, s35, 4096
  s_nop 0
  buffer_load_dwordx4 v28, s[52:55], s18 offen lds
  s_mov_b32 s18, 557056
  s_add_u32 m0, s35, 5120
  s_nop 0
  buffer_load_dwordx4 v28, s[52:55], s18 offen lds
  s_mov_b32 s18, 786432
  s_add_u32 m0, s35, 6144
  s_nop 0
  buffer_load_dwordx4 v28, s[52:55], s18 offen lds
  s_mov_b32 s18, 819200
  s_add_u32 m0, s35, 7168
  s_nop 0
  buffer_load_dwordx4 v28, s[52:55], s18 offen lds
  ds_read_b64_tr_b16 a[128:129], v29 offset:0
  ds_read_b64_tr_b16 a[132:133], v33 offset:0
  ds_read_b64_tr_b16 a[130:131], v29 offset:1024
  ds_read_b64_tr_b16 a[134:135], v33 offset:1024
  ds_read_b64_tr_b16 a[136:137], v29 offset:2048
  ds_read_b64_tr_b16 a[140:141], v33 offset:2048
  ds_read_b64_tr_b16 a[138:139], v29 offset:3072
  ds_read_b64_tr_b16 a[142:143], v33 offset:3072
  s_waitcnt vmcnt(0)
  s_waitcnt lgkmcnt(0)
  s_barrier
  s_mov_b32 s18, 1048576
  s_add_u32 m0, s35, 0
  s_nop 0
  buffer_load_dwordx4 v28, s[52:55], s18 offen lds
  s_mov_b32 s18, 1081344
  s_add_u32 m0, s35, 1024
  s_nop 0
  buffer_load_dwordx4 v28, s[52:55], s18 offen lds
  s_mov_b32 s18, 1310720
  s_add_u32 m0, s35, 2048
  s_nop 0
  buffer_load_dwordx4 v28, s[52:55], s18 offen lds
  s_mov_b32 s18, 1343488
  s_add_u32 m0, s35, 3072
  s_nop 0
  buffer_load_dwordx4 v28, s[52:55], s18 offen lds
  ds_read_b64_tr_b16 a[144:145], v29 offset:4096
  ds_read_b64_tr_b16 a[148:149], v33 offset:4096
  v_lshrrev_b32 v6, 4, v0
  v_lshrrev_b32 v4, 3, v6
  v_and_b32 v5, 7, v6
  v_xor_b32 v5, v5, v4
  v_lshlrev_b32 v5, 4, v5
  v_lshlrev_b32 v4, 10, v4
  v_add_u32 v4, v4, v5
  s_lshl_b32 s18, s13, 13
  v_add_u32 v1, s18, v4
  v_and_b32 v4, 7, v6
  v_lshrrev_b32 v5, 4, v6
  v_xor_b32 v5, v5, v4
  v_lshlrev_b32 v5, 4, v5
  v_lshlrev_b32 v4, 7, v4
  v_add_u32 v4, v4, v5
  v_and_b32 v5, 8, v6
  v_lshlrev_b32 v5, 10, v5
  v_add_u32 v2, v4, v5
  v_xor_b32 v3, 64, v2
  v_lshlrev_b32 v34, 1, v0
  v_and_b32 v34, 0xe0, v34
  buffer_load_dword v35, v34, s[92:95], 0 offen offset:4 sc1
  ds_read_b64_tr_b16 a[146:147], v29 offset:5120
  ds_read_b64_tr_b16 a[150:151], v33 offset:5120
  ds_read_b64_tr_b16 a[152:153], v29 offset:6144
  ds_read_b64_tr_b16 a[156:157], v33 offset:6144
  ds_read_b64_tr_b16 a[154:155], v29 offset:7168
  ds_read_b64_tr_b16 a[158:159], v33 offset:7168
  s_waitcnt vmcnt(1)
  s_waitcnt lgkmcnt(0)
  s_barrier
  s_mov_b32 s18, 1572864
  s_add_u32 m0, s35, 4096
  s_nop 0
  buffer_load_dwordx4 v28, s[52:55], s18 offen lds
  s_mov_b32 s18, 1605632
  s_add_u32 m0, s35, 5120
  s_nop 0
  buffer_load_dwordx4 v28, s[52:55], s18 offen lds
  s_mov_b32 s18, 1835008
  s_add_u32 m0, s35, 6144
  s_nop 0
  buffer_load_dwordx4 v28, s[52:55], s18 offen lds
  s_mov_b32 s18, 1867776
  s_add_u32 m0, s35, 7168
  s_nop 0
  buffer_load_dwordx4 v28, s[52:55], s18 offen lds
  ds_read_b64_tr_b16 a[160:161], v29 offset:0
  ds_read_b64_tr_b16 a[164:165], v33 offset:0
  ds_read_b64_tr_b16 a[162:163], v29 offset:1024
  ds_read_b64_tr_b16 a[166:167], v33 offset:1024
  ds_read_b64_tr_b16 a[168:169], v29 offset:2048
  ds_read_b64_tr_b16 a[172:173], v33 offset:2048
  ds_read_b64_tr_b16 a[170:171], v29 offset:3072
  ds_read_b64_tr_b16 a[174:175], v33 offset:3072
  s_waitcnt vmcnt(0)
  s_waitcnt lgkmcnt(0)
  s_barrier
  s_mov_b32 s18, 2097152
  s_add_u32 m0, s35, 0
  s_nop 0
  buffer_load_dwordx4 v28, s[52:55], s18 offen lds
  s_mov_b32 s18, 2129920
  s_add_u32 m0, s35, 1024
  s_nop 0
  buffer_load_dwordx4 v28, s[52:55], s18 offen lds
  s_mov_b32 s18, 2359296
  s_add_u32 m0, s35, 2048
  s_nop 0
  buffer_load_dwordx4 v28, s[52:55], s18 offen lds
  s_mov_b32 s18, 2392064
  s_add_u32 m0, s35, 3072
  s_nop 0
  buffer_load_dwordx4 v28, s[52:55], s18 offen lds
  ds_read_b64_tr_b16 a[176:177], v29 offset:4096
  ds_read_b64_tr_b16 a[180:181], v33 offset:4096
  ds_read_b64_tr_b16 a[178:179], v29 offset:5120
  ds_read_b64_tr_b16 a[182:183], v33 offset:5120
  ds_read_b64_tr_b16 a[184:185], v29 offset:6144
  ds_read_b64_tr_b16 a[188:189], v33 offset:6144
  ds_read_b64_tr_b16 a[186:187], v29 offset:7168
  ds_read_b64_tr_b16 a[190:191], v33 offset:7168
  s_waitcnt vmcnt(0)
  s_waitcnt lgkmcnt(0)
  s_barrier
  s_mov_b32 s18, 2621440
  s_add_u32 m0, s35, 4096
  s_nop 0
  buffer_load_dwordx4 v28, s[52:55], s18 offen lds
  s_mov_b32 s18, 2654208
  s_add_u32 m0, s35, 5120
  s_nop 0
  buffer_load_dwordx4 v28, s[52:55], s18 offen lds
  s_mov_b32 s18, 2883584
  s_add_u32 m0, s35, 6144
  s_nop 0
  buffer_load_dwordx4 v28, s[52:55], s18 offen lds
  s_mov_b32 s18, 2916352
  s_add_u32 m0, s35, 7168
  s_nop 0
  buffer_load_dwordx4 v28, s[52:55], s18 offen lds
  ds_read_b64_tr_b16 a[192:193], v29 offset:0
  ds_read_b64_tr_b16 a[196:197], v33 offset:0
  v_cmp_gt_u32 vcc, 32, v35
  s_cmp_eq_u64 vcc, 0
  s_cselect_b32 s42, 1, 0
  s_sub_u32 s17, s14, 1
  s_lshl_b32 s33, s17, 15
  s_add_u32 s33, s33, 87031808
  s_lshl_b32 s34, s17, 13
  s_mul_i32 s18, s12, 2097152
  s_add_u32 s34, s34, s18
  s_lshl_b32 s18, s13, 11
  s_add_u32 s34, s34, s18
  s_add_u32 s34, s34, 16777216
  s_lshl_b32 s36, s13, 13
  s_add_u32 s37, s36, 32768
  s_mov_b32 s16, 0
  s_lshl_b32 s38, s17, 2
  s_add_u32 s38, s38, s13
  s_lshl_b32 s38, s38, 10
  s_mul_i32 s18, s12, 2097152
  s_add_u32 s38, s38, s18
  s_add_u32 s38, s38, 18350080
  v_mov_b32 v80, -1
  v_mov_b32 v81, -1
  v_mov_b32 v82, -1
  v_mov_b32 v83, -1
  s_add_u32 m0, s36, 0
  s_nop 0
  buffer_load_dwordx4 v1, s[4:7], s33 offen offset:0 sc1 lds
  s_add_u32 m0, s36, 896
  s_nop 0
  buffer_load_dwordx4 v1, s[4:7], s33 offen offset:128 sc1 lds
  s_add_u32 m0, s36, 1792
  s_nop 0
  buffer_load_dwordx4 v1, s[4:7], s33 offen offset:256 sc1 lds
  s_add_u32 m0, s36, 2688
  s_nop 0
  buffer_load_dwordx4 v1, s[4:7], s33 offen offset:384 sc1 lds
  s_add_u32 m0, s36, 3584
  s_nop 0
  buffer_load_dwordx4 v1, s[4:7], s33 offen offset:512 sc1 lds
  s_add_u32 m0, s36, 4480
  s_nop 0
  buffer_load_dwordx4 v1, s[4:7], s33 offen offset:640 sc1 lds
  s_add_u32 m0, s36, 5376
  s_nop 0
  buffer_load_dwordx4 v1, s[4:7], s33 offen offset:768 sc1 lds
  s_add_u32 m0, s36, 6272
  s_nop 0
  buffer_load_dwordx4 v1, s[4:7], s33 offen offset:896 sc1 lds
  ds_read_b64_tr_b16 a[194:195], v29 offset:1024
  ds_read_b64_tr_b16 a[198:199], v33 offset:1024
  ds_read_b64_tr_b16 a[200:201], v29 offset:2048
  ds_read_b64_tr_b16 a[204:205], v33 offset:2048
  ds_read_b64_tr_b16 a[202:203], v29 offset:3072
  ds_read_b64_tr_b16 a[206:207], v33 offset:3072
  s_waitcnt vmcnt(8)
  s_waitcnt lgkmcnt(0)
  s_barrier
  s_mov_b32 s18, 3145728
  s_add_u32 m0, s35, 0
  s_nop 0
  buffer_load_dwordx4 v28, s[52:55], s18 offen lds
  s_mov_b32 s18, 3178496
  s_add_u32 m0, s35, 1024
  s_nop 0
  buffer_load_dwordx4 v28, s[52:55], s18 offen lds
  s_mov_b32 s18, 3407872
  s_add_u32 m0, s35, 2048
  s_nop 0
  buffer_load_dwordx4 v28, s[52:55], s18 offen lds
  s_mov_b32 s18, 3440640
  s_add_u32 m0, s35, 3072
  s_nop 0
  buffer_load_dwordx4 v28, s[52:55], s18 offen lds
  ds_read_b64_tr_b16 a[208:209], v29 offset:4096
  ds_read_b64_tr_b16 a[212:213], v33 offset:4096
  ds_read_b64_tr_b16 a[210:211], v29 offset:5120
  ds_read_b64_tr_b16 a[214:215], v33 offset:5120
  ds_read_b64_tr_b16 a[216:217], v29 offset:6144
  ds_read_b64_tr_b16 a[220:221], v33 offset:6144
  ds_read_b64_tr_b16 a[218:219], v29 offset:7168
  ds_read_b64_tr_b16 a[222:223], v33 offset:7168
  s_waitcnt vmcnt(0)
  s_waitcnt lgkmcnt(0)
  s_barrier
  s_mov_b32 s18, 3670016
  s_add_u32 m0, s35, 4096
  s_nop 0
  buffer_load_dwordx4 v28, s[52:55], s18 offen lds
  s_mov_b32 s18, 3702784
  s_add_u32 m0, s35, 5120
  s_nop 0
  buffer_load_dwordx4 v28, s[52:55], s18 offen lds
  s_mov_b32 s18, 3932160
  s_add_u32 m0, s35, 6144
  s_nop 0
  buffer_load_dwordx4 v28, s[52:55], s18 offen lds
  s_mov_b32 s18, 3964928
  s_add_u32 m0, s35, 7168
  s_nop 0
  buffer_load_dwordx4 v28, s[52:55], s18 offen lds
  ds_read_b64_tr_b16 a[224:225], v29 offset:0
  ds_read_b64_tr_b16 a[228:229], v33 offset:0
  ds_read_b64_tr_b16 a[226:227], v29 offset:1024
  ds_read_b64_tr_b16 a[230:231], v33 offset:1024
  ds_read_b64_tr_b16 a[232:233], v29 offset:2048
  ds_read_b64_tr_b16 a[236:237], v33 offset:2048
  ds_read_b64_tr_b16 a[234:235], v29 offset:3072
  ds_read_b64_tr_b16 a[238:239], v33 offset:3072
  s_waitcnt vmcnt(0)
  s_waitcnt lgkmcnt(0)
  s_barrier
  ds_read_b64_tr_b16 a[240:241], v29 offset:4096
  ds_read_b64_tr_b16 a[244:245], v33 offset:4096
  ds_read_b64_tr_b16 a[242:243], v29 offset:5120
  ds_read_b64_tr_b16 a[246:247], v33 offset:5120
  ds_read_b64_tr_b16 a[248:249], v29 offset:6144
  ds_read_b64_tr_b16 a[252:253], v33 offset:6144
  ds_read_b64_tr_b16 a[250:251], v29 offset:7168
  ds_read_b64_tr_b16 a[254:255], v33 offset:7168
  s_waitcnt lgkmcnt(0)
  s_barrier
  s_waitcnt lgkmcnt(0)
  v_mov_b32 v34, s42
  s_lshl_b32 s18, s13, 2
  s_add_u32 s18, s18, 65536
  v_mov_b32 v35, s18
  ds_write_b32 v35, v34
  v_mov_b32 v35, 65536
  s_waitcnt lgkmcnt(0)
  s_barrier
  ds_read_b128 v[36:39], v35
  s_waitcnt lgkmcnt(0)
  v_and_b32 v36, v36, v37
  v_and_b32 v38, v38, v39
  v_and_b32 v36, v36, v38
  s_nop 0
  v_readfirstlane_b32 s42, v36
  s_nop 0
  s_cmp_lg_u32 s42, 0
  s_cbranch_scc1 L_xok
  s_waitcnt vmcnt(0)
  s_cmp_lg_u32 s13, 0
  s_cbranch_scc1 L_wd_xn
  v_lshlrev_b32 v6, 1, v0
  v_and_b32 v6, 0xe0, v6
L_wt_xn:
  buffer_load_dword v7, v6, s[92:95], 0 offen offset:4 sc1
  s_add_u32 s24, s24, 1
  s_cmp_gt_u32 s24, 0x40000
  s_cbranch_scc1 L_bail
  s_waitcnt vmcnt(0)
  v_cmp_gt_u32 vcc, 32, v7
  s_cbranch_vccz L_wd_xn
  s_sleep 16
  s_branch L_wt_xn
L_wd_xn:
  s_barrier
  s_add_u32 m0, s36, 0
  s_nop 0
  buffer_load_dwordx4 v1, s[4:7], s33 offen offset:0 sc1 lds
  s_add_u32 m0, s36, 896
  s_nop 0
  buffer_load_dwordx4 v1, s[4:7], s33 offen offset:128 sc1 lds
  s_add_u32 m0, s36, 1792
  s_nop 0
  buffer_load_dwordx4 v1, s[4:7], s33 offen offset:256 sc1 lds
  s_add_u32 m0, s36, 2688
  s_nop 0
  buffer_load_dwordx4 v1, s[4:7], s33 offen offset:384 sc1 lds
  s_add_u32 m0, s36, 3584
  s_nop 0
  buffer_load_dwordx4 v1, s[4:7], s33 offen offset:512 sc1 lds
  s_add_u32 m0, s36, 4480
  s_nop 0
  buffer_load_dwordx4 v1, s[4:7], s33 offen offset:640 sc1 lds
  s_add_u32 m0, s36, 5376
  s_nop 0
  buffer_load_dwordx4 v1, s[4:7], s33 offen offset:768 sc1 lds
  s_add_u32 m0, s36, 6272
  s_nop 0
  buffer_load_dwordx4 v1, s[4:7], s33 offen offset:896 sc1 lds
L_xok:
L_kv_top:
  s_cmp_eq_u32 s16, 0
  s_cbranch_scc1 L_kv_first
  s_waitcnt vmcnt(5)
  s_branch L_kv_go
L_kv_first:
  s_waitcnt vmcnt(0)
L_kv_go:
  s_barrier
  s_add_u32 s33, s33, 229376
  ds_read_b128 v[8:11], v2 offset:0
  ds_read_b128 v[12:15], v2 offset:16384
  ds_read_b128 v[16:19], v3 offset:0
  ds_read_b128 v[20:23], v3 offset:16384
  s_waitcnt lgkmcnt(3)
  v_mfma_f32_16x16x32_bf16 v[32:35], a[0:3], v[8:11], 0
  ds_read_b128 v[24:27], v2 offset:1024
  v_mfma_f32_16x16x32_bf16 v[36:39], a[4:7], v[8:11], 0
  ds_read_b128 v[28:31], v2 offset:17408
  v_mfma_f32_16x16x32_bf16 v[48:51], v[8:11], a[128:131], 0
  s_add_u32 m0, s37, 0
  v_mfma_f32_16x16x32_bf16 v[52:55], v[8:11], a[132:135], 0
  buffer_load_dwordx4 v1, s[4:7], s33 offen offset:0 sc1 lds
  s_waitcnt lgkmcnt(4)
  v_mfma_f32_16x16x32_bf16 v[40:43], a[0:3], v[12:15], 0
  v_mfma_f32_16x16x32_bf16 v[44:47], a[4:7], v[12:15], 0
  v_mfma_f32_16x16x32_bf16 v[56:59], v[12:15], a[128:131], 0
  v_mfma_f32_16x16x32_bf16 v[60:63], v[12:15], a[132:135], 0
  s_waitcnt lgkmcnt(3)
  v_mfma_f32_16x16x32_bf16 v[32:35], a[8:11], v[16:19], v[32:35]
  ds_read_b128 v[8:11], v3 offset:1024
  v_mfma_f32_16x16x32_bf16 v[36:39], a[12:15], v[16:19], v[36:39]
  ds_read_b128 v[12:15], v3 offset:17408
  v_mfma_f32_16x16x32_bf16 v[48:51], v[16:19], a[136:139], v[48:51]
  s_add_u32 m0, s37, 896
  v_mfma_f32_16x16x32_bf16 v[52:55], v[16:19], a[140:143], v[52:55]
  buffer_load_dwordx4 v1, s[4:7], s33 offen offset:128 sc1 lds
  s_waitcnt lgkmcnt(4)
  v_mfma_f32_16x16x32_bf16 v[40:43], a[8:11], v[20:23], v[40:43]
  v_mfma_f32_16x16x32_bf16 v[44:47], a[12:15], v[20:23], v[44:47]
  v_mfma_f32_16x16x32_bf16 v[56:59], v[20:23], a[136:139], v[56:59]
  v_mfma_f32_16x16x32_bf16 v[60:63], v[20:23], a[140:143], v[60:63]
  s_waitcnt lgkmcnt(3)
  v_mfma_f32_16x16x32_bf16 v[32:35], a[16:19], v[24:27], v[32:35]
  ds_read_b128 v[16:19], v2 offset:2048
  v_mfma_f32_16x16x32_bf16 v[36:39], a[20:23], v[24:27], v[36:39]
  ds_read_b128 v[20:23], v2 offset:18432
  v_mfma_f32_16x16x32_bf16 v[48:51], v[24:27], a[144:147], v[48:51]
  s_add_u32 m0, s37, 1792
  v_mfma_f32_16x16x32_bf16 v[52:55], v[24:27], a[148:151], v[52:55]
  buffer_load_dwordx4 v1, s[4:7], s33 offen offset:256 sc1 lds
  s_waitcnt lgkmcnt(4)
  v_mfma_f32_16x16x32_bf16 v[40:43], a[16:19], v[28:31], v[40:43]
  v_mfma_f32_16x16x32_bf16 v[44:47], a[20:23], v[28:31], v[44:47]
  v_mfma_f32_16x16x32_bf16 v[56:59], v[28:31], a[144:147], v[56:59]
  v_mfma_f32_16x16x32_bf16 v[60:63], v[28:31], a[148:151], v[60:63]
  s_waitcnt lgkmcnt(3)
  v_mfma_f32_16x16x32_bf16 v[32:35], a[24:27], v[8:11], v[32:35]
  ds_read_b128 v[24:27], v3 offset:2048
  v_mfma_f32_16x16x32_bf16 v[36:39], a[28:31], v[8:11], v[36:39]
  ds_read_b128 v[28:31], v3 offset:18432
  v_mfma_f32_16x16x32_bf16 v[48:51], v[8:11], a[152:155], v[48:51]
  s_add_u32 m0, s37, 2688
  v_mfma_f32_16x16x32_bf16 v[52:55], v[8:11], a[156:159], v[52:55]
  buffer_load_dwordx4 v1, s[4:7], s33 offen offset:384 sc1 lds
  s_waitcnt lgkmcnt(4)
  v_mfma_f32_16x16x32_bf16 v[40:43], a[24:27], v[12:15], v[40:43]
  v_mfma_f32_16x16x32_bf16 v[44:47], a[28:31], v[12:15], v[44:47]
  v_mfma_f32_16x16x32_bf16 v[56:59], v[12:15], a[152:155], v[56:59]
  v_mfma_f32_16x16x32_bf16 v[60:63], v[12:15], a[156:159], v[60:63]
  s_waitcnt lgkmcnt(3)
  v_mfma_f32_16x16x32_bf16 v[32:35], a[32:35], v[16:19], v[32:35]
  ds_read_b128 v[8:11], v2 offset:3072
  v_mfma_f32_16x16x32_bf16 v[36:39], a[36:39], v[16:19], v[36:39]
  ds_read_b128 v[12:15], v2 offset:19456
  v_mfma_f32_16x16x32_bf16 v[48:51], v[16:19], a[160:163], v[48:51]
  s_add_u32 m0, s37, 3584
  v_mfma_f32_16x16x32_bf16 v[52:55], v[16:19], a[164:167], v[52:55]
  buffer_load_dwordx4 v1, s[4:7], s33 offen offset:512 sc1 lds
  s_waitcnt lgkmcnt(4)
  v_mfma_f32_16x16x32_bf16 v[40:43], a[32:35], v[20:23], v[40:43]
  v_mfma_f32_16x16x32_bf16 v[44:47], a[36:39], v[20:23], v[44:47]
  v_mfma_f32_16x16x32_bf16 v[56:59], v[20:23], a[160:163], v[56:59]
  v_mfma_f32_16x16x32_bf16 v[60:63], v[20:23], a[164:167], v[60:63]
  s_waitcnt lgkmcnt(3)
  v_mfma_f32_16x16x32_bf16 v[32:35], a[40:43], v[24:27], v[32:35]
  ds_read_b128 v[16:19], v3 offset:3072
  v_mfma_f32_16x16x32_bf16 v[36:39], a[44:47], v[24:27], v[36:39]
  ds_read_b128 v[20:23], v3 offset:19456
  v_mfma_f32_16x16x32_bf16 v[48:51], v[24:27], a[168:171], v[48:51]
  s_add_u32 m0, s37, 4480
  v_mfma_f32_16x16x32_bf16 v[52:55], v[24:27], a[172:175], v[52:55]
  buffer_load_dwordx4 v1, s[4:7], s33 offen offset:640 sc1 lds
  s_waitcnt lgkmcnt(4)
  v_mfma_f32_16x16x32_bf16 v[40:43], a[40:43], v[28:31], v[40:43]
  v_mfma_f32_16x16x32_bf16 v[44:47], a[44:47], v[28:31], v[44:47]
  v_mfma_f32_16x16x32_bf16 v[56:59], v[28:31], a[168:171], v[56:59]
  v_mfma_f32_16x16x32_bf16 v[60:63], v[28:31], a[172:175], v[60:63]
  s_waitcnt lgkmcnt(3)
  v_mfma_f32_16x16x32_bf16 v[32:35], a[48:51], v[8:11], v[32:35]
  ds_read_b128 v[24:27], v2 offset:4096
  v_mfma_f32_16x16x32_bf16 v[36:39], a[52:55], v[8:11], v[36:39]
  ds_read_b128 v[28:31], v2 offset:20480
  v_mfma_f32_16x16x32_bf16 v[48:51], v[8:11], a[176:179], v[48:51]
  s_add_u32 m0, s37, 5376
  v_mfma_f32_16x16x32_bf16 v[52:55], v[8:11], a[180:183], v[52:55]
  buffer_load_dwordx4 v1, s[4:7], s33 offen offset:768 sc1 lds
  s_waitcnt lgkmcnt(4)
  v_mfma_f32_16x16x32_bf16 v[40:43], a[48:51], v[12:15], v[40:43]
  v_mfma_f32_16x16x32_bf16 v[44:47], a[52:55], v[12:15], v[44:47]
  v_mfma_f32_16x16x32_bf16 v[56:59], v[12:15], a[176:179], v[56:59]
  v_mfma_f32_16x16x32_bf16 v[60:63], v[12:15], a[180:183], v[60:63]
  s_waitcnt lgkmcnt(3)
  v_mfma_f32_16x16x32_bf16 v[32:35], a[56:59], v[16:19], v[32:35]
  ds_read_b128 v[8:11], v3 offset:4096
  v_mfma_f32_16x16x32_bf16 v[36:39], a[60:63], v[16:19], v[36:39]
  ds_read_b128 v[12:15], v3 offset:20480
  v_mfma_f32_16x16x32_bf16 v[48:51], v[16:19], a[184:187], v[48:51]
  s_add_u32 m0, s37, 6272
  v_mfma_f32_16x16x32_bf16 v[52:55], v[16:19], a[188:191], v[52:55]
  buffer_load_dwordx4 v1, s[4:7], s33 offen offset:896 sc1 lds
  s_waitcnt lgkmcnt(4)
  v_mfma_f32_16x16x32_bf16 v[40:43], a[56:59], v[20:23], v[40:43]
  v_mfma_f32_16x16x32_bf16 v[44:47], a[60:63], v[20:23], v[44:47]
  v_mfma_f32_16x16x32_bf16 v[56:59], v[20:23], a[184:187], v[56:59]
  v_mfma_f32_16x16x32_bf16 v[60:63], v[20:23], a[188:191], v[60:63]
  s_waitcnt lgkmcnt(3)
  v_mfma_f32_16x16x32_bf16 v[32:35], a[64:67], v[24:27], v[32:35]
  ds_read_b128 v[16:19], v2 offset:5120
  v_mfma_f32_16x16x32_bf16 v[36:39], a[68:71], v[24:27], v[36:39]
  ds_read_b128 v[20:23], v2 offset:21504
  v_mfma_f32_16x16x32_bf16 v[48:51], v[24:27], a[192:195], v[48:51]
  v_mfma_f32_16x16x32_bf16 v[52:55], v[24:27], a[196:199], v[52:55]
  s_waitcnt lgkmcnt(4)
  v_mfma_f32_16x16x32_bf16 v[40:43], a[64:67], v[28:31], v[40:43]
  v_mfma_f32_16x16x32_bf16 v[44:47], a[68:71], v[28:31], v[44:47]
  v_mfma_f32_16x16x32_bf16 v[56:59], v[28:31], a[192:195], v[56:59]
  v_mfma_f32_16x16x32_bf16 v[60:63], v[28:31], a[196:199], v[60:63]
  s_waitcnt vmcnt(8)
  v_mov_b32 v64, s16
  buffer_store_dword v64, off, s[4:7], s29 sc1
  s_waitcnt lgkmcnt(3)
  v_mfma_f32_16x16x32_bf16 v[32:35], a[72:75], v[8:11], v[32:35]
  ds_read_b128 v[24:27], v3 offset:5120
  v_mfma_f32_16x16x32_bf16 v[36:39], a[76:79], v[8:11], v[36:39]
  ds_read_b128 v[28:31], v3 offset:21504
  v_mfma_f32_16x16x32_bf16 v[48:51], v[8:11], a[200:203], v[48:51]
  v_mfma_f32_16x16x32_bf16 v[52:55], v[8:11], a[204:207], v[52:55]
  s_waitcnt lgkmcnt(4)
  v_mfma_f32_16x16x32_bf16 v[40:43], a[72:75], v[12:15], v[40:43]
  v_mfma_f32_16x16x32_bf16 v[44:47], a[76:79], v[12:15], v[44:47]
  v_mfma_f32_16x16x32_bf16 v[56:59], v[12:15], a[200:203], v[56:59]
  v_mfma_f32_16x16x32_bf16 v[60:63], v[12:15], a[204:207], v[60:63]
  s_waitcnt lgkmcnt(3)
  v_mfma_f32_16x16x32_bf16 v[32:35], a[80:83], v[16:19], v[32:35]
  ds_read_b128 v[8:11], v2 offset:6144
  v_mfma_f32_16x16x32_bf16 v[36:39], a[84:87], v[16:19], v[36:39]
  ds_read_b128 v[12:15], v2 offset:22528
  v_mfma_f32_16x16x32_bf16 v[48:51], v[16:19], a[208:211], v[48:51]
  v_mfma_f32_16x16x32_bf16 v[52:55], v[16:19], a[212:215], v[52:55]
  s_waitcnt lgkmcnt(4)
  v_mfma_f32_16x16x32_bf16 v[40:43], a[80:83], v[20:23], v[40:43]
  v_mfma_f32_16x16x32_bf16 v[44:47], a[84:87], v[20:23], v[44:47]
  v_mfma_f32_16x16x32_bf16 v[56:59], v[20:23], a[208:211], v[56:59]
  v_mfma_f32_16x16x32_bf16 v[60:63], v[20:23], a[212:215], v[60:63]
  s_waitcnt lgkmcnt(3)
  v_mfma_f32_16x16x32_bf16 v[32:35], a[88:91], v[24:27], v[32:35]
  ds_read_b128 v[16:19], v3 offset:6144
  v_mfma_f32_16x16x32_bf16 v[36:39], a[92:95], v[24:27], v[36:39]
  ds_read_b128 v[20:23], v3 offset:22528
  v_mfma_f32_16x16x32_bf16 v[48:51], v[24:27], a[216:219], v[48:51]
  v_mfma_f32_16x16x32_bf16 v[52:55], v[24:27], a[220:223], v[52:55]
  s_waitcnt lgkmcnt(4)
  v_mfma_f32_16x16x32_bf16 v[40:43], a[88:91], v[28:31], v[40:43]
  v_mfma_f32_16x16x32_bf16 v[44:47], a[92:95], v[28:31], v[44:47]
  v_mfma_f32_16x16x32_bf16 v[56:59], v[28:31], a[216:219], v[56:59]
  v_mfma_f32_16x16x32_bf16 v[60:63], v[28:31], a[220:223], v[60:63]
  s_waitcnt lgkmcnt(3)
  v_mfma_f32_16x16x32_bf16 v[32:35], a[96:99], v[8:11], v[32:35]
  ds_read_b128 v[24:27], v2 offset:7168
  v_mfma_f32_16x16x32_bf16 v[36:39], a[100:103], v[8:11], v[36:39]
  ds_read_b128 v[28:31], v2 offset:23552
  v_mfma_f32_16x16x32_bf16 v[48:51], v[8:11], a[224:227], v[48:51]
  v_mfma_f32_16x16x32_bf16 v[52:55], v[8:11], a[228:231], v[52:55]
  s_waitcnt lgkmcnt(4)
  v_mfma_f32_16x16x32_bf16 v[40:43], a[96:99], v[12:15], v[40:43]
  v_mfma_f32_16x16x32_bf16 v[44:47], a[100:103], v[12:15], v[44:47]
  v_mfma_f32_16x16x32_bf16 v[56:59], v[12:15], a[224:227], v[56:59]
  v_mfma_f32_16x16x32_bf16 v[60:63], v[12:15], a[228:231], v[60:63]
  s_waitcnt lgkmcnt(3)
  v_mfma_f32_16x16x32_bf16 v[32:35], a[104:107], v[16:19], v[32:35]
  ds_read_b128 v[8:11], v3 offset:7168
  v_mfma_f32_16x16x32_bf16 v[36:39], a[108:111], v[16:19], v[36:39]
  ds_read_b128 v[12:15], v3 offset:23552
  v_mfma_f32_16x16x32_bf16 v[48:51], v[16:19], a[232:235], v[48:51]
  v_mfma_f32_16x16x32_bf16 v[52:55], v[16:19], a[236:239], v[52:55]
  s_waitcnt lgkmcnt(4)
  v_mfma_f32_16x16x32_bf16 v[40:43], a[104:107], v[20:23], v[40:43]
  v_mfma_f32_16x16x32_bf16 v[44:47], a[108:111], v[20:23], v[44:47]
  v_mfma_f32_16x16x32_bf16 v[56:59], v[20:23], a[232:235], v[56:59]
  v_mfma_f32_16x16x32_bf16 v[60:63], v[20:23], a[236:239], v[60:63]
  s_waitcnt lgkmcnt(3)
  v_mfma_f32_16x16x32_bf16 v[32:35], a[112:115], v[24:27], v[32:35]
  v_mfma_f32_16x16x32_bf16 v[36:39], a[116:119], v[24:27], v[36:39]
  v_mfma_f32_16x16x32_bf16 v[48:51], v[24:27], a[240:243], v[48:51]
  v_mfma_f32_16x16x32_bf16 v[52:55], v[24:27], a[244:247], v[52:55]
  s_waitcnt lgkmcnt(2)
  v_mfma_f32_16x16x32_bf16 v[40:43], a[112:115], v[28:31], v[40:43]
  v_mfma_f32_16x16x32_bf16 v[44:47], a[116:119], v[28:31], v[44:47]
  v_mfma_f32_16x16x32_bf16 v[56:59], v[28:31], a[240:243], v[56:59]
  v_mfma_f32_16x16x32_bf16 v[60:63], v[28:31], a[244:247], v[60:63]
  s_waitcnt lgkmcnt(1)
  v_mfma_f32_16x16x32_bf16 v[32:35], a[120:123], v[8:11], v[32:35]
  v_mfma_f32_16x16x32_bf16 v[36:39], a[124:127], v[8:11], v[36:39]
  v_mfma_f32_16x16x32_bf16 v[48:51], v[8:11], a[248:251], v[48:51]
  v_mfma_f32_16x16x32_bf16 v[52:55], v[8:11], a[252:255], v[52:55]
  s_waitcnt lgkmcnt(0)
  v_mfma_f32_16x16x32_bf16 v[40:43], a[120:123], v[12:15], v[40:43]
  v_mfma_f32_16x16x32_bf16 v[44:47], a[124:127], v[12:15], v[44:47]
  v_mfma_f32_16x16x32_bf16 v[56:59], v[12:15], a[248:251], v[56:59]
  v_mfma_f32_16x16x32_bf16 v[60:63], v[12:15], a[252:255], v[60:63]
  v_mul_f32 v32, s22, v32
  v_mul_f32 v33, s22, v33
  v_mul_f32 v34, s22, v34
  v_mul_f32 v35, s22, v35
  v_cvt_pk_bf16_f32 v64, v32, v33
  v_cvt_pk_bf16_f32 v65, v34, v35
  v_mul_f32 v36, s22, v36
  v_mul_f32 v37, s22, v37
  v_mul_f32 v38, s22, v38
  v_mul_f32 v39, s22, v39
  v_cvt_pk_bf16_f32 v66, v36, v37
  v_cvt_pk_bf16_f32 v67, v38, v39
  buffer_store_dwordx4 v[64:67], v0, s[4:7], s34 offen offset:0 sc1
  v_mul_f32 v40, s22, v40
  v_mul_f32 v41, s22, v41
  v_mul_f32 v42, s22, v42
  v_mul_f32 v43, s22, v43
  v_cvt_pk_bf16_f32 v68, v40, v41
  v_cvt_pk_bf16_f32 v69, v42, v43
  v_mul_f32 v44, s22, v44
  v_mul_f32 v45, s22, v45
  v_mul_f32 v46, s22, v46
  v_mul_f32 v47, s22, v47
  v_cvt_pk_bf16_f32 v70, v44, v45
  v_cvt_pk_bf16_f32 v71, v46, v47
  buffer_store_dwordx4 v[68:71], v0, s[4:7], s34 offen offset:1024 sc1
  s_add_u32 s18, s34, 524288
  v_cvt_pk_bf16_f32 v72, v48, v49
  v_cvt_pk_bf16_f32 v73, v56, v57
  v_cvt_pk_bf16_f32 v74, v50, v51
  v_cvt_pk_bf16_f32 v75, v58, v59
  buffer_store_dwordx4 v[72:75], v0, s[4:7], s18 offen offset:0 sc1
  v_cvt_pk_bf16_f32 v76, v52, v53
  v_cvt_pk_bf16_f32 v77, v60, v61
  v_cvt_pk_bf16_f32 v78, v54, v55
  v_cvt_pk_bf16_f32 v79, v62, v63
  buffer_store_dwordx4 v[76:79], v0, s[4:7], s18 offen offset:1024 sc1
  buffer_store_dwordx4 v[80:83], v0, s[4:7], s38 offen sc1
  s_add_u32 s38, s38, 28672
  s_add_u32 s34, s34, 57344
  s_add_u32 s16, s16, 1
  s_cmp_ge_u32 s16, s15
  s_cbranch_scc1 L_kv_done
  s_waitcnt vmcnt(5)
  s_barrier
  s_add_u32 s33, s33, 229376
  ds_read_b128 v[8:11], v2 offset:32768
  ds_read_b128 v[12:15], v2 offset:49152
  ds_read_b128 v[16:19], v3 offset:32768
  ds_read_b128 v[20:23], v3 offset:49152
  s_waitcnt lgkmcnt(3)
  v_mfma_f32_16x16x32_bf16 v[32:35], a[0:3], v[8:11], 0
  ds_read_b128 v[24:27], v2 offset:33792
  v_mfma_f32_16x16x32_bf16 v[36:39], a[4:7], v[8:11], 0
  ds_read_b128 v[28:31], v2 offset:50176
  v_mfma_f32_16x16x32_bf16 v[48:51], v[8:11], a[128:131], 0
  s_add_u32 m0, s36, 0
  v_mfma_f32_16x16x32_bf16 v[52:55], v[8:11], a[132:135], 0
  buffer_load_dwordx4 v1, s[4:7], s33 offen offset:0 sc1 lds
  s_waitcnt lgkmcnt(4)
  v_mfma_f32_16x16x32_bf16 v[40:43], a[0:3], v[12:15], 0
  v_mfma_f32_16x16x32_bf16 v[44:47], a[4:7], v[12:15], 0
  v_mfma_f32_16x16x32_bf16 v[56:59], v[12:15], a[128:131], 0
  v_mfma_f32_16x16x32_bf16 v[60:63], v[12:15], a[132:135], 0
  s_waitcnt lgkmcnt(3)
  v_mfma_f32_16x16x32_bf16 v[32:35], a[8:11], v[16:19], v[32:35]
  ds_read_b128 v[8:11], v3 offset:33792
  v_mfma_f32_16x16x32_bf16 v[36:39], a[12:15], v[16:19], v[36:39]
  ds_read_b128 v[12:15], v3 offset:50176
  v_mfma_f32_16x16x32_bf16 v[48:51], v[16:19], a[136:139], v[48:51]
  s_add_u32 m0, s36, 896
  v_mfma_f32_16x16x32_bf16 v[52:55], v[16:19], a[140:143], v[52:55]
  buffer_load_dwordx4 v1, s[4:7], s33 offen offset:128 sc1 lds
  s_waitcnt lgkmcnt(4)
  v_mfma_f32_16x16x32_bf16 v[40:43], a[8:11], v[20:23], v[40:43]
  v_mfma_f32_16x16x32_bf16 v[44:47], a[12:15], v[20:23], v[44:47]
  v_mfma_f32_16x16x32_bf16 v[56:59], v[20:23], a[136:139], v[56:59]
  v_mfma_f32_16x16x32_bf16 v[60:63], v[20:23], a[140:143], v[60:63]
  s_waitcnt lgkmcnt(3)
  v_mfma_f32_16x16x32_bf16 v[32:35], a[16:19], v[24:27], v[32:35]
  ds_read_b128 v[16:19], v2 offset:34816
  v_mfma_f32_16x16x32_bf16 v[36:39], a[20:23], v[24:27], v[36:39]
  ds_read_b128 v[20:23], v2 offset:51200
  v_mfma_f32_16x16x32_bf16 v[48:51], v[24:27], a[144:147], v[48:51]
  s_add_u32 m0, s36, 1792
  v_mfma_f32_16x16x32_bf16 v[52:55], v[24:27], a[148:151], v[52:55]
  buffer_load_dwordx4 v1, s[4:7], s33 offen offset:256 sc1 lds
  s_waitcnt lgkmcnt(4)
  v_mfma_f32_16x16x32_bf16 v[40:43], a[16:19], v[28:31], v[40:43]
  v_mfma_f32_16x16x32_bf16 v[44:47], a[20:23], v[28:31], v[44:47]
  v_mfma_f32_16x16x32_bf16 v[56:59], v[28:31], a[144:147], v[56:59]
  v_mfma_f32_16x16x32_bf16 v[60:63], v[28:31], a[148:151], v[60:63]
  s_waitcnt lgkmcnt(3)
  v_mfma_f32_16x16x32_bf16 v[32:35], a[24:27], v[8:11], v[32:35]
  ds_read_b128 v[24:27], v3 offset:34816
  v_mfma_f32_16x16x32_bf16 v[36:39], a[28:31], v[8:11], v[36:39]
  ds_read_b128 v[28:31], v3 offset:51200
  v_mfma_f32_16x16x32_bf16 v[48:51], v[8:11], a[152:155], v[48:51]
  s_add_u32 m0, s36, 2688
  v_mfma_f32_16x16x32_bf16 v[52:55], v[8:11], a[156:159], v[52:55]
  buffer_load_dwordx4 v1, s[4:7], s33 offen offset:384 sc1 lds
  s_waitcnt lgkmcnt(4)
  v_mfma_f32_16x16x32_bf16 v[40:43], a[24:27], v[12:15], v[40:43]
  v_mfma_f32_16x16x32_bf16 v[44:47], a[28:31], v[12:15], v[44:47]
  v_mfma_f32_16x16x32_bf16 v[56:59], v[12:15], a[152:155], v[56:59]
  v_mfma_f32_16x16x32_bf16 v[60:63], v[12:15], a[156:159], v[60:63]
  s_waitcnt lgkmcnt(3)
  v_mfma_f32_16x16x32_bf16 v[32:35], a[32:35], v[16:19], v[32:35]
  ds_read_b128 v[8:11], v2 offset:35840
  v_mfma_f32_16x16x32_bf16 v[36:39], a[36:39], v[16:19], v[36:39]
  ds_read_b128 v[12:15], v2 offset:52224
  v_mfma_f32_16x16x32_bf16 v[48:51], v[16:19], a[160:163], v[48:51]
  s_add_u32 m0, s36, 3584
  v_mfma_f32_16x16x32_bf16 v[52:55], v[16:19], a[164:167], v[52:55]
  buffer_load_dwordx4 v1, s[4:7], s33 offen offset:512 sc1 lds
  s_waitcnt lgkmcnt(4)
  v_mfma_f32_16x16x32_bf16 v[40:43], a[32:35], v[20:23], v[40:43]
  v_mfma_f32_16x16x32_bf16 v[44:47], a[36:39], v[20:23], v[44:47]
  v_mfma_f32_16x16x32_bf16 v[56:59], v[20:23], a[160:163], v[56:59]
  v_mfma_f32_16x16x32_bf16 v[60:63], v[20:23], a[164:167], v[60:63]
  s_waitcnt lgkmcnt(3)
  v_mfma_f32_16x16x32_bf16 v[32:35], a[40:43], v[24:27], v[32:35]
  ds_read_b128 v[16:19], v3 offset:35840
  v_mfma_f32_16x16x32_bf16 v[36:39], a[44:47], v[24:27], v[36:39]
  ds_read_b128 v[20:23], v3 offset:52224
  v_mfma_f32_16x16x32_bf16 v[48:51], v[24:27], a[168:171], v[48:51]
  s_add_u32 m0, s36, 4480
  v_mfma_f32_16x16x32_bf16 v[52:55], v[24:27], a[172:175], v[52:55]
  buffer_load_dwordx4 v1, s[4:7], s33 offen offset:640 sc1 lds
  s_waitcnt lgkmcnt(4)
  v_mfma_f32_16x16x32_bf16 v[40:43], a[40:43], v[28:31], v[40:43]
  v_mfma_f32_16x16x32_bf16 v[44:47], a[44:47], v[28:31], v[44:47]
  v_mfma_f32_16x16x32_bf16 v[56:59], v[28:31], a[168:171], v[56:59]
  v_mfma_f32_16x16x32_bf16 v[60:63], v[28:31], a[172:175], v[60:63]
  s_waitcnt lgkmcnt(3)
  v_mfma_f32_16x16x32_bf16 v[32:35], a[48:51], v[8:11], v[32:35]
  ds_read_b128 v[24:27], v2 offset:36864
  v_mfma_f32_16x16x32_bf16 v[36:39], a[52:55], v[8:11], v[36:39]
  ds_read_b128 v[28:31], v2 offset:53248
  v_mfma_f32_16x16x32_bf16 v[48:51], v[8:11], a[176:179], v[48:51]
  s_add_u32 m0, s36, 5376
  v_mfma_f32_16x16x32_bf16 v[52:55], v[8:11], a[180:183], v[52:55]
  buffer_load_dwordx4 v1, s[4:7], s33 offen offset:768 sc1 lds
  s_waitcnt lgkmcnt(4)
  v_mfma_f32_16x16x32_bf16 v[40:43], a[48:51], v[12:15], v[40:43]
  v_mfma_f32_16x16x32_bf16 v[44:47], a[52:55], v[12:15], v[44:47]
  v_mfma_f32_16x16x32_bf16 v[56:59], v[12:15], a[176:179], v[56:59]
  v_mfma_f32_16x16x32_bf16 v[60:63], v[12:15], a[180:183], v[60:63]
  s_waitcnt lgkmcnt(3)
  v_mfma_f32_16x16x32_bf16 v[32:35], a[56:59], v[16:19], v[32:35]
  ds_read_b128 v[8:11], v3 offset:36864
  v_mfma_f32_16x16x32_bf16 v[36:39], a[60:63], v[16:19], v[36:39]
  ds_read_b128 v[12:15], v3 offset:53248
  v_mfma_f32_16x16x32_bf16 v[48:51], v[16:19], a[184:187], v[48:51]
  s_add_u32 m0, s36, 6272
  v_mfma_f32_16x16x32_bf16 v[52:55], v[16:19], a[188:191], v[52:55]
  buffer_load_dwordx4 v1, s[4:7], s33 offen offset:896 sc1 lds
  s_waitcnt lgkmcnt(4)
  v_mfma_f32_16x16x32_bf16 v[40:43], a[56:59], v[20:23], v[40:43]
  v_mfma_f32_16x16x32_bf16 v[44:47], a[60:63], v[20:23], v[44:47]
  v_mfma_f32_16x16x32_bf16 v[56:59], v[20:23], a[184:187], v[56:59]
  v_mfma_f32_16x16x32_bf16 v[60:63], v[20:23], a[188:191], v[60:63]
  s_waitcnt lgkmcnt(3)
  v_mfma_f32_16x16x32_bf16 v[32:35], a[64:67], v[24:27], v[32:35]
  ds_read_b128 v[16:19], v2 offset:37888
  v_mfma_f32_16x16x32_bf16 v[36:39], a[68:71], v[24:27], v[36:39]
  ds_read_b128 v[20:23], v2 offset:54272
  v_mfma_f32_16x16x32_bf16 v[48:51], v[24:27], a[192:195], v[48:51]
  v_mfma_f32_16x16x32_bf16 v[52:55], v[24:27], a[196:199], v[52:55]
  s_waitcnt lgkmcnt(4)
  v_mfma_f32_16x16x32_bf16 v[40:43], a[64:67], v[28:31], v[40:43]
  v_mfma_f32_16x16x32_bf16 v[44:47], a[68:71], v[28:31], v[44:47]
  v_mfma_f32_16x16x32_bf16 v[56:59], v[28:31], a[192:195], v[56:59]
  v_mfma_f32_16x16x32_bf16 v[60:63], v[28:31], a[196:199], v[60:63]
  s_waitcnt vmcnt(8)
  v_mov_b32 v64, s16
  buffer_store_dword v64, off, s[4:7], s29 sc1
  s_waitcnt lgkmcnt(3)
  v_mfma_f32_16x16x32_bf16 v[32:35], a[72:75], v[8:11], v[32:35]
  ds_read_b128 v[24:27], v3 offset:37888
  v_mfma_f32_16x16x32_bf16 v[36:39], a[76:79], v[8:11], v[36:39]
  ds_read_b128 v[28:31], v3 offset:54272
  v_mfma_f32_16x16x32_bf16 v[48:51], v[8:11], a[200:203], v[48:51]
  v_mfma_f32_16x16x32_bf16 v[52:55], v[8:11], a[204:207], v[52:55]
  s_waitcnt lgkmcnt(4)
  v_mfma_f32_16x16x32_bf16 v[40:43], a[72:75], v[12:15], v[40:43]
  v_mfma_f32_16x16x32_bf16 v[44:47], a[76:79], v[12:15], v[44:47]
  v_mfma_f32_16x16x32_bf16 v[56:59], v[12:15], a[200:203], v[56:59]
  v_mfma_f32_16x16x32_bf16 v[60:63], v[12:15], a[204:207], v[60:63]
  s_waitcnt lgkmcnt(3)
  v_mfma_f32_16x16x32_bf16 v[32:35], a[80:83], v[16:19], v[32:35]
  ds_read_b128 v[8:11], v2 offset:38912
  v_mfma_f32_16x16x32_bf16 v[36:39], a[84:87], v[16:19], v[36:39]
  ds_read_b128 v[12:15], v2 offset:55296
  v_mfma_f32_16x16x32_bf16 v[48:51], v[16:19], a[208:211], v[48:51]
  v_mfma_f32_16x16x32_bf16 v[52:55], v[16:19], a[212:215], v[52:55]
  s_waitcnt lgkmcnt(4)
  v_mfma_f32_16x16x32_bf16 v[40:43], a[80:83], v[20:23], v[40:43]
  v_mfma_f32_16x16x32_bf16 v[44:47], a[84:87], v[20:23], v[44:47]
  v_mfma_f32_16x16x32_bf16 v[56:59], v[20:23], a[208:211], v[56:59]
  v_mfma_f32_16x16x32_bf16 v[60:63], v[20:23], a[212:215], v[60:63]
  s_waitcnt lgkmcnt(3)
  v_mfma_f32_16x16x32_bf16 v[32:35], a[88:91], v[24:27], v[32:35]
  ds_read_b128 v[16:19], v3 offset:38912
  v_mfma_f32_16x16x32_bf16 v[36:39], a[92:95], v[24:27], v[36:39]
  ds_read_b128 v[20:23], v3 offset:55296
  v_mfma_f32_16x16x32_bf16 v[48:51], v[24:27], a[216:219], v[48:51]
  v_mfma_f32_16x16x32_bf16 v[52:55], v[24:27], a[220:223], v[52:55]
  s_waitcnt lgkmcnt(4)
  v_mfma_f32_16x16x32_bf16 v[40:43], a[88:91], v[28:31], v[40:43]
  v_mfma_f32_16x16x32_bf16 v[44:47], a[92:95], v[28:31], v[44:47]
  v_mfma_f32_16x16x32_bf16 v[56:59], v[28:31], a[216:219], v[56:59]
  v_mfma_f32_16x16x32_bf16 v[60:63], v[28:31], a[220:223], v[60:63]
  s_waitcnt lgkmcnt(3)
  v_mfma_f32_16x16x32_bf16 v[32:35], a[96:99], v[8:11], v[32:35]
  ds_read_b128 v[24:27], v2 offset:39936
  v_mfma_f32_16x16x32_bf16 v[36:39], a[100:103], v[8:11], v[36:39]
  ds_read_b128 v[28:31], v2 offset:56320
  v_mfma_f32_16x16x32_bf16 v[48:51], v[8:11], a[224:227], v[48:51]
  v_mfma_f32_16x16x32_bf16 v[52:55], v[8:11], a[228:231], v[52:55]
  s_waitcnt lgkmcnt(4)
  v_mfma_f32_16x16x32_bf16 v[40:43], a[96:99], v[12:15], v[40:43]
  v_mfma_f32_16x16x32_bf16 v[44:47], a[100:103], v[12:15], v[44:47]
  v_mfma_f32_16x16x32_bf16 v[56:59], v[12:15], a[224:227], v[56:59]
  v_mfma_f32_16x16x32_bf16 v[60:63], v[12:15], a[228:231], v[60:63]
  s_waitcnt lgkmcnt(3)
  v_mfma_f32_16x16x32_bf16 v[32:35], a[104:107], v[16:19], v[32:35]
  ds_read_b128 v[8:11], v3 offset:39936
  v_mfma_f32_16x16x32_bf16 v[36:39], a[108:111], v[16:19], v[36:39]
  ds_read_b128 v[12:15], v3 offset:56320
  v_mfma_f32_16x16x32_bf16 v[48:51], v[16:19], a[232:235], v[48:51]
  v_mfma_f32_16x16x32_bf16 v[52:55], v[16:19], a[236:239], v[52:55]
  s_waitcnt lgkmcnt(4)
  v_mfma_f32_16x16x32_bf16 v[40:43], a[104:107], v[20:23], v[40:43]
  v_mfma_f32_16x16x32_bf16 v[44:47], a[108:111], v[20:23], v[44:47]
  v_mfma_f32_16x16x32_bf16 v[56:59], v[20:23], a[232:235], v[56:59]
  v_mfma_f32_16x16x32_bf16 v[60:63], v[20:23], a[236:239], v[60:63]
  s_waitcnt lgkmcnt(3)
  v_mfma_f32_16x16x32_bf16 v[32:35], a[112:115], v[24:27], v[32:35]
  v_mfma_f32_16x16x32_bf16 v[36:39], a[116:119], v[24:27], v[36:39]
  v_mfma_f32_16x16x32_bf16 v[48:51], v[24:27], a[240:243], v[48:51]
  v_mfma_f32_16x16x32_bf16 v[52:55], v[24:27], a[244:247], v[52:55]
  s_waitcnt lgkmcnt(2)
  v_mfma_f32_16x16x32_bf16 v[40:43], a[112:115], v[28:31], v[40:43]
  v_mfma_f32_16x16x32_bf16 v[44:47], a[116:119], v[28:31], v[44:47]
  v_mfma_f32_16x16x32_bf16 v[56:59], v[28:31], a[240:243], v[56:59]
  v_mfma_f32_16x16x32_bf16 v[60:63], v[28:31], a[244:247], v[60:63]
  s_waitcnt lgkmcnt(1)
  v_mfma_f32_16x16x32_bf16 v[32:35], a[120:123], v[8:11], v[32:35]
  v_mfma_f32_16x16x32_bf16 v[36:39], a[124:127], v[8:11], v[36:39]
  v_mfma_f32_16x16x32_bf16 v[48:51], v[8:11], a[248:251], v[48:51]
  v_mfma_f32_16x16x32_bf16 v[52:55], v[8:11], a[252:255], v[52:55]
  s_waitcnt lgkmcnt(0)
  v_mfma_f32_16x16x32_bf16 v[40:43], a[120:123], v[12:15], v[40:43]
  v_mfma_f32_16x16x32_bf16 v[44:47], a[124:127], v[12:15], v[44:47]
  v_mfma_f32_16x16x32_bf16 v[56:59], v[12:15], a[248:251], v[56:59]
  v_mfma_f32_16x16x32_bf16 v[60:63], v[12:15], a[252:255], v[60:63]
  v_mul_f32 v32, s22, v32
  v_mul_f32 v33, s22, v33
  v_mul_f32 v34, s22, v34
  v_mul_f32 v35, s22, v35
  v_cvt_pk_bf16_f32 v64, v32, v33
  v_cvt_pk_bf16_f32 v65, v34, v35
  v_mul_f32 v36, s22, v36
  v_mul_f32 v37, s22, v37
  v_mul_f32 v38, s22, v38
  v_mul_f32 v39, s22, v39
  v_cvt_pk_bf16_f32 v66, v36, v37
  v_cvt_pk_bf16_f32 v67, v38, v39
  buffer_store_dwordx4 v[64:67], v0, s[4:7], s34 offen offset:0 sc1
  v_mul_f32 v40, s22, v40
  v_mul_f32 v41, s22, v41
  v_mul_f32 v42, s22, v42
  v_mul_f32 v43, s22, v43
  v_cvt_pk_bf16_f32 v68, v40, v41
  v_cvt_pk_bf16_f32 v69, v42, v43
  v_mul_f32 v44, s22, v44
  v_mul_f32 v45, s22, v45
  v_mul_f32 v46, s22, v46
  v_mul_f32 v47, s22, v47
  v_cvt_pk_bf16_f32 v70, v44, v45
  v_cvt_pk_bf16_f32 v71, v46, v47
  buffer_store_dwordx4 v[68:71], v0, s[4:7], s34 offen offset:1024 sc1
  s_add_u32 s18, s34, 524288
  v_cvt_pk_bf16_f32 v72, v48, v49
  v_cvt_pk_bf16_f32 v73, v56, v57
  v_cvt_pk_bf16_f32 v74, v50, v51
  v_cvt_pk_bf16_f32 v75, v58, v59
  buffer_store_dwordx4 v[72:75], v0, s[4:7], s18 offen offset:0 sc1
  v_cvt_pk_bf16_f32 v76, v52, v53
  v_cvt_pk_bf16_f32 v77, v60, v61
  v_cvt_pk_bf16_f32 v78, v54, v55
  v_cvt_pk_bf16_f32 v79, v62, v63
  buffer_store_dwordx4 v[76:79], v0, s[4:7], s18 offen offset:1024 sc1
  buffer_store_dwordx4 v[80:83], v0, s[4:7], s38 offen sc1
  s_add_u32 s38, s38, 28672
  s_add_u32 s34, s34, 57344
  s_add_u32 s16, s16, 1
  s_cmp_ge_u32 s16, s15
  s_cbranch_scc0 L_kv_top
L_kv_done:
  s_waitcnt vmcnt(0)
  v_mov_b32 v64, s16
  buffer_store_dword v64, off, s[4:7], s29 sc1
  v_lshrrev_b32 v32, 4, v0
  s_mul_i32 s35, s13, 24576
  s_add_u32 s35, s35, 65536
  v_and_b32 v30, 32, v32
  v_lshlrev_b32 v30, 11, v30
  v_and_b32 v31, 16, v32
  v_lshlrev_b32 v31, 10, v31
  v_add_u32 v30, v30, v31
  v_and_b32 v31, 8, v32
  v_lshlrev_b32 v31, 10, v31
  v_add_u32 v30, v30, v31
  v_lshrrev_b32 v31, 3, v32
  v_and_b32 v31, 6, v31
  v_xor_b32 v31, v31, v32
  v_and_b32 v31, 7, v31
  v_lshlrev_b32 v31, 4, v31
  v_add_u32 v30, v30, v31
  s_lshl_b32 s18, s12, 8
  s_and_b32 s19, s13, 2
  s_lshl_b32 s19, s19, 6
  s_add_u32 s18, s18, s19
  v_add_u32 v28, s18, v30
  s_and_b32 s19, s13, 1
  s_lshl_b32 s18, s19, 17
  v_add_u32 v28, s18, v28
  s_mul_i32 s19, s19, 24576
  v_lshrrev_b32 v31, 5, v32
  v_mul_u32_u24 v31, 24576, v31
  v_subrev_u32 v31, s19, v31
  v_bfe_u32 v30, v32, 2, 3
  v_lshlrev_b32 v30, 7, v30
  v_add_u32 v30, v30, v31
  v_bfe_u32 v31, v32, 3, 2
  s_and_b32 s19, s13, 1
  s_lshl_b32 s19, s19, 1
  v_xor_b32 v31, s19, v31
  v_lshlrev_b32 v31, 5, v31
  v_add_u32 v30, v30, v31
  v_and_b32 v31, 3, v32
  v_lshlrev_b32 v31, 3, v31
  v_add_u32 v30, v30, v31
  v_add_u32 v29, s35, v30
  v_xor_b32 v33, 32, v29
  s_barrier
  s_mov_b32 s18, 0
  s_add_u32 m0, s35, 0
  s_nop 0
  buffer_load_dwordx4 v28, s[44:47], s18 offen lds
  s_mov_b32 s18, 32768
  s_add_u32 m0, s35, 1024
  s_nop 0
  buffer_load_dwordx4 v28, s[44:47], s18 offen lds
  s_mov_b32 s18, 262144
  s_add_u32 m0, s35, 2048
  s_nop 0
  buffer_load_dwordx4 v28, s[44:47], s18 offen lds
  s_mov_b32 s18, 294912
  s_add_u32 m0, s35, 3072
  s_nop 0
  buffer_load_dwordx4 v28, s[44:47], s18 offen lds
  s_waitcnt vmcnt(2)
  s_waitcnt lgkmcnt(0)
  s_barrier
  ds_read_b64_tr_b16 v[128:129], v29 offset:0
  ds_read_b64_tr_b16 v[132:133], v33 offset:0
  ds_read_b64_tr_b16 v[130:131], v29 offset:1024
  ds_read_b64_tr_b16 v[134:135], v33 offset:1024
  s_waitcnt vmcnt(0)
  s_waitcnt lgkmcnt(0)
  s_barrier
  s_mov_b32 s18, 524288
  s_add_u32 m0, s35, 0
  s_nop 0
  buffer_load_dwordx4 v28, s[44:47], s18 offen lds
  s_mov_b32 s18, 557056
  s_add_u32 m0, s35, 1024
  s_nop 0
  buffer_load_dwordx4 v28, s[44:47], s18 offen lds
  ds_read_b64_tr_b16 v[136:137], v29 offset:2048
  ds_read_b64_tr_b16 v[140:141], v33 offset:2048
  ds_read_b64_tr_b16 v[138:139], v29 offset:3072
  ds_read_b64_tr_b16 v[142:143], v33 offset:3072
  s_waitcnt vmcnt(0)
  s_waitcnt lgkmcnt(0)
  s_barrier
  s_mov_b32 s18, 786432
  s_add_u32 m0, s35, 2048
  s_nop 0
  buffer_load_dwordx4 v28, s[44:47], s18 offen lds
  s_mov_b32 s18, 819200
  s_add_u32 m0, s35, 3072
  s_nop 0
  buffer_load_dwordx4 v28, s[44:47], s18 offen lds
  ds_read_b64_tr_b16 v[144:145], v29 offset:0
  ds_read_b64_tr_b16 v[148:149], v33 offset:0
  ds_read_b64_tr_b16 v[146:147], v29 offset:1024
  ds_read_b64_tr_b16 v[150:151], v33 offset:1024
  s_waitcnt vmcnt(0)
  s_waitcnt lgkmcnt(0)
  s_barrier
  s_mov_b32 s18, 1048576
  s_add_u32 m0, s35, 0
  s_nop 0
  buffer_load_dwordx4 v28, s[44:47], s18 offen lds
  s_mov_b32 s18, 1081344
  s_add_u32 m0, s35, 1024
  s_nop 0
  buffer_load_dwordx4 v28, s[44:47], s18 offen lds
  ds_read_b64_tr_b16 v[152:153], v29 offset:2048
  ds_read_b64_tr_b16 v[156:157], v33 offset:2048
  ds_read_b64_tr_b16 v[154:155], v29 offset:3072
  ds_read_b64_tr_b16 v[158:159], v33 offset:3072
  s_waitcnt vmcnt(0)
  s_waitcnt lgkmcnt(0)
  s_barrier
  s_mov_b32 s18, 1310720
  s_add_u32 m0, s35, 2048
  s_nop 0
  buffer_load_dwordx4 v28, s[44:47], s18 offen lds
  s_mov_b32 s18, 1343488
  s_add_u32 m0, s35, 3072
  s_nop 0
  buffer_load_dwordx4 v28, s[44:47], s18 offen lds
  ds_read_b64_tr_b16 v[160:161], v29 offset:0
  ds_read_b64_tr_b16 v[164:165], v33 offset:0
  ds_read_b64_tr_b16 v[162:163], v29 offset:1024
  ds_read_b64_tr_b16 v[166:167], v33 offset:1024
  s_waitcnt vmcnt(0)
  s_waitcnt lgkmcnt(0)
  s_barrier
  s_mov_b32 s18, 1572864
  s_add_u32 m0, s35, 0
  s_nop 0
  buffer_load_dwordx4 v28, s[44:47], s18 offen lds
  s_mov_b32 s18, 1605632
  s_add_u32 m0, s35, 1024
  s_nop 0
  buffer_load_dwordx4 v28, s[44:47], s18 offen lds
  ds_read_b64_tr_b16 v[168:169], v29 offset:2048
  ds_read_b64_tr_b16 v[172:173], v33 offset:2048
  ds_read_b64_tr_b16 v[170:171], v29 offset:3072
  ds_read_b64_tr_b16 v[174:175], v33 offset:3072
  s_waitcnt vmcnt(0)
  s_waitcnt lgkmcnt(0)
  s_barrier
  s_mov_b32 s18, 1835008
  s_add_u32 m0, s35, 2048
  s_nop 0
  buffer_load_dwordx4 v28, s[44:47], s18 offen lds
  s_mov_b32 s18, 1867776
  s_add_u32 m0, s35, 3072
  s_nop 0
  buffer_load_dwordx4 v28, s[44:47], s18 offen lds
  ds_read_b64_tr_b16 v[176:177], v29 offset:0
  ds_read_b64_tr_b16 v[180:181], v33 offset:0
  ds_read_b64_tr_b16 v[178:179], v29 offset:1024
  ds_read_b64_tr_b16 v[182:183], v33 offset:1024
  s_waitcnt vmcnt(0)
  s_waitcnt lgkmcnt(0)
  s_barrier
  s_mov_b32 s18, 2097152
  s_add_u32 m0, s35, 0
  s_nop 0
  buffer_load_dwordx4 v28, s[44:47], s18 offen lds
  s_mov_b32 s18, 2129920
  s_add_u32 m0, s35, 1024
  s_nop 0
  buffer_load_dwordx4 v28, s[44:47], s18 offen lds
  ds_read_b64_tr_b16 v[184:185], v29 offset:2048
  ds_read_b64_tr_b16 v[188:189], v33 offset:2048
  ds_read_b64_tr_b16 v[186:187], v29 offset:3072
  ds_read_b64_tr_b16 v[190:191], v33 offset:3072
  s_waitcnt vmcnt(0)
  s_waitcnt lgkmcnt(0)
  s_barrier
  s_mov_b32 s18, 2359296
  s_add_u32 m0, s35, 2048
  s_nop 0
  buffer_load_dwordx4 v28, s[44:47], s18 offen lds
  s_mov_b32 s18, 2392064
  s_add_u32 m0, s35, 3072
  s_nop 0
  buffer_load_dwordx4 v28, s[44:47], s18 offen lds
  ds_read_b64_tr_b16 v[192:193], v29 offset:0
  ds_read_b64_tr_b16 v[196:197], v33 offset:0
  ds_read_b64_tr_b16 v[194:195], v29 offset:1024
  ds_read_b64_tr_b16 v[198:199], v33 offset:1024
  s_waitcnt vmcnt(0)
  s_waitcnt lgkmcnt(0)
  s_barrier
  s_mov_b32 s18, 2621440
  s_add_u32 m0, s35, 0
  s_nop 0
  buffer_load_dwordx4 v28, s[44:47], s18 offen lds
  s_mov_b32 s18, 2654208
  s_add_u32 m0, s35, 1024
  s_nop 0
  buffer_load_dwordx4 v28, s[44:47], s18 offen lds
  ds_read_b64_tr_b16 v[200:201], v29 offset:2048
  ds_read_b64_tr_b16 v[204:205], v33 offset:2048
  ds_read_b64_tr_b16 v[202:203], v29 offset:3072
  ds_read_b64_tr_b16 v[206:207], v33 offset:3072
  s_waitcnt vmcnt(0)
  s_waitcnt lgkmcnt(0)
  s_barrier
  s_mov_b32 s18, 2883584
  s_add_u32 m0, s35, 2048
  s_nop 0
  buffer_load_dwordx4 v28, s[44:47], s18 offen lds
  s_mov_b32 s18, 2916352
  s_add_u32 m0, s35, 3072
  s_nop 0
  buffer_load_dwordx4 v28, s[44:47], s18 offen lds
  ds_read_b64_tr_b16 v[208:209], v29 offset:0
  ds_read_b64_tr_b16 v[212:213], v33 offset:0
  ds_read_b64_tr_b16 v[210:211], v29 offset:1024
  ds_read_b64_tr_b16 v[214:215], v33 offset:1024
  s_waitcnt vmcnt(0)
  s_waitcnt lgkmcnt(0)
  s_barrier
  s_mov_b32 s18, 3145728
  s_add_u32 m0, s35, 0
  s_nop 0
  buffer_load_dwordx4 v28, s[44:47], s18 offen lds
  s_mov_b32 s18, 3178496
  s_add_u32 m0, s35, 1024
  s_nop 0
  buffer_load_dwordx4 v28, s[44:47], s18 offen lds
  ds_read_b64_tr_b16 v[216:217], v29 offset:2048
  ds_read_b64_tr_b16 v[220:221], v33 offset:2048
  ds_read_b64_tr_b16 v[218:219], v29 offset:3072
  ds_read_b64_tr_b16 v[222:223], v33 offset:3072
  s_waitcnt vmcnt(0)
  s_waitcnt lgkmcnt(0)
  s_barrier
  s_mov_b32 s18, 3407872
  s_add_u32 m0, s35, 2048
  s_nop 0
  buffer_load_dwordx4 v28, s[44:47], s18 offen lds
  s_mov_b32 s18, 3440640
  s_add_u32 m0, s35, 3072
  s_nop 0
  buffer_load_dwordx4 v28, s[44:47], s18 offen lds
  ds_read_b64_tr_b16 v[224:225], v29 offset:0
  ds_read_b64_tr_b16 v[228:229], v33 offset:0
  ds_read_b64_tr_b16 v[226:227], v29 offset:1024
  ds_read_b64_tr_b16 v[230:231], v33 offset:1024
  s_waitcnt vmcnt(0)
  s_waitcnt lgkmcnt(0)
  s_barrier
  s_mov_b32 s18, 3670016
  s_add_u32 m0, s35, 0
  s_nop 0
  buffer_load_dwordx4 v28, s[44:47], s18 offen lds
  s_mov_b32 s18, 3702784
  s_add_u32 m0, s35, 1024
  s_nop 0
  buffer_load_dwordx4 v28, s[44:47], s18 offen lds
  ds_read_b64_tr_b16 v[232:233], v29 offset:2048
  ds_read_b64_tr_b16 v[236:237], v33 offset:2048
  ds_read_b64_tr_b16 v[234:235], v29 offset:3072
  ds_read_b64_tr_b16 v[238:239], v33 offset:3072
  s_waitcnt vmcnt(0)
  s_waitcnt lgkmcnt(0)
  s_barrier
  s_mov_b32 s18, 3932160
  s_add_u32 m0, s35, 2048
  s_nop 0
  buffer_load_dwordx4 v28, s[44:47], s18 offen lds
  s_mov_b32 s18, 3964928
  s_add_u32 m0, s35, 3072
  s_nop 0
  buffer_load_dwordx4 v28, s[44:47], s18 offen lds
  ds_read_b64_tr_b16 v[240:241], v29 offset:0
  ds_read_b64_tr_b16 v[244:245], v33 offset:0
  ds_read_b64_tr_b16 v[242:243], v29 offset:1024
  ds_read_b64_tr_b16 v[246:247], v33 offset:1024
  s_waitcnt vmcnt(0)
  s_waitcnt lgkmcnt(0)
  s_barrier
  ds_read_b64_tr_b16 v[248:249], v29 offset:2048
  ds_read_b64_tr_b16 v[252:253], v33 offset:2048
  ds_read_b64_tr_b16 v[250:251], v29 offset:3072
  ds_read_b64_tr_b16 v[254:255], v33 offset:3072
  s_waitcnt lgkmcnt(0)
  s_barrier
  s_waitcnt lgkmcnt(0)
  s_sub_u32 s17, s14, 1
  s_lshl_b32 s33, s17, 15
  s_add_u32 s33, s33, 87031808
  s_lshl_b32 s34, s17, 13
  s_mul_i32 s18, s12, 2097152
  s_add_u32 s34, s34, s18
  s_lshl_b32 s18, s13, 11
  s_add_u32 s34, s34, s18
  s_add_u32 s34, s34, 17825792
  s_lshl_b32 s36, s13, 13
  s_add_u32 s37, s36, 32768
  s_mov_b32 s16, 0
  s_add_u32 m0, s36, 0
  s_nop 0
  buffer_load_dwordx4 v1, s[4:7], s33 offen offset:0 sc1 lds
  s_add_u32 m0, s36, 896
  s_nop 0
  buffer_load_dwordx4 v1, s[4:7], s33 offen offset:128 sc1 lds
  s_add_u32 m0, s36, 1792
  s_nop 0
  buffer_load_dwordx4 v1, s[4:7], s33 offen offset:256 sc1 lds
  s_add_u32 m0, s36, 2688
  s_nop 0
  buffer_load_dwordx4 v1, s[4:7], s33 offen offset:384 sc1 lds
  s_add_u32 m0, s36, 3584
  s_nop 0
  buffer_load_dwordx4 v1, s[4:7], s33 offen offset:512 sc1 lds
  s_add_u32 m0, s36, 4480
  s_nop 0
  buffer_load_dwordx4 v1, s[4:7], s33 offen offset:640 sc1 lds
  s_add_u32 m0, s36, 5376
  s_nop 0
  buffer_load_dwordx4 v1, s[4:7], s33 offen offset:768 sc1 lds
  s_add_u32 m0, s36, 6272
  s_nop 0
  buffer_load_dwordx4 v1, s[4:7], s33 offen offset:896 sc1 lds
L_q_top:
  s_cmp_eq_u32 s16, 0
  s_cbranch_scc1 L_q_first
  s_waitcnt vmcnt(2)
  s_branch L_q_go
L_q_first:
  s_waitcnt vmcnt(0)
L_q_go:
  s_barrier
  s_add_u32 s33, s33, 229376
  ds_read_b128 v[8:11], v2 offset:0
  ds_read_b128 v[12:15], v2 offset:16384
  ds_read_b128 v[16:19], v3 offset:0
  ds_read_b128 v[20:23], v3 offset:16384
  s_waitcnt lgkmcnt(3)
  v_mfma_f32_16x16x32_bf16 v[32:35], v[128:131], v[8:11], 0
  ds_read_b128 v[24:27], v2 offset:1024
  v_mfma_f32_16x16x32_bf16 v[36:39], v[132:135], v[8:11], 0
  ds_read_b128 v[28:31], v2 offset:17408
  s_waitcnt lgkmcnt(4)
  v_mfma_f32_16x16x32_bf16 v[40:43], v[128:131], v[12:15], 0
  s_add_u32 m0, s37, 0
  v_mfma_f32_16x16x32_bf16 v[44:47], v[132:135], v[12:15], 0
  buffer_load_dwordx4 v1, s[4:7], s33 offen offset:0 sc1 lds
  s_waitcnt lgkmcnt(3)
  v_mfma_f32_16x16x32_bf16 v[32:35], v[136:139], v[16:19], v[32:35]
  ds_read_b128 v[8:11], v3 offset:1024
  v_mfma_f32_16x16x32_bf16 v[36:39], v[140:143], v[16:19], v[36:39]
  ds_read_b128 v[12:15], v3 offset:17408
  s_waitcnt lgkmcnt(4)
  v_mfma_f32_16x16x32_bf16 v[40:43], v[136:139], v[20:23], v[40:43]
  s_add_u32 m0, s37, 896
  v_mfma_f32_16x16x32_bf16 v[44:47], v[140:143], v[20:23], v[44:47]
  buffer_load_dwordx4 v1, s[4:7], s33 offen offset:128 sc1 lds
  s_waitcnt lgkmcnt(3)
  v_mfma_f32_16x16x32_bf16 v[32:35], v[144:147], v[24:27], v[32:35]
  ds_read_b128 v[16:19], v2 offset:2048
  v_mfma_f32_16x16x32_bf16 v[36:39], v[148:151], v[24:27], v[36:39]
  ds_read_b128 v[20:23], v2 offset:18432
  s_waitcnt lgkmcnt(4)
  v_mfma_f32_16x16x32_bf16 v[40:43], v[144:147], v[28:31], v[40:43]
  s_add_u32 m0, s37, 1792
  v_mfma_f32_16x16x32_bf16 v[44:47], v[148:151], v[28:31], v[44:47]
  buffer_load_dwordx4 v1, s[4:7], s33 offen offset:256 sc1 lds
  s_waitcnt lgkmcnt(3)
  v_mfma_f32_16x16x32_bf16 v[32:35], v[152:155], v[8:11], v[32:35]
  ds_read_b128 v[24:27], v3 offset:2048
  v_mfma_f32_16x16x32_bf16 v[36:39], v[156:159], v[8:11], v[36:39]
  ds_read_b128 v[28:31], v3 offset:18432
  s_waitcnt lgkmcnt(4)
  v_mfma_f32_16x16x32_bf16 v[40:43], v[152:155], v[12:15], v[40:43]
  s_add_u32 m0, s37, 2688
  v_mfma_f32_16x16x32_bf16 v[44:47], v[156:159], v[12:15], v[44:47]
  buffer_load_dwordx4 v1, s[4:7], s33 offen offset:384 sc1 lds
  s_waitcnt lgkmcnt(3)
  v_mfma_f32_16x16x32_bf16 v[32:35], v[160:163], v[16:19], v[32:35]
  ds_read_b128 v[8:11], v2 offset:3072
  v_mfma_f32_16x16x32_bf16 v[36:39], v[164:167], v[16:19], v[36:39]
  ds_read_b128 v[12:15], v2 offset:19456
  s_waitcnt lgkmcnt(4)
  v_mfma_f32_16x16x32_bf16 v[40:43], v[160:163], v[20:23], v[40:43]
  s_add_u32 m0, s37, 3584
  v_mfma_f32_16x16x32_bf16 v[44:47], v[164:167], v[20:23], v[44:47]
  buffer_load_dwordx4 v1, s[4:7], s33 offen offset:512 sc1 lds
  s_waitcnt lgkmcnt(3)
  v_mfma_f32_16x16x32_bf16 v[32:35], v[168:171], v[24:27], v[32:35]
  ds_read_b128 v[16:19], v3 offset:3072
  v_mfma_f32_16x16x32_bf16 v[36:39], v[172:175], v[24:27], v[36:39]
  ds_read_b128 v[20:23], v3 offset:19456
  s_waitcnt lgkmcnt(4)
  v_mfma_f32_16x16x32_bf16 v[40:43], v[168:171], v[28:31], v[40:43]
  s_add_u32 m0, s37, 4480
  v_mfma_f32_16x16x32_bf16 v[44:47], v[172:175], v[28:31], v[44:47]
  buffer_load_dwordx4 v1, s[4:7], s33 offen offset:640 sc1 lds
  s_waitcnt lgkmcnt(3)
  v_mfma_f32_16x16x32_bf16 v[32:35], v[176:179], v[8:11], v[32:35]
  ds_read_b128 v[24:27], v2 offset:4096
  v_mfma_f32_16x16x32_bf16 v[36:39], v[180:183], v[8:11], v[36:39]
  ds_read_b128 v[28:31], v2 offset:20480
  s_waitcnt lgkmcnt(4)
  v_mfma_f32_16x16x32_bf16 v[40:43], v[176:179], v[12:15], v[40:43]
  s_add_u32 m0, s37, 5376
  v_mfma_f32_16x16x32_bf16 v[44:47], v[180:183], v[12:15], v[44:47]
  buffer_load_dwordx4 v1, s[4:7], s33 offen offset:768 sc1 lds
  s_waitcnt lgkmcnt(3)
  v_mfma_f32_16x16x32_bf16 v[32:35], v[184:187], v[16:19], v[32:35]
  ds_read_b128 v[8:11], v3 offset:4096
  v_mfma_f32_16x16x32_bf16 v[36:39], v[188:191], v[16:19], v[36:39]
  ds_read_b128 v[12:15], v3 offset:20480
  s_waitcnt lgkmcnt(4)
  v_mfma_f32_16x16x32_bf16 v[40:43], v[184:187], v[20:23], v[40:43]
  s_add_u32 m0, s37, 6272
  v_mfma_f32_16x16x32_bf16 v[44:47], v[188:191], v[20:23], v[44:47]
  buffer_load_dwordx4 v1, s[4:7], s33 offen offset:896 sc1 lds
  s_waitcnt lgkmcnt(3)
  v_mfma_f32_16x16x32_bf16 v[32:35], v[192:195], v[24:27], v[32:35]
  ds_read_b128 v[16:19], v2 offset:5120
  v_mfma_f32_16x16x32_bf16 v[36:39], v[196:199], v[24:27], v[36:39]
  ds_read_b128 v[20:23], v2 offset:21504
  s_waitcnt lgkmcnt(4)
  v_mfma_f32_16x16x32_bf16 v[40:43], v[192:195], v[28:31], v[40:43]
  v_mfma_f32_16x16x32_bf16 v[44:47], v[196:199], v[28:31], v[44:47]
  s_waitcnt lgkmcnt(3)
  v_mfma_f32_16x16x32_bf16 v[32:35], v[200:203], v[8:11], v[32:35]
  ds_read_b128 v[24:27], v3 offset:5120
  v_mfma_f32_16x16x32_bf16 v[36:39], v[204:207], v[8:11], v[36:39]
  ds_read_b128 v[28:31], v3 offset:21504
  s_waitcnt lgkmcnt(4)
  v_mfma_f32_16x16x32_bf16 v[40:43], v[200:203], v[12:15], v[40:43]
  v_mfma_f32_16x16x32_bf16 v[44:47], v[204:207], v[12:15], v[44:47]
  s_waitcnt lgkmcnt(3)
  v_mfma_f32_16x16x32_bf16 v[32:35], v[208:211], v[16:19], v[32:35]
  ds_read_b128 v[8:11], v2 offset:6144
  v_mfma_f32_16x16x32_bf16 v[36:39], v[212:215], v[16:19], v[36:39]
  ds_read_b128 v[12:15], v2 offset:22528
  s_waitcnt lgkmcnt(4)
  v_mfma_f32_16x16x32_bf16 v[40:43], v[208:211], v[20:23], v[40:43]
  v_mfma_f32_16x16x32_bf16 v[44:47], v[212:215], v[20:23], v[44:47]
  s_waitcnt lgkmcnt(3)
  v_mfma_f32_16x16x32_bf16 v[32:35], v[216:219], v[24:27], v[32:35]
  ds_read_b128 v[16:19], v3 offset:6144
  v_mfma_f32_16x16x32_bf16 v[36:39], v[220:223], v[24:27], v[36:39]
  ds_read_b128 v[20:23], v3 offset:22528
  s_waitcnt lgkmcnt(4)
  v_mfma_f32_16x16x32_bf16 v[40:43], v[216:219], v[28:31], v[40:43]
  v_mfma_f32_16x16x32_bf16 v[44:47], v[220:223], v[28:31], v[44:47]
  s_waitcnt lgkmcnt(3)
  v_mfma_f32_16x16x32_bf16 v[32:35], v[224:227], v[8:11], v[32:35]
  ds_read_b128 v[24:27], v2 offset:7168
  v_mfma_f32_16x16x32_bf16 v[36:39], v[228:231], v[8:11], v[36:39]
  ds_read_b128 v[28:31], v2 offset:23552
  s_waitcnt lgkmcnt(4)
  v_mfma_f32_16x16x32_bf16 v[40:43], v[224:227], v[12:15], v[40:43]
  v_mfma_f32_16x16x32_bf16 v[44:47], v[228:231], v[12:15], v[44:47]
  s_waitcnt lgkmcnt(3)
  v_mfma_f32_16x16x32_bf16 v[32:35], v[232:235], v[16:19], v[32:35]
  ds_read_b128 v[8:11], v3 offset:7168
  v_mfma_f32_16x16x32_bf16 v[36:39], v[236:239], v[16:19], v[36:39]
  ds_read_b128 v[12:15], v3 offset:23552
  s_waitcnt lgkmcnt(4)
  v_mfma_f32_16x16x32_bf16 v[40:43], v[232:235], v[20:23], v[40:43]
  v_mfma_f32_16x16x32_bf16 v[44:47], v[236:239], v[20:23], v[44:47]
  s_waitcnt lgkmcnt(3)
  v_mfma_f32_16x16x32_bf16 v[32:35], v[240:243], v[24:27], v[32:35]
  v_mfma_f32_16x16x32_bf16 v[36:39], v[244:247], v[24:27], v[36:39]
  s_waitcnt lgkmcnt(2)
  v_mfma_f32_16x16x32_bf16 v[40:43], v[240:243], v[28:31], v[40:43]
  v_mfma_f32_16x16x32_bf16 v[44:47], v[244:247], v[28:31], v[44:47]
  s_waitcnt lgkmcnt(1)
  v_mfma_f32_16x16x32_bf16 v[32:35], v[248:251], v[8:11], v[32:35]
  v_mfma_f32_16x16x32_bf16 v[36:39], v[252:255], v[8:11], v[36:39]
  s_waitcnt lgkmcnt(0)
  v_mfma_f32_16x16x32_bf16 v[40:43], v[248:251], v[12:15], v[40:43]
  v_mfma_f32_16x16x32_bf16 v[44:47], v[252:255], v[12:15], v[44:47]
  s_nop 3
  v_cvt_pk_bf16_f32 v64, v32, v33
  v_cvt_pk_bf16_f32 v65, v34, v35
  v_cvt_pk_bf16_f32 v66, v36, v37
  v_cvt_pk_bf16_f32 v67, v38, v39
  buffer_store_dwordx4 v[64:67], v0, s[4:7], s34 offen offset:0
  v_cvt_pk_bf16_f32 v68, v40, v41
  v_cvt_pk_bf16_f32 v69, v42, v43
  v_cvt_pk_bf16_f32 v70, v44, v45
  v_cvt_pk_bf16_f32 v71, v46, v47
  buffer_store_dwordx4 v[68:71], v0, s[4:7], s34 offen offset:1024
  s_add_u32 s34, s34, 57344
  s_add_u32 s16, s16, 1
  s_cmp_ge_u32 s16, s15
  s_cbranch_scc1 L_q_done
  s_waitcnt vmcnt(2)
  s_barrier
  s_add_u32 s33, s33, 229376
  ds_read_b128 v[8:11], v2 offset:32768
  ds_read_b128 v[12:15], v2 offset:49152
  ds_read_b128 v[16:19], v3 offset:32768
  ds_read_b128 v[20:23], v3 offset:49152
  s_waitcnt lgkmcnt(3)
  v_mfma_f32_16x16x32_bf16 v[32:35], v[128:131], v[8:11], 0
  ds_read_b128 v[24:27], v2 offset:33792
  v_mfma_f32_16x16x32_bf16 v[36:39], v[132:135], v[8:11], 0
  ds_read_b128 v[28:31], v2 offset:50176
  s_waitcnt lgkmcnt(4)
  v_mfma_f32_16x16x32_bf16 v[40:43], v[128:131], v[12:15], 0
  s_add_u32 m0, s36, 0
  v_mfma_f32_16x16x32_bf16 v[44:47], v[132:135], v[12:15], 0
  buffer_load_dwordx4 v1, s[4:7], s33 offen offset:0 sc1 lds
  s_waitcnt lgkmcnt(3)
  v_mfma_f32_16x16x32_bf16 v[32:35], v[136:139], v[16:19], v[32:35]
  ds_read_b128 v[8:11], v3 offset:33792
  v_mfma_f32_16x16x32_bf16 v[36:39], v[140:143], v[16:19], v[36:39]
  ds_read_b128 v[12:15], v3 offset:50176
  s_waitcnt lgkmcnt(4)
  v_mfma_f32_16x16x32_bf16 v[40:43], v[136:139], v[20:23], v[40:43]
  s_add_u32 m0, s36, 896
  v_mfma_f32_16x16x32_bf16 v[44:47], v[140:143], v[20:23], v[44:47]
  buffer_load_dwordx4 v1, s[4:7], s33 offen offset:128 sc1 lds
  s_waitcnt lgkmcnt(3)
  v_mfma_f32_16x16x32_bf16 v[32:35], v[144:147], v[24:27], v[32:35]
  ds_read_b128 v[16:19], v2 offset:34816
  v_mfma_f32_16x16x32_bf16 v[36:39], v[148:151], v[24:27], v[36:39]
  ds_read_b128 v[20:23], v2 offset:51200
  s_waitcnt lgkmcnt(4)
  v_mfma_f32_16x16x32_bf16 v[40:43], v[144:147], v[28:31], v[40:43]
  s_add_u32 m0, s36, 1792
  v_mfma_f32_16x16x32_bf16 v[44:47], v[148:151], v[28:31], v[44:47]
  buffer_load_dwordx4 v1, s[4:7], s33 offen offset:256 sc1 lds
  s_waitcnt lgkmcnt(3)
  v_mfma_f32_16x16x32_bf16 v[32:35], v[152:155], v[8:11], v[32:35]
  ds_read_b128 v[24:27], v3 offset:34816
  v_mfma_f32_16x16x32_bf16 v[36:39], v[156:159], v[8:11], v[36:39]
  ds_read_b128 v[28:31], v3 offset:51200
  s_waitcnt lgkmcnt(4)
  v_mfma_f32_16x16x32_bf16 v[40:43], v[152:155], v[12:15], v[40:43]
  s_add_u32 m0, s36, 2688
  v_mfma_f32_16x16x32_bf16 v[44:47], v[156:159], v[12:15], v[44:47]
  buffer_load_dwordx4 v1, s[4:7], s33 offen offset:384 sc1 lds
  s_waitcnt lgkmcnt(3)
  v_mfma_f32_16x16x32_bf16 v[32:35], v[160:163], v[16:19], v[32:35]
  ds_read_b128 v[8:11], v2 offset:35840
  v_mfma_f32_16x16x32_bf16 v[36:39], v[164:167], v[16:19], v[36:39]
  ds_read_b128 v[12:15], v2 offset:52224
  s_waitcnt lgkmcnt(4)
  v_mfma_f32_16x16x32_bf16 v[40:43], v[160:163], v[20:23], v[40:43]
  s_add_u32 m0, s36, 3584
  v_mfma_f32_16x16x32_bf16 v[44:47], v[164:167], v[20:23], v[44:47]
  buffer_load_dwordx4 v1, s[4:7], s33 offen offset:512 sc1 lds
  s_waitcnt lgkmcnt(3)
  v_mfma_f32_16x16x32_bf16 v[32:35], v[168:171], v[24:27], v[32:35]
  ds_read_b128 v[16:19], v3 offset:35840
  v_mfma_f32_16x16x32_bf16 v[36:39], v[172:175], v[24:27], v[36:39]
  ds_read_b128 v[20:23], v3 offset:52224
  s_waitcnt lgkmcnt(4)
  v_mfma_f32_16x16x32_bf16 v[40:43], v[168:171], v[28:31], v[40:43]
  s_add_u32 m0, s36, 4480
  v_mfma_f32_16x16x32_bf16 v[44:47], v[172:175], v[28:31], v[44:47]
  buffer_load_dwordx4 v1, s[4:7], s33 offen offset:640 sc1 lds
  s_waitcnt lgkmcnt(3)
  v_mfma_f32_16x16x32_bf16 v[32:35], v[176:179], v[8:11], v[32:35]
  ds_read_b128 v[24:27], v2 offset:36864
  v_mfma_f32_16x16x32_bf16 v[36:39], v[180:183], v[8:11], v[36:39]
  ds_read_b128 v[28:31], v2 offset:53248
  s_waitcnt lgkmcnt(4)
  v_mfma_f32_16x16x32_bf16 v[40:43], v[176:179], v[12:15], v[40:43]
  s_add_u32 m0, s36, 5376
  v_mfma_f32_16x16x32_bf16 v[44:47], v[180:183], v[12:15], v[44:47]
  buffer_load_dwordx4 v1, s[4:7], s33 offen offset:768 sc1 lds
  s_waitcnt lgkmcnt(3)
  v_mfma_f32_16x16x32_bf16 v[32:35], v[184:187], v[16:19], v[32:35]
  ds_read_b128 v[8:11], v3 offset:36864
  v_mfma_f32_16x16x32_bf16 v[36:39], v[188:191], v[16:19], v[36:39]
  ds_read_b128 v[12:15], v3 offset:53248
  s_waitcnt lgkmcnt(4)
  v_mfma_f32_16x16x32_bf16 v[40:43], v[184:187], v[20:23], v[40:43]
  s_add_u32 m0, s36, 6272
  v_mfma_f32_16x16x32_bf16 v[44:47], v[188:191], v[20:23], v[44:47]
  buffer_load_dwordx4 v1, s[4:7], s33 offen offset:896 sc1 lds
  s_waitcnt lgkmcnt(3)
  v_mfma_f32_16x16x32_bf16 v[32:35], v[192:195], v[24:27], v[32:35]
  ds_read_b128 v[16:19], v2 offset:37888
  v_mfma_f32_16x16x32_bf16 v[36:39], v[196:199], v[24:27], v[36:39]
  ds_read_b128 v[20:23], v2 offset:54272
  s_waitcnt lgkmcnt(4)
  v_mfma_f32_16x16x32_bf16 v[40:43], v[192:195], v[28:31], v[40:43]
  v_mfma_f32_16x16x32_bf16 v[44:47], v[196:199], v[28:31], v[44:47]
  s_waitcnt lgkmcnt(3)
  v_mfma_f32_16x16x32_bf16 v[32:35], v[200:203], v[8:11], v[32:35]
  ds_read_b128 v[24:27], v3 offset:37888
  v_mfma_f32_16x16x32_bf16 v[36:39], v[204:207], v[8:11], v[36:39]
  ds_read_b128 v[28:31], v3 offset:54272
  s_waitcnt lgkmcnt(4)
  v_mfma_f32_16x16x32_bf16 v[40:43], v[200:203], v[12:15], v[40:43]
  v_mfma_f32_16x16x32_bf16 v[44:47], v[204:207], v[12:15], v[44:47]
  s_waitcnt lgkmcnt(3)
  v_mfma_f32_16x16x32_bf16 v[32:35], v[208:211], v[16:19], v[32:35]
  ds_read_b128 v[8:11], v2 offset:38912
  v_mfma_f32_16x16x32_bf16 v[36:39], v[212:215], v[16:19], v[36:39]
  ds_read_b128 v[12:15], v2 offset:55296
  s_waitcnt lgkmcnt(4)
  v_mfma_f32_16x16x32_bf16 v[40:43], v[208:211], v[20:23], v[40:43]
  v_mfma_f32_16x16x32_bf16 v[44:47], v[212:215], v[20:23], v[44:47]
  s_waitcnt lgkmcnt(3)
  v_mfma_f32_16x16x32_bf16 v[32:35], v[216:219], v[24:27], v[32:35]
  ds_read_b128 v[16:19], v3 offset:38912
  v_mfma_f32_16x16x32_bf16 v[36:39], v[220:223], v[24:27], v[36:39]
  ds_read_b128 v[20:23], v3 offset:55296
  s_waitcnt lgkmcnt(4)
  v_mfma_f32_16x16x32_bf16 v[40:43], v[216:219], v[28:31], v[40:43]
  v_mfma_f32_16x16x32_bf16 v[44:47], v[220:223], v[28:31], v[44:47]
  s_waitcnt lgkmcnt(3)
  v_mfma_f32_16x16x32_bf16 v[32:35], v[224:227], v[8:11], v[32:35]
  ds_read_b128 v[24:27], v2 offset:39936
  v_mfma_f32_16x16x32_bf16 v[36:39], v[228:231], v[8:11], v[36:39]
  ds_read_b128 v[28:31], v2 offset:56320
  s_waitcnt lgkmcnt(4)
  v_mfma_f32_16x16x32_bf16 v[40:43], v[224:227], v[12:15], v[40:43]
  v_mfma_f32_16x16x32_bf16 v[44:47], v[228:231], v[12:15], v[44:47]
  s_waitcnt lgkmcnt(3)
  v_mfma_f32_16x16x32_bf16 v[32:35], v[232:235], v[16:19], v[32:35]
  ds_read_b128 v[8:11], v3 offset:39936
  v_mfma_f32_16x16x32_bf16 v[36:39], v[236:239], v[16:19], v[36:39]
  ds_read_b128 v[12:15], v3 offset:56320
  s_waitcnt lgkmcnt(4)
  v_mfma_f32_16x16x32_bf16 v[40:43], v[232:235], v[20:23], v[40:43]
  v_mfma_f32_16x16x32_bf16 v[44:47], v[236:239], v[20:23], v[44:47]
  s_waitcnt lgkmcnt(3)
  v_mfma_f32_16x16x32_bf16 v[32:35], v[240:243], v[24:27], v[32:35]
  v_mfma_f32_16x16x32_bf16 v[36:39], v[244:247], v[24:27], v[36:39]
  s_waitcnt lgkmcnt(2)
  v_mfma_f32_16x16x32_bf16 v[40:43], v[240:243], v[28:31], v[40:43]
  v_mfma_f32_16x16x32_bf16 v[44:47], v[244:247], v[28:31], v[44:47]
  s_waitcnt lgkmcnt(1)
  v_mfma_f32_16x16x32_bf16 v[32:35], v[248:251], v[8:11], v[32:35]
  v_mfma_f32_16x16x32_bf16 v[36:39], v[252:255], v[8:11], v[36:39]
  s_waitcnt lgkmcnt(0)
  v_mfma_f32_16x16x32_bf16 v[40:43], v[248:251], v[12:15], v[40:43]
  v_mfma_f32_16x16x32_bf16 v[44:47], v[252:255], v[12:15], v[44:47]
  s_nop 3
  v_cvt_pk_bf16_f32 v64, v32, v33
  v_cvt_pk_bf16_f32 v65, v34, v35
  v_cvt_pk_bf16_f32 v66, v36, v37
  v_cvt_pk_bf16_f32 v67, v38, v39
  buffer_store_dwordx4 v[64:67], v0, s[4:7], s34 offen offset:0
  v_cvt_pk_bf16_f32 v68, v40, v41
  v_cvt_pk_bf16_f32 v69, v42, v43
  v_cvt_pk_bf16_f32 v70, v44, v45
  v_cvt_pk_bf16_f32 v71, v46, v47
  buffer_store_dwordx4 v[68:71], v0, s[4:7], s34 offen offset:1024
  s_add_u32 s34, s34, 57344
  s_add_u32 s16, s16, 1
  s_cmp_ge_u32 s16, s15
  s_cbranch_scc0 L_q_top
L_q_done:
  s_waitcnt vmcnt(0)
  v_lshrrev_b32 v29, 8, v0
  v_and_b32 v30, 0xf0, v0
  v_lshlrev_b32 v28, 12, v29
  v_add_u32 v28, v28, v30
  v_lshlrev_b32 v27, 12, v29
  v_add_u32 v27, v27, v30
  s_lshl_b32 s19, s13, 8
  s_lshl_b32 s18, s12, 17
  s_add_u32 s18, s18, s19
  v_add_u32 v28, s18, v28
  s_lshl_b32 s18, s12, 16
  s_add_u32 s18, s18, s19
  v_add_u32 v27, s18, v27
  s_mov_b32 s18, 0
  buffer_load_dwordx4 v[32:35], v28, s[56:59], s18 offen
  s_mov_b32 s18, 16384
  buffer_load_dwordx4 v[36:39], v28, s[56:59], s18 offen
  v_lshrrev_b32 v24, 4, v0
  v_lshrrev_b32 v29, 3, v24
  v_mul_u32_u24 v26, 3584, v29
  v_and_b32 v30, 6, v29
  v_xor_b32 v30, v30, v24
  v_and_b32 v30, 7, v30
  v_lshlrev_b32 v30, 4, v30
  v_add_u32 v26, v26, v30
  s_lshl_b32 s18, s12, 7
  s_mul_i32 s19, s13, 28672
  s_add_u32 s18, s18, s19
  v_add_u32 v26, s18, v26
  v_mov_b32 v30, 0x40000000
  s_cmp_lt_u32 s12, 28
  s_cselect_b64 vcc, -1, 0
  v_cndmask_b32 v26, v30, v26, vcc
  s_mul_i32 s35, s13, 32832
  v_lshrrev_b32 v29, 4, v24
  v_mul_u32_u24 v29, 32832, v29
  v_bfe_u32 v30, v24, 2, 2
  v_lshlrev_b32 v30, 7, v30
  v_add_u32 v29, v29, v30
  v_and_b32 v30, 3, v24
  v_lshlrev_b32 v30, 3, v30
  v_add_u32 v29, v29, v30
  v_bfe_u32 v30, v24, 3, 1
  v_xor_b32 v30, s13, v30
  v_lshlrev_b32 v23, 5, v30
  v_add_u32 v25, v29, v23
  v_xor_b32 v23, 64, v23
  v_add_u32 v23, v29, v23
  s_barrier
  s_mov_b32 s18, 0
  s_add_u32 m0, s35, 0
  s_nop 0
  buffer_load_dwordx4 v26, s[60:63], s18 offen lds
  s_mov_b32 s18, 0
  s_add_u32 m0, s35, 1024
  s_nop 0
  buffer_load_dwordx4 v26, s[64:67], s18 offen lds
  s_waitcnt vmcnt(1)
  s_waitcnt lgkmcnt(0)
  s_barrier
  ds_read_b64_tr_b16 a[128:129], v25 offset:0
  ds_read_b64_tr_b16 a[130:131], v23 offset:512
  s_waitcnt vmcnt(0)
  s_waitcnt lgkmcnt(0)
  s_barrier
  s_mov_b32 s18, 114688
  s_add_u32 m0, s35, 0
  s_nop 0
  buffer_load_dwordx4 v26, s[60:63], s18 offen lds
  ds_read_b64_tr_b16 a[192:193], v25 offset:1024
  ds_read_b64_tr_b16 a[194:195], v23 offset:1536
  v_perm_b32 v176, v36, v32, s40
  v_accvgpr_write_b32 a0, v176
  v_perm_b32 v177, v36, v32, s41
  v_accvgpr_write_b32 a4, v177
  v_perm_b32 v178, v37, v33, s40
  v_accvgpr_write_b32 a8, v178
  v_perm_b32 v179, v37, v33, s41
  v_accvgpr_write_b32 a12, v179
  v_perm_b32 v176, v38, v34, s40
  v_accvgpr_write_b32 a16, v176
  v_perm_b32 v177, v38, v34, s41
  v_accvgpr_write_b32 a20, v177
  v_perm_b32 v178, v39, v35, s40
  v_accvgpr_write_b32 a24, v178
  v_perm_b32 v179, v39, v35, s41
  v_accvgpr_write_b32 a28, v179
  s_mov_b32 s18, 1024
  buffer_load_dwordx4 v[40:43], v28, s[56:59], s18 offen
  s_mov_b32 s18, 17408
  buffer_load_dwordx4 v[44:47], v28, s[56:59], s18 offen
  s_waitcnt vmcnt(2)
  s_waitcnt lgkmcnt(0)
  s_barrier
  s_mov_b32 s18, 114688
  s_add_u32 m0, s35, 1024
  s_nop 0
  buffer_load_dwordx4 v26, s[64:67], s18 offen lds
  ds_read_b64_tr_b16 a[132:133], v25 offset:0
  ds_read_b64_tr_b16 a[134:135], v23 offset:512
  s_waitcnt vmcnt(1)
  v_perm_b32 v176, v44, v40, s40
  v_accvgpr_write_b32 a1, v176
  v_perm_b32 v177, v44, v40, s41
  v_accvgpr_write_b32 a5, v177
  v_perm_b32 v178, v45, v41, s40
  v_accvgpr_write_b32 a9, v178
  v_perm_b32 v179, v45, v41, s41
  v_accvgpr_write_b32 a13, v179
  v_perm_b32 v176, v46, v42, s40
  v_accvgpr_write_b32 a17, v176
  v_perm_b32 v177, v46, v42, s41
  v_accvgpr_write_b32 a21, v177
  v_perm_b32 v178, v47, v43, s40
  v_accvgpr_write_b32 a25, v178
  v_perm_b32 v179, v47, v43, s41
  v_accvgpr_write_b32 a29, v179
  s_mov_b32 s18, 2048
  buffer_load_dwordx4 v[48:51], v28, s[56:59], s18 offen
  s_mov_b32 s18, 18432
  buffer_load_dwordx4 v[52:55], v28, s[56:59], s18 offen
  s_waitcnt vmcnt(2)
  s_waitcnt lgkmcnt(0)
  s_barrier
  s_mov_b32 s18, 229376
  s_add_u32 m0, s35, 0
  s_nop 0
  buffer_load_dwordx4 v26, s[60:63], s18 offen lds
  ds_read_b64_tr_b16 a[196:197], v25 offset:1024
  ds_read_b64_tr_b16 a[198:199], v23 offset:1536
  s_waitcnt vmcnt(1)
  v_perm_b32 v176, v52, v48, s40
  v_accvgpr_write_b32 a2, v176
  v_perm_b32 v177, v52, v48, s41
  v_accvgpr_write_b32 a6, v177
  v_perm_b32 v178, v53, v49, s40
  v_accvgpr_write_b32 a10, v178
  v_perm_b32 v179, v53, v49, s41
  v_accvgpr_write_b32 a14, v179
  v_perm_b32 v176, v54, v50, s40
  v_accvgpr_write_b32 a18, v176
  v_perm_b32 v177, v54, v50, s41
  v_accvgpr_write_b32 a22, v177
  v_perm_b32 v178, v55, v51, s40
  v_accvgpr_write_b32 a26, v178
  v_perm_b32 v179, v55, v51, s41
  v_accvgpr_write_b32 a30, v179
  s_mov_b32 s18, 3072
  buffer_load_dwordx4 v[56:59], v28, s[56:59], s18 offen
  s_mov_b32 s18, 19456
  buffer_load_dwordx4 v[60:63], v28, s[56:59], s18 offen
  s_waitcnt vmcnt(2)
  s_waitcnt lgkmcnt(0)
  s_barrier
  s_mov_b32 s18, 229376
  s_add_u32 m0, s35, 1024
  s_nop 0
  buffer_load_dwordx4 v26, s[64:67], s18 offen lds
  ds_read_b64_tr_b16 a[136:137], v25 offset:0
  ds_read_b64_tr_b16 a[138:139], v23 offset:512
  s_waitcnt vmcnt(0)
  s_waitcnt lgkmcnt(0)
  s_barrier
  s_mov_b32 s18, 344064
  s_add_u32 m0, s35, 0
  s_nop 0
  buffer_load_dwordx4 v26, s[60:63], s18 offen lds
  ds_read_b64_tr_b16 a[200:201], v25 offset:1024
  ds_read_b64_tr_b16 a[202:203], v23 offset:1536
  v_perm_b32 v176, v60, v56, s40
  v_accvgpr_write_b32 a3, v176
  v_perm_b32 v177, v60, v56, s41
  v_accvgpr_write_b32 a7, v177
  v_perm_b32 v178, v61, v57, s40
  v_accvgpr_write_b32 a11, v178
  v_perm_b32 v179, v61, v57, s41
  v_accvgpr_write_b32 a15, v179
  v_perm_b32 v176, v62, v58, s40
  v_accvgpr_write_b32 a19, v176
  v_perm_b32 v177, v62, v58, s41
  v_accvgpr_write_b32 a23, v177
  v_perm_b32 v178, v63, v59, s40
  v_accvgpr_write_b32 a27, v178
  v_perm_b32 v179, v63, v59, s41
  v_accvgpr_write_b32 a31, v179
  s_mov_b32 s18, 32768
  buffer_load_dwordx4 v[64:67], v28, s[56:59], s18 offen
  s_mov_b32 s18, 49152
  buffer_load_dwordx4 v[68:71], v28, s[56:59], s18 offen
  s_waitcnt vmcnt(2)
  s_waitcnt lgkmcnt(0)
  s_barrier
  s_mov_b32 s18, 344064
  s_add_u32 m0, s35, 1024
  s_nop 0
  buffer_load_dwordx4 v26, s[64:67], s18 offen lds
  ds_read_b64_tr_b16 a[140:141], v25 offset:0
  ds_read_b64_tr_b16 a[142:143], v23 offset:512
  s_waitcnt vmcnt(1)
  v_perm_b32 v176, v68, v64, s40
  v_accvgpr_write_b32 a32, v176
  v_perm_b32 v177, v68, v64, s41
  v_accvgpr_write_b32 a36, v177
  v_perm_b32 v178, v69, v65, s40
  v_accvgpr_write_b32 a40, v178
  v_perm_b32 v179, v69, v65, s41
  v_accvgpr_write_b32 a44, v179
  v_perm_b32 v176, v70, v66, s40
  v_accvgpr_write_b32 a48, v176
  v_perm_b32 v177, v70, v66, s41
  v_accvgpr_write_b32 a52, v177
  v_perm_b32 v178, v71, v67, s40
  v_accvgpr_write_b32 a56, v178
  v_perm_b32 v179, v71, v67, s41
  v_accvgpr_write_b32 a60, v179
  s_mov_b32 s18, 33792
  buffer_load_dwordx4 v[72:75], v28, s[56:59], s18 offen
  s_mov_b32 s18, 50176
  buffer_load_dwordx4 v[76:79], v28, s[56:59], s18 offen
  s_waitcnt vmcnt(2)
  s_waitcnt lgkmcnt(0)
  s_barrier
  s_mov_b32 s18, 458752
  s_add_u32 m0, s35, 0
  s_nop 0
  buffer_load_dwordx4 v26, s[60:63], s18 offen lds
  ds_read_b64_tr_b16 a[204:205], v25 offset:1024
  ds_read_b64_tr_b16 a[206:207], v23 offset:1536
  s_waitcnt vmcnt(1)
  v_perm_b32 v176, v76, v72, s40
  v_accvgpr_write_b32 a33, v176
  v_perm_b32 v177, v76, v72, s41
  v_accvgpr_write_b32 a37, v177
  v_perm_b32 v178, v77, v73, s40
  v_accvgpr_write_b32 a41, v178
  v_perm_b32 v179, v77, v73, s41
  v_accvgpr_write_b32 a45, v179
  v_perm_b32 v176, v78, v74, s40
  v_accvgpr_write_b32 a49, v176
  v_perm_b32 v177, v78, v74, s41
  v_accvgpr_write_b32 a53, v177
  v_perm_b32 v178, v79, v75, s40
  v_accvgpr_write_b32 a57, v178
  v_perm_b32 v179, v79, v75, s41
  v_accvgpr_write_b32 a61, v179
  s_mov_b32 s18, 34816
  buffer_load_dwordx4 v[80:83], v28, s[56:59], s18 offen
  s_mov_b32 s18, 51200
  buffer_load_dwordx4 v[84:87], v28, s[56:59], s18 offen
  s_waitcnt vmcnt(2)
  s_waitcnt lgkmcnt(0)
  s_barrier
  s_mov_b32 s18, 458752
  s_add_u32 m0, s35, 1024
  s_nop 0
  buffer_load_dwordx4 v26, s[64:67], s18 offen lds
  ds_read_b64_tr_b16 a[144:145], v25 offset:0
  ds_read_b64_tr_b16 a[146:147], v23 offset:512
  s_waitcnt vmcnt(0)
  s_waitcnt lgkmcnt(0)
  s_barrier
  s_mov_b32 s18, 573440
  s_add_u32 m0, s35, 0
  s_nop 0
  buffer_load_dwordx4 v26, s[60:63], s18 offen lds
  ds_read_b64_tr_b16 a[208:209], v25 offset:1024
  ds_read_b64_tr_b16 a[210:211], v23 offset:1536
  v_perm_b32 v176, v84, v80, s40
  v_accvgpr_write_b32 a34, v176
  v_perm_b32 v177, v84, v80, s41
  v_accvgpr_write_b32 a38, v177
  v_perm_b32 v178, v85, v81, s40
  v_accvgpr_write_b32 a42, v178
  v_perm_b32 v179, v85, v81, s41
  v_accvgpr_write_b32 a46, v179
  v_perm_b32 v176, v86, v82, s40
  v_accvgpr_write_b32 a50, v176
  v_perm_b32 v177, v86, v82, s41
  v_accvgpr_write_b32 a54, v177
  v_perm_b32 v178, v87, v83, s40
  v_accvgpr_write_b32 a58, v178
  v_perm_b32 v179, v87, v83, s41
  v_accvgpr_write_b32 a62, v179
  s_mov_b32 s18, 35840
  buffer_load_dwordx4 v[88:91], v28, s[56:59], s18 offen
  s_mov_b32 s18, 52224
  buffer_load_dwordx4 v[92:95], v28, s[56:59], s18 offen
  s_waitcnt vmcnt(2)
  s_waitcnt lgkmcnt(0)
  s_barrier
  s_mov_b32 s18, 573440
  s_add_u32 m0, s35, 1024
  s_nop 0
  buffer_load_dwordx4 v26, s[64:67], s18 offen lds
  ds_read_b64_tr_b16 a[148:149], v25 offset:0
  ds_read_b64_tr_b16 a[150:151], v23 offset:512
  s_waitcnt vmcnt(1)
  v_perm_b32 v176, v92, v88, s40
  v_accvgpr_write_b32 a35, v176
  v_perm_b32 v177, v92, v88, s41
  v_accvgpr_write_b32 a39, v177
  v_perm_b32 v178, v93, v89, s40
  v_accvgpr_write_b32 a43, v178
  v_perm_b32 v179, v93, v89, s41
  v_accvgpr_write_b32 a47, v179
  v_perm_b32 v176, v94, v90, s40
  v_accvgpr_write_b32 a51, v176
  v_perm_b32 v177, v94, v90, s41
  v_accvgpr_write_b32 a55, v177
  v_perm_b32 v178, v95, v91, s40
  v_accvgpr_write_b32 a59, v178
  v_perm_b32 v179, v95, v91, s41
  v_accvgpr_write_b32 a63, v179
  s_mov_b32 s18, 65536
  buffer_load_dwordx4 v[96:99], v28, s[56:59], s18 offen
  s_mov_b32 s18, 81920
  buffer_load_dwordx4 v[100:103], v28, s[56:59], s18 offen
  s_waitcnt vmcnt(2)
  s_waitcnt lgkmcnt(0)
  s_barrier
  s_mov_b32 s18, 688128
  s_add_u32 m0, s35, 0
  s_nop 0
  buffer_load_dwordx4 v26, s[60:63], s18 offen lds
  ds_read_b64_tr_b16 a[212:213], v25 offset:1024
  ds_read_b64_tr_b16 a[214:215], v23 offset:1536
  s_waitcnt vmcnt(1)
  v_perm_b32 v176, v100, v96, s40
  v_accvgpr_write_b32 a64, v176
  v_perm_b32 v177, v100, v96, s41
  v_accvgpr_write_b32 a68, v177
  v_perm_b32 v178, v101, v97, s40
  v_accvgpr_write_b32 a72, v178
  v_perm_b32 v179, v101, v97, s41
  v_accvgpr_write_b32 a76, v179
  v_perm_b32 v176, v102, v98, s40
  v_accvgpr_write_b32 a80, v176
  v_perm_b32 v177, v102, v98, s41
  v_accvgpr_write_b32 a84, v177
  v_perm_b32 v178, v103, v99, s40
  v_accvgpr_write_b32 a88, v178
  v_perm_b32 v179, v103, v99, s41
  v_accvgpr_write_b32 a92, v179
  s_mov_b32 s18, 66560
  buffer_load_dwordx4 v[104:107], v28, s[56:59], s18 offen
  s_mov_b32 s18, 82944
  buffer_load_dwordx4 v[108:111], v28, s[56:59], s18 offen
  s_waitcnt vmcnt(2)
  s_waitcnt lgkmcnt(0)
  s_barrier
  s_mov_b32 s18, 688128
  s_add_u32 m0, s35, 1024
  s_nop 0
  buffer_load_dwordx4 v26, s[64:67], s18 offen lds
  ds_read_b64_tr_b16 a[152:153], v25 offset:0
  ds_read_b64_tr_b16 a[154:155], v23 offset:512
  s_waitcnt vmcnt(0)
  s_waitcnt lgkmcnt(0)
  s_barrier
  s_mov_b32 s18, 802816
  s_add_u32 m0, s35, 0
  s_nop 0
  buffer_load_dwordx4 v26, s[60:63], s18 offen lds
  ds_read_b64_tr_b16 a[216:217], v25 offset:1024
  ds_read_b64_tr_b16 a[218:219], v23 offset:1536
  v_perm_b32 v176, v108, v104, s40
  v_accvgpr_write_b32 a65, v176
  v_perm_b32 v177, v108, v104, s41
  v_accvgpr_write_b32 a69, v177
  v_perm_b32 v178, v109, v105, s40
  v_accvgpr_write_b32 a73, v178
  v_perm_b32 v179, v109, v105, s41
  v_accvgpr_write_b32 a77, v179
  v_perm_b32 v176, v110, v106, s40
  v_accvgpr_write_b32 a81, v176
  v_perm_b32 v177, v110, v106, s41
  v_accvgpr_write_b32 a85, v177
  v_perm_b32 v178, v111, v107, s40
  v_accvgpr_write_b32 a89, v178
  v_perm_b32 v179, v111, v107, s41
  v_accvgpr_write_b32 a93, v179
  s_mov_b32 s18, 67584
  buffer_load_dwordx4 v[112:115], v28, s[56:59], s18 offen
  s_mov_b32 s18, 83968
  buffer_load_dwordx4 v[116:119], v28, s[56:59], s18 offen
  s_waitcnt vmcnt(2)
  s_waitcnt lgkmcnt(0)
  s_barrier
  s_mov_b32 s18, 802816
  s_add_u32 m0, s35, 1024
  s_nop 0
  buffer_load_dwordx4 v26, s[64:67], s18 offen lds
  ds_read_b64_tr_b16 a[156:157], v25 offset:0
  ds_read_b64_tr_b16 a[158:159], v23 offset:512
  s_waitcnt vmcnt(1)
  v_perm_b32 v176, v116, v112, s40
  v_accvgpr_write_b32 a66, v176
  v_perm_b32 v177, v116, v112, s41
  v_accvgpr_write_b32 a70, v177
  v_perm_b32 v178, v117, v113, s40
  v_accvgpr_write_b32 a74, v178
  v_perm_b32 v179, v117, v113, s41
  v_accvgpr_write_b32 a78, v179
  v_perm_b32 v176, v118, v114, s40
  v_accvgpr_write_b32 a82, v176
  v_perm_b32 v177, v118, v114, s41
  v_accvgpr_write_b32 a86, v177
  v_perm_b32 v178, v119, v115, s40
  v_accvgpr_write_b32 a90, v178
  v_perm_b32 v179, v119, v115, s41
  v_accvgpr_write_b32 a94, v179
  s_mov_b32 s18, 68608
  buffer_load_dwordx4 v[120:123], v28, s[56:59], s18 offen
  s_mov_b32 s18, 84992
  buffer_load_dwordx4 v[124:127], v28, s[56:59], s18 offen
  s_waitcnt vmcnt(2)
  s_waitcnt lgkmcnt(0)
  s_barrier
  s_mov_b32 s18, 917504
  s_add_u32 m0, s35, 0
  s_nop 0
  buffer_load_dwordx4 v26, s[60:63], s18 offen lds
  ds_read_b64_tr_b16 a[220:221], v25 offset:1024
  ds_read_b64_tr_b16 a[222:223], v23 offset:1536
  s_waitcnt vmcnt(1)
  v_perm_b32 v176, v124, v120, s40
  v_accvgpr_write_b32 a67, v176
  v_perm_b32 v177, v124, v120, s41
  v_accvgpr_write_b32 a71, v177
  v_perm_b32 v178, v125, v121, s40
  v_accvgpr_write_b32 a75, v178
  v_perm_b32 v179, v125, v121, s41
  v_accvgpr_write_b32 a79, v179
  v_perm_b32 v176, v126, v122, s40
  v_accvgpr_write_b32 a83, v176
  v_perm_b32 v177, v126, v122, s41
  v_accvgpr_write_b32 a87, v177
  v_perm_b32 v178, v127, v123, s40
  v_accvgpr_write_b32 a91, v178
  v_perm_b32 v179, v127, v123, s41
  v_accvgpr_write_b32 a95, v179
  s_mov_b32 s18, 98304
  buffer_load_dwordx4 v[128:131], v28, s[56:59], s18 offen
  s_mov_b32 s18, 114688
  buffer_load_dwordx4 v[132:135], v28, s[56:59], s18 offen
  s_waitcnt vmcnt(2)
  s_waitcnt lgkmcnt(0)
  s_barrier
  s_mov_b32 s18, 917504
  s_add_u32 m0, s35, 1024
  s_nop 0
  buffer_load_dwordx4 v26, s[64:67], s18 offen lds
  ds_read_b64_tr_b16 a[160:161], v25 offset:0
  ds_read_b64_tr_b16 a[162:163], v23 offset:512
  s_waitcnt vmcnt(0)
  s_waitcnt lgkmcnt(0)
  s_barrier
  s_mov_b32 s18, 1032192
  s_add_u32 m0, s35, 0
  s_nop 0
  buffer_load_dwordx4 v26, s[60:63], s18 offen lds
  ds_read_b64_tr_b16 a[224:225], v25 offset:1024
  ds_read_b64_tr_b16 a[226:227], v23 offset:1536
  v_perm_b32 v176, v132, v128, s40
  v_accvgpr_write_b32 a96, v176
  v_perm_b32 v177, v132, v128, s41
  v_accvgpr_write_b32 a100, v177
  v_perm_b32 v178, v133, v129, s40
  v_accvgpr_write_b32 a104, v178
  v_perm_b32 v179, v133, v129, s41
  v_accvgpr_write_b32 a108, v179
  v_perm_b32 v176, v134, v130, s40
  v_accvgpr_write_b32 a112, v176
  v_perm_b32 v177, v134, v130, s41
  v_accvgpr_write_b32 a116, v177
  v_perm_b32 v178, v135, v131, s40
  v_accvgpr_write_b32 a120, v178
  v_perm_b32 v179, v135, v131, s41
  v_accvgpr_write_b32 a124, v179
  s_mov_b32 s18, 99328
  buffer_load_dwordx4 v[136:139], v28, s[56:59], s18 offen
  s_mov_b32 s18, 115712
  buffer_load_dwordx4 v[140:143], v28, s[56:59], s18 offen
  s_waitcnt vmcnt(2)
  s_waitcnt lgkmcnt(0)
  s_barrier
  s_mov_b32 s18, 1032192
  s_add_u32 m0, s35, 1024
  s_nop 0
  buffer_load_dwordx4 v26, s[64:67], s18 offen lds
  ds_read_b64_tr_b16 a[164:165], v25 offset:0
  ds_read_b64_tr_b16 a[166:167], v23 offset:512
  s_waitcnt vmcnt(1)
  v_perm_b32 v176, v140, v136, s40
  v_accvgpr_write_b32 a97, v176
  v_perm_b32 v177, v140, v136, s41
  v_accvgpr_write_b32 a101, v177
  v_perm_b32 v178, v141, v137, s40
  v_accvgpr_write_b32 a105, v178
  v_perm_b32 v179, v141, v137, s41
  v_accvgpr_write_b32 a109, v179
  v_perm_b32 v176, v142, v138, s40
  v_accvgpr_write_b32 a113, v176
  v_perm_b32 v177, v142, v138, s41
  v_accvgpr_write_b32 a117, v177
  v_perm_b32 v178, v143, v139, s40
  v_accvgpr_write_b32 a121, v178
  v_perm_b32 v179, v143, v139, s41
  v_accvgpr_write_b32 a125, v179
  s_mov_b32 s18, 100352
  buffer_load_dwordx4 v[144:147], v28, s[56:59], s18 offen
  s_mov_b32 s18, 116736
  buffer_load_dwordx4 v[148:151], v28, s[56:59], s18 offen
  s_waitcnt vmcnt(2)
  s_waitcnt lgkmcnt(0)
  s_barrier
  s_mov_b32 s18, 1146880
  s_add_u32 m0, s35, 0
  s_nop 0
  buffer_load_dwordx4 v26, s[60:63], s18 offen lds
  ds_read_b64_tr_b16 a[228:229], v25 offset:1024
  ds_read_b64_tr_b16 a[230:231], v23 offset:1536
  s_waitcnt vmcnt(1)
  v_perm_b32 v176, v148, v144, s40
  v_accvgpr_write_b32 a98, v176
  v_perm_b32 v177, v148, v144, s41
  v_accvgpr_write_b32 a102, v177
  v_perm_b32 v178, v149, v145, s40
  v_accvgpr_write_b32 a106, v178
  v_perm_b32 v179, v149, v145, s41
  v_accvgpr_write_b32 a110, v179
  v_perm_b32 v176, v150, v146, s40
  v_accvgpr_write_b32 a114, v176
  v_perm_b32 v177, v150, v146, s41
  v_accvgpr_write_b32 a118, v177
  v_perm_b32 v178, v151, v147, s40
  v_accvgpr_write_b32 a122, v178
  v_perm_b32 v179, v151, v147, s41
  v_accvgpr_write_b32 a126, v179
  s_mov_b32 s18, 101376
  buffer_load_dwordx4 v[152:155], v28, s[56:59], s18 offen
  s_mov_b32 s18, 117760
  buffer_load_dwordx4 v[156:159], v28, s[56:59], s18 offen
  s_waitcnt vmcnt(2)
  s_waitcnt lgkmcnt(0)
  s_barrier
  s_mov_b32 s18, 1146880
  s_add_u32 m0, s35, 1024
  s_nop 0
  buffer_load_dwordx4 v26, s[64:67], s18 offen lds
  ds_read_b64_tr_b16 a[168:169], v25 offset:0
  ds_read_b64_tr_b16 a[170:171], v23 offset:512
  s_waitcnt vmcnt(0)
  s_waitcnt lgkmcnt(0)
  s_barrier
  s_mov_b32 s18, 1261568
  s_add_u32 m0, s35, 0
  s_nop 0
  buffer_load_dwordx4 v26, s[60:63], s18 offen lds
  ds_read_b64_tr_b16 a[232:233], v25 offset:1024
  ds_read_b64_tr_b16 a[234:235], v23 offset:1536
  v_perm_b32 v176, v156, v152, s40
  v_accvgpr_write_b32 a99, v176
  v_perm_b32 v177, v156, v152, s41
  v_accvgpr_write_b32 a103, v177
  v_perm_b32 v178, v157, v153, s40
  v_accvgpr_write_b32 a107, v178
  v_perm_b32 v179, v157, v153, s41
  v_accvgpr_write_b32 a111, v179
  v_perm_b32 v176, v158, v154, s40
  v_accvgpr_write_b32 a115, v176
  v_perm_b32 v177, v158, v154, s41
  v_accvgpr_write_b32 a119, v177
  v_perm_b32 v178, v159, v155, s40
  v_accvgpr_write_b32 a123, v178
  v_perm_b32 v179, v159, v155, s41
  v_accvgpr_write_b32 a127, v179
  s_mov_b32 s18, 0
  buffer_load_dwordx4 v[32:35], v27, s[68:71], s18 offen
  s_mov_b32 s18, 1024
  buffer_load_dwordx4 v[36:39], v27, s[68:71], s18 offen
  s_waitcnt vmcnt(2)
  s_waitcnt lgkmcnt(0)
  s_barrier
  s_mov_b32 s18, 1261568
  s_add_u32 m0, s35, 1024
  s_nop 0
  buffer_load_dwordx4 v26, s[64:67], s18 offen lds
  ds_read_b64_tr_b16 a[172:173], v25 offset:0
  ds_read_b64_tr_b16 a[174:175], v23 offset:512
  s_waitcnt vmcnt(1)
  v_perm_b32 v192, v36, v32, s40
  v_perm_b32 v196, v36, v32, s41
  v_perm_b32 v200, v37, v33, s40
  v_perm_b32 v204, v37, v33, s41
  v_perm_b32 v208, v38, v34, s40
  v_perm_b32 v212, v38, v34, s41
  v_perm_b32 v216, v39, v35, s40
  v_perm_b32 v220, v39, v35, s41
  s_mov_b32 s18, 2048
  buffer_load_dwordx4 v[40:43], v27, s[68:71], s18 offen
  s_mov_b32 s18, 3072
  buffer_load_dwordx4 v[44:47], v27, s[68:71], s18 offen
  s_waitcnt vmcnt(2)
  s_waitcnt lgkmcnt(0)
  s_barrier
  s_mov_b32 s18, 1376256
  s_add_u32 m0, s35, 0
  s_nop 0
  buffer_load_dwordx4 v26, s[60:63], s18 offen lds
  ds_read_b64_tr_b16 a[236:237], v25 offset:1024
  ds_read_b64_tr_b16 a[238:239], v23 offset:1536
  s_waitcnt vmcnt(1)
  v_perm_b32 v193, v44, v40, s40
  v_perm_b32 v197, v44, v40, s41
  v_perm_b32 v201, v45, v41, s40
  v_perm_b32 v205, v45, v41, s41
  v_perm_b32 v209, v46, v42, s40
  v_perm_b32 v213, v46, v42, s41
  v_perm_b32 v217, v47, v43, s40
  v_perm_b32 v221, v47, v43, s41
  s_mov_b32 s18, 16384
  buffer_load_dwordx4 v[48:51], v27, s[68:71], s18 offen
  s_mov_b32 s18, 17408
  buffer_load_dwordx4 v[52:55], v27, s[68:71], s18 offen
  s_waitcnt vmcnt(2)
  s_waitcnt lgkmcnt(0)
  s_barrier
  s_mov_b32 s18, 1376256
  s_add_u32 m0, s35, 1024
  s_nop 0
  buffer_load_dwordx4 v26, s[64:67], s18 offen lds
  ds_read_b64_tr_b16 a[176:177], v25 offset:0
  ds_read_b64_tr_b16 a[178:179], v23 offset:512
  s_waitcnt vmcnt(0)
  s_waitcnt lgkmcnt(0)
  s_barrier
  s_mov_b32 s18, 1490944
  s_add_u32 m0, s35, 0
  s_nop 0
  buffer_load_dwordx4 v26, s[60:63], s18 offen lds
  ds_read_b64_tr_b16 a[240:241], v25 offset:1024
  ds_read_b64_tr_b16 a[242:243], v23 offset:1536
  v_perm_b32 v194, v52, v48, s40
  v_perm_b32 v198, v52, v48, s41
  v_perm_b32 v202, v53, v49, s40
  v_perm_b32 v206, v53, v49, s41
  v_perm_b32 v210, v54, v50, s40
  v_perm_b32 v214, v54, v50, s41
  v_perm_b32 v218, v55, v51, s40
  v_perm_b32 v222, v55, v51, s41
  s_mov_b32 s18, 18432
  buffer_load_dwordx4 v[56:59], v27, s[68:71], s18 offen
  s_mov_b32 s18, 19456
  buffer_load_dwordx4 v[60:63], v27, s[68:71], s18 offen
  s_waitcnt vmcnt(2)
  s_waitcnt lgkmcnt(0)
  s_barrier
  s_mov_b32 s18, 1490944
  s_add_u32 m0, s35, 1024
  s_nop 0
  buffer_load_dwordx4 v26, s[64:67], s18 offen lds
  ds_read_b64_tr_b16 a[180:181], v25 offset:0
  ds_read_b64_tr_b16 a[182:183], v23 offset:512
  s_waitcnt vmcnt(1)
  v_perm_b32 v195, v60, v56, s40
  v_perm_b32 v199, v60, v56, s41
  v_perm_b32 v203, v61, v57, s40
  v_perm_b32 v207, v61, v57, s41
  v_perm_b32 v211, v62, v58, s40
  v_perm_b32 v215, v62, v58, s41
  v_perm_b32 v219, v63, v59, s40
  v_perm_b32 v223, v63, v59, s41
  s_mov_b32 s18, 32768
  buffer_load_dwordx4 v[64:67], v27, s[68:71], s18 offen
  s_mov_b32 s18, 33792
  buffer_load_dwordx4 v[68:71], v27, s[68:71], s18 offen
  s_waitcnt vmcnt(2)
  s_waitcnt lgkmcnt(0)
  s_barrier
  s_mov_b32 s18, 1605632
  s_add_u32 m0, s35, 0
  s_nop 0
  buffer_load_dwordx4 v26, s[60:63], s18 offen lds
  ds_read_b64_tr_b16 a[244:245], v25 offset:1024
  ds_read_b64_tr_b16 a[246:247], v23 offset:1536
  s_waitcnt vmcnt(1)
  v_perm_b32 v224, v68, v64, s40
  v_perm_b32 v228, v68, v64, s41
  v_perm_b32 v232, v69, v65, s40
  v_perm_b32 v236, v69, v65, s41
  v_perm_b32 v240, v70, v66, s40
  v_perm_b32 v244, v70, v66, s41
  v_perm_b32 v248, v71, v67, s40
  v_perm_b32 v252, v71, v67, s41
  s_mov_b32 s18, 34816
  buffer_load_dwordx4 v[72:75], v27, s[68:71], s18 offen
  s_mov_b32 s18, 35840
  buffer_load_dwordx4 v[76:79], v27, s[68:71], s18 offen
  s_waitcnt vmcnt(2)
  s_waitcnt lgkmcnt(0)
  s_barrier
  s_mov_b32 s18, 1605632
  s_add_u32 m0, s35, 1024
  s_nop 0
  buffer_load_dwordx4 v26, s[64:67], s18 offen lds
  ds_read_b64_tr_b16 a[184:185], v25 offset:0
  ds_read_b64_tr_b16 a[186:187], v23 offset:512
  s_waitcnt vmcnt(0)
  s_waitcnt lgkmcnt(0)
  s_barrier
  s_mov_b32 s18, 1720320
  s_add_u32 m0, s35, 0
  s_nop 0
  buffer_load_dwordx4 v26, s[60:63], s18 offen lds
  ds_read_b64_tr_b16 a[248:249], v25 offset:1024
  ds_read_b64_tr_b16 a[250:251], v23 offset:1536
  v_perm_b32 v225, v76, v72, s40
  v_perm_b32 v229, v76, v72, s41
  v_perm_b32 v233, v77, v73, s40
  v_perm_b32 v237, v77, v73, s41
  v_perm_b32 v241, v78, v74, s40
  v_perm_b32 v245, v78, v74, s41
  v_perm_b32 v249, v79, v75, s40
  v_perm_b32 v253, v79, v75, s41
  s_mov_b32 s18, 49152
  buffer_load_dwordx4 v[80:83], v27, s[68:71], s18 offen
  s_mov_b32 s18, 50176
  buffer_load_dwordx4 v[84:87], v27, s[68:71], s18 offen
  s_waitcnt vmcnt(2)
  s_waitcnt lgkmcnt(0)
  s_barrier
  s_mov_b32 s18, 1720320
  s_add_u32 m0, s35, 1024
  s_nop 0
  buffer_load_dwordx4 v26, s[64:67], s18 offen lds
  ds_read_b64_tr_b16 a[188:189], v25 offset:0
  ds_read_b64_tr_b16 a[190:191], v23 offset:512
  s_waitcnt vmcnt(1)
  v_perm_b32 v226, v84, v80, s40
  v_perm_b32 v230, v84, v80, s41
  v_perm_b32 v234, v85, v81, s40
  v_perm_b32 v238, v85, v81, s41
  v_perm_b32 v242, v86, v82, s40
  v_perm_b32 v246, v86, v82, s41
  v_perm_b32 v250, v87, v83, s40
  v_perm_b32 v254, v87, v83, s41
  s_mov_b32 s18, 51200
  buffer_load_dwordx4 v[88:91], v27, s[68:71], s18 offen
  s_mov_b32 s18, 52224
  buffer_load_dwordx4 v[92:95], v27, s[68:71], s18 offen
  s_waitcnt vmcnt(2)
  s_waitcnt lgkmcnt(0)
  s_barrier
  ds_read_b64_tr_b16 a[252:253], v25 offset:1024
  ds_read_b64_tr_b16 a[254:255], v23 offset:1536
  s_waitcnt vmcnt(0)
  v_perm_b32 v227, v92, v88, s40
  v_perm_b32 v231, v92, v88, s41
  v_perm_b32 v235, v93, v89, s40
  v_perm_b32 v239, v93, v89, s41
  v_perm_b32 v243, v94, v90, s40
  v_perm_b32 v247, v94, v90, s41
  v_perm_b32 v251, v95, v91, s40
  v_perm_b32 v255, v95, v91, s41
  s_waitcnt lgkmcnt(0)
  s_barrier
  s_waitcnt lgkmcnt(0)
  v_lshrrev_b32 v116, 4, v0
  v_and_b32 v117, 15, v116
  v_lshrrev_b32 v118, 4, v116
  s_lshl_b32 s19, s13, 8
  v_lshlrev_b32 v114, 17, v118
  v_lshlrev_b32 v115, 4, v117
  v_add_u32 v114, v114, v115
  s_lshl_b32 s18, s12, 10
  s_add_u32 s18, s18, s19
  v_add_u32 v4, s18, v114
  v_lshlrev_b32 v114, 10, v118
  v_add_u32 v114, v114, v115
  s_lshl_b32 s18, s12, 15
  s_add_u32 s18, s18, s19
  v_add_u32 v5, s18, v114
  v_and_b32 v114, 1, v118
  v_lshlrev_b32 v114, 3, v114
  v_add_u32 v114, v114, v115
  s_lshl_b32 s18, s12, 10
  s_add_u32 s18, s18, s19
  v_add_u32 v114, s18, v114
  v_mov_b32 v115, 0x40000000
  v_cmp_gt_u32 vcc, 32, v116
  s_nop 1
  v_cndmask_b32 v6, v115, v114, vcc
  v_mov_b32 v9, v114
  s_and_b32 s18, s13, 1
  s_lshl_b32 s18, s18, 12
  s_lshl_b32 s19, s13, 10
  s_add_u32 s18, s18, s19
  s_add_u32 s19, s18, 32768
  v_add_u32 v7, s19, v0
  v_xor_b32 v188, 1024, v7
  v_mul_u32_u24 v114, 1088, v118
  v_lshlrev_b32 v115, 3, v117
  v_add_u32 v114, v114, v115
  s_lshl_b32 s19, s13, 7
  s_add_u32 s19, s19, 46080
  v_add_u32 v189, s19, v114
  v_and_b32 v114, 3, v116
  v_mul_u32_u24 v114, 1088, v114
  v_lshrrev_b32 v115, 2, v116
  v_lshlrev_b32 v115, 3, v115
  v_add_u32 v114, v114, v115
  v_add_u32 v190, 46080, v114
  s_and_b32 s18, s13, 2
  s_lshl_b32 s18, s18, 9
  s_and_b32 s19, s13, 1
  s_lshl_b32 s19, s19, 3
  s_add_u32 s18, s18, s19
  s_add_u32 s18, s18, 40960
  v_add_u32 v8, s18, v0
  v_mov_b32 v11, 0
  v_mov_b32 v187, 0xfffe0000
  v_mov_b32 v16, 0x3f803f80
  v_mov_b32 v17, 0x3f803f80
  v_mov_b32 v18, 0x3f803f80
  v_mov_b32 v19, 0x3f803f80
  v_and_b32 v114, 1, v117
  v_lshlrev_b32 v114, 4, v114
  v_mov_b32 v115, 0x3f80
  v_lshlrev_b32 v114, v114, v115
  v_bfe_u32 v115, v117, 1, 2
  v_cmp_eq_u32 vcc, 0, v115
  s_nop 1
  v_cndmask_b32 v12, 0, v114, vcc
  v_cmp_eq_u32 vcc, 1, v115
  s_nop 1
  v_cndmask_b32 v13, 0, v114, vcc
  v_cmp_eq_u32 vcc, 2, v115
  s_nop 1
  v_cndmask_b32 v14, 0, v114, vcc
  v_cmp_eq_u32 vcc, 3, v115
  s_nop 1
  v_cndmask_b32 v15, 0, v114, vcc
  s_and_b32 s18, s13, 1
  s_lshl_b32 s18, s18, 4
  v_add_u32 v114, s18, v117
  v_lshlrev_b32 v115, 2, v118
  v_sub_u32 v114, v114, v115
  v_cmp_le_i32 s[78:79], 0, v114
  v_cmp_le_i32 s[80:81], 1, v114
  v_cmp_le_i32 s[82:83], 2, v114
  v_cmp_le_i32 s[84:85], 3, v114
  v_cmp_le_i32 s[86:87], 16, v114
  v_cmp_le_i32 s[88:89], 17, v114
  v_cmp_le_i32 s[90:91], 18, v114
  v_cmp_le_i32 s[20:21], 19, v114
  s_mov_b32 s23, 0xff800000
  s_sub_u32 s17, s14, 1
  s_mul_i32 s25, s12, 2097152
  s_lshl_b32 s18, s17, 13
  s_add_u32 s18, s18, s25
  s_add_u32 s34, s18, 16777216
  s_and_b32 s19, s13, 1
  s_lshl_b32 s19, s19, 10
  s_add_u32 s33, s18, s19
  s_add_u32 s33, s33, 17825792
  s_lshl_b32 s19, s13, 11
  s_add_u32 s35, s18, s19
  s_add_u32 s35, s35, 17301504
  s_lshl_b32 s18, s17, 12
  s_add_u32 s18, s18, s25
  s_lshr_b32 s19, s19, 1
  s_add_u32 s36, s18, s19
  s_add_u32 s36, s36, 18350080
  s_lshl_b32 s18, s14, 20
  s_add_u32 s39, s18, 92274688
  s_add_u32 s42, s18, 100663296
  s_lshl_b32 s18, s14, 15
  s_add_u32 s43, s18, 109051904
  s_lshl_b32 s76, s17, 15
  s_lshl_b32 s77, s13, 13
  s_mov_b32 s16, 1
  s_barrier
  s_lshl_b32 s18, s14, 5
  buffer_load_dword v114, off, s[92:95], s18 sc1
  s_waitcnt vmcnt(0)
  v_readfirstlane_b32 s18, v114
  s_nop 0
  s_cmp_lt_u32 s18, 32
  s_cbranch_scc1 L_p2_slow
L_p2_fast:
  s_add_u32 s19, s33, 0
  buffer_load_dwordx4 v[20:23], v0, s[4:7], s19 offen sc1
  s_add_u32 s19, s33, 2048
  buffer_load_dwordx4 v[24:27], v0, s[4:7], s19 offen sc1
  s_add_u32 s19, s33, 4096
  buffer_load_dwordx4 v[28:31], v0, s[4:7], s19 offen sc1
  s_add_u32 s19, s33, 6144
  buffer_load_dwordx4 v[32:35], v0, s[4:7], s19 offen sc1
  s_xor_b32 s19, s35, 0
  buffer_load_dwordx4 v[68:71], v0, s[4:7], s19 offen offset:0 sc1
  s_xor_b32 s19, s35, 0
  buffer_load_dwordx4 v[72:75], v0, s[4:7], s19 offen offset:1024 sc1
  s_xor_b32 s19, s35, 2048
  buffer_load_dwordx4 v[76:79], v0, s[4:7], s19 offen offset:0 sc1
  s_xor_b32 s19, s35, 2048
  buffer_load_dwordx4 v[80:83], v0, s[4:7], s19 offen offset:1024 sc1
  s_add_u32 s33, s33, 57344
  s_add_u32 s35, s35, 57344
  s_add_u32 s19, s34, 0
  buffer_load_dwordx4 v[36:39], v0, s[4:7], s19 offen offset:0 sc1
  s_add_u32 s19, s34, 0
  buffer_load_dwordx4 v[40:43], v0, s[4:7], s19 offen offset:1024 sc1
  s_add_u32 s19, s34, 2048
  buffer_load_dwordx4 v[44:47], v0, s[4:7], s19 offen offset:0 sc1
  s_add_u32 s19, s34, 2048
  buffer_load_dwordx4 v[48:51], v0, s[4:7], s19 offen offset:1024 sc1
  s_add_u32 s19, s34, 4096
  buffer_load_dwordx4 v[52:55], v0, s[4:7], s19 offen offset:0 sc1
  s_add_u32 s19, s34, 4096
  buffer_load_dwordx4 v[56:59], v0, s[4:7], s19 offen offset:1024 sc1
  s_add_u32 s19, s34, 6144
  buffer_load_dwordx4 v[60:63], v0, s[4:7], s19 offen offset:0 sc1
  s_add_u32 s19, s34, 6144
  buffer_load_dwordx4 v[64:67], v0, s[4:7], s19 offen offset:1024 sc1
  s_add_u32 s34, s34, 57344
L_p2top_fast:
  buffer_load_dwordx2 v[112:113], v9, s[8:11], s76 offen
  s_waitcnt vmcnt(8)
  v_mfma_f32_16x16x32_bf16 v[118:121], v[36:39], v[20:23], 0
  s_waitcnt vmcnt(7)
  v_mfma_f32_16x16x32_bf16 v[122:125], v[40:43], v[20:23], 0
  s_waitcnt vmcnt(6)
  v_mfma_f32_16x16x32_bf16 v[118:121], v[44:47], v[24:27], v[118:121]
  s_waitcnt vmcnt(5)
  v_mfma_f32_16x16x32_bf16 v[122:125], v[48:51], v[24:27], v[122:125]
  s_waitcnt vmcnt(4)
  v_mfma_f32_16x16x32_bf16 v[118:121], v[52:55], v[28:31], v[118:121]
  s_waitcnt vmcnt(3)
  v_mfma_f32_16x16x32_bf16 v[122:125], v[56:59], v[28:31], v[122:125]
  s_waitcnt vmcnt(2)
  v_mfma_f32_16x16x32_bf16 v[118:121], v[60:63], v[32:35], v[118:121]
  s_waitcnt vmcnt(1)
  v_mfma_f32_16x16x32_bf16 v[122:125], v[64:67], v[32:35], v[122:125]
  v_mov_b32 v130, s23
  s_nop 4
  v_cndmask_b32 v118, v130, v118, s[78:79]
  v_cndmask_b32 v119, v130, v119, s[80:81]
  v_cndmask_b32 v120, v130, v120, s[82:83]
  v_cndmask_b32 v121, v130, v121, s[84:85]
  v_cndmask_b32 v122, v130, v122, s[86:87]
  v_cndmask_b32 v123, v130, v123, s[88:89]
  v_cndmask_b32 v124, v130, v124, s[90:91]
  v_cndmask_b32 v125, v130, v125, s[20:21]
  v_max3_f32 v130, v118, v119, v120
  v_max3_f32 v130, v130, v121, v122
  v_max3_f32 v130, v130, v123, v124
  v_max_f32 v130, v130, v125
L_xl_fast:
  buffer_load_dwordx4 v[100:103], v0, s[4:7], s36 offen sc1
  s_xor_b32 s18, s36, 1024
  buffer_load_dwordx4 v[104:107], v0, s[4:7], s18 offen sc1
  s_add_u32 s24, s24, 1
  s_cmp_gt_u32 s24, 0x200000
  s_cbranch_scc1 L_bail
  s_waitcnt vmcnt(0)
  v_max_u32 v114, v100, v104
  v_cmp_eq_u32 vcc, -1, v114
  s_cbranch_vccz L_xd_fast
  s_cmp_eq_u32 s16, s15
  s_cbranch_scc1 L_xq_fast
  s_sleep 12
L_xq_fast:
  s_sleep 1
  s_branch L_xl_fast
L_xd_fast:
  ds_write2st64_b32 v189, v101, v103 offset0:0 offset1:2
  s_add_u32 s36, s36, 28672
  s_waitcnt lgkmcnt(0)
  s_barrier
  ds_read_b64_tr_b16 v[84:85], v190 offset:0
  ds_read_b64_tr_b16 v[86:87], v190 offset:512
  ds_read_b64_tr_b16 v[88:89], v190 offset:128
  ds_read_b64_tr_b16 v[90:91], v190 offset:640
  ds_read_b64_tr_b16 v[92:93], v190 offset:256
  ds_read_b64_tr_b16 v[94:95], v190 offset:768
  ds_read_b64_tr_b16 v[96:97], v190 offset:384
  ds_read_b64_tr_b16 v[98:99], v190 offset:896
  s_waitcnt lgkmcnt(6)
  v_mfma_f32_16x16x32_bf16 v[126:129], v[84:87], v[20:23], 0
  s_waitcnt lgkmcnt(4)
  v_mfma_f32_16x16x32_bf16 v[126:129], v[88:91], v[24:27], v[126:129]
  s_waitcnt lgkmcnt(2)
  v_mfma_f32_16x16x32_bf16 v[126:129], v[92:95], v[28:31], v[126:129]
  s_waitcnt lgkmcnt(0)
  v_mfma_f32_16x16x32_bf16 v[126:129], v[96:99], v[32:35], v[126:129]
  s_nop 7
  v_mul_f32 v126, s22, v126
  v_mul_f32 v127, s22, v127
  v_max3_f32 v130, v130, v126, v127
  v_mov_b32 v131, v130
  s_nop 1
  v_permlane16_swap_b32 v130, v131
  v_max_f32 v130, v130, v131
  v_mov_b32 v131, v130
  s_nop 1
  v_permlane32_swap_b32 v130, v131
  v_max_f32 v130, v130, v131
  v_sub_f32 v118, v118, v130
  v_sub_f32 v119, v119, v130
  v_sub_f32 v120, v120, v130
  v_sub_f32 v121, v121, v130
  v_sub_f32 v122, v122, v130
  v_sub_f32 v123, v123, v130
  v_sub_f32 v124, v124, v130
  v_sub_f32 v125, v125, v130
  v_sub_f32 v126, v126, v130
  v_sub_f32 v127, v127, v130
  v_exp_f32 v118, v118
  v_exp_f32 v119, v119
  v_exp_f32 v120, v120
  v_exp_f32 v121, v121
  v_exp_f32 v122, v122
  v_exp_f32 v123, v123
  v_exp_f32 v124, v124
  v_exp_f32 v125, v125
  v_exp_f32 v126, v126
  v_exp_f32 v127, v127
  v_cvt_pk_bf16_f32 v134, v118, v119
  v_cvt_pk_bf16_f32 v135, v122, v123
  v_cvt_pk_bf16_f32 v136, v120, v121
  v_cvt_pk_bf16_f32 v137, v124, v125
  v_cvt_pk_bf16_f32 v10, v126, v127
  s_nop 0
  v_mfma_f32_16x16x32_bf16 v[138:141], v[16:19], v[134:137], 0
  v_mfma_f32_16x16x32_bf16 v[142:145], v[68:71], v[134:137], 0
  v_mfma_f32_16x16x32_bf16 v[146:149], v[72:75], v[134:137], 0
  v_mfma_f32_16x16x32_bf16 v[150:153], v[76:79], v[134:137], 0
  v_mfma_f32_16x16x32_bf16 v[154:157], v[80:83], v[134:137], 0
  s_nop 1
  v_mfma_f32_16x16x16_bf16 v[138:141], v[16:17], v[10:11], v[138:141]
  v_mfma_f32_16x16x16_bf16 v[142:145], v[100:101], v[10:11], v[142:145]
  v_mfma_f32_16x16x16_bf16 v[146:149], v[102:103], v[10:11], v[146:149]
  v_mfma_f32_16x16x16_bf16 v[150:153], v[104:105], v[10:11], v[150:153]
  v_mfma_f32_16x16x16_bf16 v[154:157], v[106:107], v[10:11], v[154:157]
  s_nop 3
  v_rcp_f32 v138, v138
  s_nop 0
  v_mul_f32 v142, v142, v138
  v_mul_f32 v143, v143, v138
  v_mul_f32 v144, v144, v138
  v_mul_f32 v145, v145, v138
  v_mul_f32 v146, v146, v138
  v_mul_f32 v147, v147, v138
  v_mul_f32 v148, v148, v138
  v_mul_f32 v149, v149, v138
  v_mul_f32 v150, v150, v138
  v_mul_f32 v151, v151, v138
  v_mul_f32 v152, v152, v138
  v_mul_f32 v153, v153, v138
  v_mul_f32 v154, v154, v138
  v_mul_f32 v155, v155, v138
  v_mul_f32 v156, v156, v138
  v_mul_f32 v157, v157, v138
  v_cvt_pk_bf16_f32 v118, v142, v146
  v_cvt_pk_bf16_f32 v119, v143, v147
  v_cvt_pk_bf16_f32 v120, v144, v148
  v_cvt_pk_bf16_f32 v121, v145, v149
  ds_write_b128 v7, v[118:121]
  v_cvt_pk_bf16_f32 v122, v150, v154
  v_cvt_pk_bf16_f32 v123, v151, v155
  v_cvt_pk_bf16_f32 v124, v152, v156
  v_cvt_pk_bf16_f32 v125, v153, v157
  ds_write_b128 v188, v[122:125]
  s_waitcnt lgkmcnt(0)
  s_barrier
  ds_read_b128 v[36:39], v0 offset:32768
  ds_read_b128 v[40:43], v0 offset:33792
  ds_read_b128 v[44:47], v0 offset:34816
  ds_read_b128 v[48:51], v0 offset:35840
  ds_read_b128 v[52:55], v0 offset:36864
  ds_read_b128 v[56:59], v0 offset:37888
  ds_read_b128 v[60:63], v0 offset:38912
  ds_read_b128 v[64:67], v0 offset:39936
  s_and_b32 s27, s16, 1
  s_lshl_b32 s27, s27, 16
  s_xor_b32 s26, s27, 0x10000
  s_cmp_lt_u32 s16, s15
  s_cselect_b32 s18, 0, 57344
  s_sub_u32 s33, s33, s18
  s_sub_u32 s34, s34, s18
  s_sub_u32 s35, s35, s18
  s_waitcnt lgkmcnt(7)
  v_mfma_f32_16x16x32_bf16 v[114:117], v[36:39], a[0:3], 0
  v_mfma_f32_16x16x32_bf16 v[118:121], v[36:39], a[4:7], 0
  s_add_u32 s19, s33, 0
  buffer_load_dwordx4 v[20:23], v0, s[4:7], s19 offen sc1
  s_waitcnt lgkmcnt(6)
  v_mfma_f32_16x16x32_bf16 v[114:117], v[40:43], a[32:35], v[114:117]
  v_mfma_f32_16x16x32_bf16 v[118:121], v[40:43], a[36:39], v[118:121]
  s_waitcnt lgkmcnt(5)
  v_mfma_f32_16x16x32_bf16 v[114:117], v[44:47], a[64:67], v[114:117]
  v_mfma_f32_16x16x32_bf16 v[118:121], v[44:47], a[68:71], v[118:121]
  s_add_u32 s19, s33, 2048
  buffer_load_dwordx4 v[24:27], v0, s[4:7], s19 offen sc1
  s_waitcnt lgkmcnt(4)
  v_mfma_f32_16x16x32_bf16 v[114:117], v[48:51], a[96:99], v[114:117]
  v_mfma_f32_16x16x32_bf16 v[118:121], v[48:51], a[100:103], v[118:121]
  v_mfma_f32_16x16x32_bf16 v[122:125], v[36:39], a[8:11], 0
  v_mfma_f32_16x16x32_bf16 v[126:129], v[36:39], a[12:15], 0
  s_add_u32 s19, s33, 4096
  buffer_load_dwordx4 v[28:31], v0, s[4:7], s19 offen sc1
  v_mfma_f32_16x16x32_bf16 v[122:125], v[40:43], a[40:43], v[122:125]
  v_mfma_f32_16x16x32_bf16 v[126:129], v[40:43], a[44:47], v[126:129]
  s_nop 1
  v_add_u32 v118, s26, v118
  v_and_or_b32 v118, v118, v187, s27
  v_cvt_pk_bf16_f32 v84, v114, v118
  v_mfma_f32_16x16x32_bf16 v[122:125], v[44:47], a[72:75], v[122:125]
  v_add_u32 v119, s26, v119
  v_and_or_b32 v119, v119, v187, s27
  v_cvt_pk_bf16_f32 v88, v115, v119
  v_mfma_f32_16x16x32_bf16 v[126:129], v[44:47], a[76:79], v[126:129]
  v_add_u32 v120, s26, v120
  v_and_or_b32 v120, v120, v187, s27
  s_add_u32 s19, s33, 6144
  buffer_load_dwordx4 v[32:35], v0, s[4:7], s19 offen sc1
  v_mfma_f32_16x16x32_bf16 v[122:125], v[48:51], a[104:107], v[122:125]
  v_cvt_pk_bf16_f32 v92, v116, v120
  v_add_u32 v121, s26, v121
  v_mfma_f32_16x16x32_bf16 v[126:129], v[48:51], a[108:111], v[126:129]
  v_and_or_b32 v121, v121, v187, s27
  v_cvt_pk_bf16_f32 v96, v117, v121
  v_mfma_f32_16x16x32_bf16 v[130:133], v[36:39], a[16:19], 0
  v_mfma_f32_16x16x32_bf16 v[134:137], v[36:39], a[20:23], 0
  s_xor_b32 s19, s35, 0
  buffer_load_dwordx4 v[68:71], v0, s[4:7], s19 offen offset:0 sc1
  v_mfma_f32_16x16x32_bf16 v[130:133], v[40:43], a[48:51], v[130:133]
  v_mfma_f32_16x16x32_bf16 v[134:137], v[40:43], a[52:55], v[134:137]
  v_cvt_pk_bf16_f32 v85, v122, v126
  v_mfma_f32_16x16x32_bf16 v[130:133], v[44:47], a[80:83], v[130:133]
  v_cvt_pk_bf16_f32 v89, v123, v127
  v_mfma_f32_16x16x32_bf16 v[134:137], v[44:47], a[84:87], v[134:137]
  v_cvt_pk_bf16_f32 v93, v124, v128
  s_xor_b32 s19, s35, 0
  buffer_load_dwordx4 v[72:75], v0, s[4:7], s19 offen offset:1024 sc1
  v_mfma_f32_16x16x32_bf16 v[130:133], v[48:51], a[112:115], v[130:133]
  v_cvt_pk_bf16_f32 v97, v125, v129
  v_mfma_f32_16x16x32_bf16 v[134:137], v[48:51], a[116:119], v[134:137]
  v_mfma_f32_16x16x32_bf16 v[138:141], v[36:39], a[24:27], 0
  v_mfma_f32_16x16x32_bf16 v[142:145], v[36:39], a[28:31], 0
  s_xor_b32 s19, s35, 2048
  buffer_load_dwordx4 v[76:79], v0, s[4:7], s19 offen offset:0 sc1
  v_mfma_f32_16x16x32_bf16 v[138:141], v[40:43], a[56:59], v[138:141]
  v_mfma_f32_16x16x32_bf16 v[142:145], v[40:43], a[60:63], v[142:145]
  s_nop 1
  v_cvt_pk_bf16_f32 v86, v130, v134
  v_mfma_f32_16x16x32_bf16 v[138:141], v[44:47], a[88:91], v[138:141]
  v_cvt_pk_bf16_f32 v90, v131, v135
  v_mfma_f32_16x16x32_bf16 v[142:145], v[44:47], a[92:95], v[142:145]
  v_cvt_pk_bf16_f32 v94, v132, v136
  s_xor_b32 s19, s35, 2048
  buffer_load_dwordx4 v[80:83], v0, s[4:7], s19 offen offset:1024 sc1
  v_mfma_f32_16x16x32_bf16 v[138:141], v[48:51], a[120:123], v[138:141]
  v_cvt_pk_bf16_f32 v98, v133, v137
  v_mfma_f32_16x16x32_bf16 v[142:145], v[48:51], a[124:127], v[142:145]
  s_waitcnt lgkmcnt(3)
  v_mfma_f32_16x16x32_bf16 v[146:149], v[52:55], a[0:3], 0
  v_mfma_f32_16x16x32_bf16 v[150:153], v[52:55], a[4:7], 0
  s_add_u32 s33, s33, 57344
  s_add_u32 s35, s35, 57344
  s_waitcnt lgkmcnt(2)
  v_mfma_f32_16x16x32_bf16 v[146:149], v[56:59], a[32:35], v[146:149]
  v_mfma_f32_16x16x32_bf16 v[150:153], v[56:59], a[36:39], v[150:153]
  v_cvt_pk_bf16_f32 v87, v138, v142
  s_waitcnt lgkmcnt(1)
  v_mfma_f32_16x16x32_bf16 v[146:149], v[60:63], a[64:67], v[146:149]
  v_cvt_pk_bf16_f32 v91, v139, v143
  v_mfma_f32_16x16x32_bf16 v[150:153], v[60:63], a[68:71], v[150:153]
  v_cvt_pk_bf16_f32 v95, v140, v144
  s_waitcnt lgkmcnt(0)
  v_mfma_f32_16x16x32_bf16 v[146:149], v[64:67], a[96:99], v[146:149]
  v_cvt_pk_bf16_f32 v99, v141, v145
  s_add_u32 s18, s39, 0
  buffer_store_dwordx4 v[84:87], v4, s[4:7], s18 offen
  v_mfma_f32_16x16x32_bf16 v[150:153], v[64:67], a[100:103], v[150:153]
  v_mfma_f32_16x16x32_bf16 v[154:157], v[52:55], a[8:11], 0
  v_mfma_f32_16x16x32_bf16 v[158:161], v[52:55], a[12:15], 0
  v_mfma_f32_16x16x32_bf16 v[154:157], v[56:59], a[40:43], v[154:157]
  v_mfma_f32_16x16x32_bf16 v[158:161], v[56:59], a[44:47], v[158:161]
  s_nop 3
  v_add_u32 v150, s26, v150
  v_and_or_b32 v150, v150, v187, s27
  v_cvt_pk_bf16_f32 v114, v146, v150
  s_add_u32 s18, s39, 32768
  buffer_store_dwordx4 v[88:91], v4, s[4:7], s18 offen
  v_mfma_f32_16x16x32_bf16 v[154:157], v[60:63], a[72:75], v[154:157]
  v_add_u32 v151, s26, v151
  v_and_or_b32 v151, v151, v187, s27
  v_cvt_pk_bf16_f32 v118, v147, v151
  v_mfma_f32_16x16x32_bf16 v[158:161], v[60:63], a[76:79], v[158:161]
  v_add_u32 v152, s26, v152
  v_and_or_b32 v152, v152, v187, s27
  v_mfma_f32_16x16x32_bf16 v[154:157], v[64:67], a[104:107], v[154:157]
  v_cvt_pk_bf16_f32 v122, v148, v152
  v_add_u32 v153, s26, v153
  v_mfma_f32_16x16x32_bf16 v[158:161], v[64:67], a[108:111], v[158:161]
  v_and_or_b32 v153, v153, v187, s27
  v_cvt_pk_bf16_f32 v126, v149, v153
  v_mfma_f32_16x16x32_bf16 v[162:165], v[52:55], a[16:19], 0
  s_add_u32 s18, s39, 65536
  buffer_store_dwordx4 v[92:95], v4, s[4:7], s18 offen
  v_mfma_f32_16x16x32_bf16 v[166:169], v[52:55], a[20:23], 0
  v_mfma_f32_16x16x32_bf16 v[162:165], v[56:59], a[48:51], v[162:165]
  v_mfma_f32_16x16x32_bf16 v[166:169], v[56:59], a[52:55], v[166:169]
  v_cvt_pk_bf16_f32 v115, v154, v158
  v_mfma_f32_16x16x32_bf16 v[162:165], v[60:63], a[80:83], v[162:165]
  v_cvt_pk_bf16_f32 v119, v155, v159
  v_mfma_f32_16x16x32_bf16 v[166:169], v[60:63], a[84:87], v[166:169]
  v_cvt_pk_bf16_f32 v123, v156, v160
  s_add_u32 s18, s39, 98304
  buffer_store_dwordx4 v[96:99], v4, s[4:7], s18 offen
  v_mfma_f32_16x16x32_bf16 v[162:165], v[64:67], a[112:115], v[162:165]
  v_cvt_pk_bf16_f32 v127, v157, v161
  v_mfma_f32_16x16x32_bf16 v[166:169], v[64:67], a[116:119], v[166:169]
  v_mfma_f32_16x16x32_bf16 v[170:173], v[52:55], a[24:27], 0
  v_mfma_f32_16x16x32_bf16 v[174:177], v[52:55], a[28:31], 0
  v_mfma_f32_16x16x32_bf16 v[170:173], v[56:59], a[56:59], v[170:173]
  v_mfma_f32_16x16x32_bf16 v[174:177], v[56:59], a[60:63], v[174:177]
  s_nop 3
  v_cvt_pk_bf16_f32 v116, v162, v166
  v_mfma_f32_16x16x32_bf16 v[170:173], v[60:63], a[88:91], v[170:173]
  v_cvt_pk_bf16_f32 v120, v163, v167
  v_mfma_f32_16x16x32_bf16 v[174:177], v[60:63], a[92:95], v[174:177]
  v_cvt_pk_bf16_f32 v124, v164, v168
  v_mfma_f32_16x16x32_bf16 v[170:173], v[64:67], a[120:123], v[170:173]
  v_cvt_pk_bf16_f32 v128, v165, v169
  v_mfma_f32_16x16x32_bf16 v[174:177], v[64:67], a[124:127], v[174:177]
  s_nop 7
  v_cvt_pk_bf16_f32 v117, v170, v174
  v_cvt_pk_bf16_f32 v121, v171, v175
  v_cvt_pk_bf16_f32 v125, v172, v176
  v_cvt_pk_bf16_f32 v129, v173, v177
  s_add_u32 s18, s39, 524288
  buffer_store_dwordx4 v[114:117], v4, s[4:7], s18 offen
  s_add_u32 s18, s39, 557056
  buffer_store_dwordx4 v[118:121], v4, s[4:7], s18 offen
  s_add_u32 s18, s39, 589824
  buffer_store_dwordx4 v[122:125], v4, s[4:7], s18 offen
  s_add_u32 s18, s39, 622592
  buffer_store_dwordx4 v[126:129], v4, s[4:7], s18 offen
  s_waitcnt vmcnt(2)
  s_cmp_lg_u32 s16, 1
  s_cbranch_scc1 L_ns_afast
  s_waitcnt vmcnt(0)
  v_mov_b32 v114, s16
  buffer_store_dword v114, off, s[4:7], s31 offset:0
L_ns_afast:
  s_cmp_lg_u32 s16, 1
  s_cbranch_scc1 L_nf_afast
  v_lshrrev_b32 v115, 2, v0
  v_min_u32 v115, 124, v115
L_pf_afast:
  buffer_load_dword v114, v115, s[4:7], s30 offen offset:0 sc1
  s_add_u32 s24, s24, 1
  s_cmp_gt_u32 s24, 0x200000
  s_cbranch_scc1 L_bail
  s_waitcnt vmcnt(0)
  v_cmp_gt_u32 vcc, s16, v114
  s_cbranch_vccnz L_pf_afast
L_nf_afast:
  s_add_u32 s18, s39, 0
  buffer_load_dwordx4 v[122:125], v5, s[4:7], s18 offen sc1
  s_add_u32 s18, s39, 4096
  buffer_load_dwordx4 v[126:129], v5, s[4:7], s18 offen sc1
  s_add_u32 s18, s39, 8192
  buffer_load_dwordx4 v[130:133], v5, s[4:7], s18 offen sc1
  s_add_u32 s18, s39, 12288
  buffer_load_dwordx4 v[134:137], v5, s[4:7], s18 offen sc1
  s_add_u32 s18, s39, 16384
  buffer_load_dwordx4 v[138:141], v5, s[4:7], s18 offen sc1
  s_add_u32 s18, s39, 20480
  buffer_load_dwordx4 v[142:145], v5, s[4:7], s18 offen sc1
  s_add_u32 s18, s39, 24576
  buffer_load_dwordx4 v[146:149], v5, s[4:7], s18 offen sc1
  s_add_u32 s18, s39, 28672
  buffer_load_dwordx4 v[150:153], v5, s[4:7], s18 offen sc1
  s_add_u32 s24, s24, 1
  s_cmp_gt_u32 s24, 0x200000
  s_cbranch_scc1 L_bail
  s_waitcnt vmcnt(7)
  v_mfma_f32_16x16x32_bf16 v[114:117], v[12:15], v[122:125], 0
  v_xor_b32 v118, s27, v122
  s_waitcnt vmcnt(6)
  v_mfma_f32_16x16x32_bf16 v[114:117], v[12:15], v[126:129], v[114:117]
  v_bitop3_b32 v118, v118, v126, s27 bitop3:0xf6
  s_waitcnt vmcnt(5)
  v_mfma_f32_16x16x32_bf16 v[114:117], v[12:15], v[130:133], v[114:117]
  v_bitop3_b32 v118, v118, v130, s27 bitop3:0xf6
  s_waitcnt vmcnt(4)
  v_mfma_f32_16x16x32_bf16 v[114:117], v[12:15], v[134:137], v[114:117]
  v_bitop3_b32 v118, v118, v134, s27 bitop3:0xf6
  s_waitcnt vmcnt(3)
  v_mfma_f32_16x16x32_bf16 v[114:117], v[12:15], v[138:141], v[114:117]
  v_bitop3_b32 v118, v118, v138, s27 bitop3:0xf6
  s_waitcnt vmcnt(2)
  v_mfma_f32_16x16x32_bf16 v[114:117], v[12:15], v[142:145], v[114:117]
  v_bitop3_b32 v118, v118, v142, s27 bitop3:0xf6
  s_waitcnt vmcnt(1)
  v_mfma_f32_16x16x32_bf16 v[114:117], v[12:15], v[146:149], v[114:117]
  v_bitop3_b32 v118, v118, v146, s27 bitop3:0xf6
  s_waitcnt vmcnt(0)
  v_mfma_f32_16x16x32_bf16 v[114:117], v[12:15], v[150:153], v[114:117]
  v_bitop3_b32 v118, v118, v150, s27 bitop3:0xf6
  v_and_b32 v118, 0x10000, v118
  v_cmp_ne_u32 vcc, 0, v118
  s_cbranch_vccnz L_nf_afast
  v_lshlrev_b32 v108, 16, v112
  v_and_b32 v109, 0xffff0000, v112
  v_lshlrev_b32 v110, 16, v113
  v_and_b32 v111, 0xffff0000, v113
  v_add_f32 v108, v108, v114
  v_add_f32 v109, v109, v115
  v_add_f32 v110, v110, v116
  v_add_f32 v111, v111, v117
  v_cvt_pk_bf16_f32 v114, v108, v109
  v_cvt_pk_bf16_f32 v115, v110, v111
  v_lshlrev_b32 v108, 16, v114
  v_and_b32 v109, 0xffff0000, v114
  v_lshlrev_b32 v110, 16, v115
  v_and_b32 v111, 0xffff0000, v115
  v_readfirstlane_b32 s25, v108
  s_nop 1
  v_subrev_f32 v114, s25, v108
  v_subrev_f32 v115, s25, v109
  v_subrev_f32 v116, s25, v110
  v_subrev_f32 v117, s25, v111
  v_add_f32 v118, v114, v115
  v_mul_f32 v120, v114, v114
  v_add_f32 v119, v116, v117
  v_fmac_f32 v120, v115, v115
  v_add_f32 v118, v118, v119
  v_fmac_f32 v120, v116, v116
  v_fmac_f32 v120, v117, v117
  v_add_f32_dpp v118, v118, v118 row_ror:8 row_mask:0xf bank_mask:0xf
  s_nop 0
  v_add_f32_dpp v120, v120, v120 row_ror:8 row_mask:0xf bank_mask:0xf
  v_add_f32_dpp v118, v118, v118 row_ror:4 row_mask:0xf bank_mask:0xf
  s_nop 0
  v_add_f32_dpp v120, v120, v120 row_ror:4 row_mask:0xf bank_mask:0xf
  v_add_f32_dpp v118, v118, v118 row_ror:2 row_mask:0xf bank_mask:0xf
  s_nop 0
  v_add_f32_dpp v120, v120, v120 row_ror:2 row_mask:0xf bank_mask:0xf
  v_add_f32_dpp v118, v118, v118 row_ror:1 row_mask:0xf bank_mask:0xf
  s_nop 0
  v_add_f32_dpp v120, v120, v120 row_ror:1 row_mask:0xf bank_mask:0xf
  v_mov_b32 v119, v118
  v_mov_b32 v121, v120
  s_nop 0
  v_permlane16_swap_b32 v118, v119
  v_permlane16_swap_b32 v120, v121
  v_add_f32 v118, v118, v119
  v_add_f32 v120, v120, v121
  v_mul_f32 v119, 1006632960, v118
  s_lshl_b32 s18, s13, 3
  v_mov_b32 v121, s18
  v_fma_f32 v120, -v119, v118, v120
  v_add_f32 v118, s25, v119
  v_mov_b32 v119, v120
  ds_write_b64 v121, v[118:119] offset:45056
  s_waitcnt lgkmcnt(0)
  s_barrier
  ds_read_b128 v[122:125], v11 offset:45056
  ds_read_b128 v[126:129], v11 offset:45072
  s_waitcnt lgkmcnt(1)
  v_add_f32 v118, v122, v124
  v_add_f32 v120, v123, v125
  s_waitcnt lgkmcnt(0)
  v_add_f32 v119, v126, v128
  v_add_f32 v121, v127, v129
  v_add_f32 v118, v118, v119
  v_add_f32 v120, v120, v121
  v_mul_f32 v118, 1048576000, v118
  v_mul_f32 v120, 1006632960, v120
  v_sub_f32 v122, v122, v118
  v_sub_f32 v124, v124, v118
  v_sub_f32 v126, v126, v118
  v_sub_f32 v128, v128, v118
  v_fmac_f32 v120, v122, v122
  v_fmac_f32 v120, v124, v124
  v_fmac_f32 v120, v126, v126
  v_fmac_f32 v120, v128, v128
  v_mov_b32 v119, 925353388
  v_fmac_f32 v119, 1048576000, v120
  v_rsq_f32 v120, v119
  v_sub_f32 v114, v108, v118
  v_sub_f32 v115, v109, v118
  v_sub_f32 v116, v110, v118
  v_sub_f32 v117, v111, v118
  v_mul_f32 v114, v114, v120
  v_mul_f32 v115, v115, v120
  v_mul_f32 v116, v116, v120
  v_mul_f32 v117, v117, v120
  v_cvt_pk_bf16_f32 v114, v114, v115
  v_cvt_pk_bf16_f32 v115, v116, v117
  buffer_store_dwordx2 v[114:115], v6, s[4:7], s43 offen
  s_waitcnt vmcnt(0)
  v_mov_b32 v114, s16
  buffer_store_dword v114, off, s[4:7], s32 offset:512
  s_cmp_ge_u32 s12, 28
  s_cbranch_scc1 L_skip_fast
  v_lshrrev_b32 v115, 2, v0
  v_min_u32 v115, 124, v115
L_pf_bfast:
  buffer_load_dword v114, v115, s[4:7], s30 offen offset:512 sc1
  s_add_u32 s24, s24, 1
  s_cmp_gt_u32 s24, 0x200000
  s_cbranch_scc1 L_bail
  s_waitcnt vmcnt(0)
  v_cmp_gt_u32 vcc, s16, v114
  s_cbranch_vccnz L_pf_bfast
  s_add_u32 m0, s77, 0
  s_nop 0
  buffer_load_dwordx4 v1, s[4:7], s43 offen offset:0 sc1 lds
  s_add_u32 m0, s77, 896
  s_nop 0
  buffer_load_dwordx4 v1, s[4:7], s43 offen offset:128 sc1 lds
  s_add_u32 m0, s77, 1792
  s_nop 0
  buffer_load_dwordx4 v1, s[4:7], s43 offen offset:256 sc1 lds
  s_add_u32 m0, s77, 2688
  s_nop 0
  buffer_load_dwordx4 v1, s[4:7], s43 offen offset:384 sc1 lds
  s_add_u32 m0, s77, 3584
  s_nop 0
  buffer_load_dwordx4 v1, s[4:7], s43 offen offset:512 sc1 lds
  s_add_u32 m0, s77, 4480
  s_nop 0
  buffer_load_dwordx4 v1, s[4:7], s43 offen offset:640 sc1 lds
  s_add_u32 m0, s77, 5376
  s_nop 0
  buffer_load_dwordx4 v1, s[4:7], s43 offen offset:768 sc1 lds
  s_add_u32 m0, s77, 6272
  s_nop 0
  buffer_load_dwordx4 v1, s[4:7], s43 offen offset:896 sc1 lds
  s_waitcnt vmcnt(4)
  s_barrier
  ds_read_b128 v[146:149], v2 offset:0
  ds_read_b128 v[150:153], v2 offset:16384
  ds_read_b128 v[154:157], v3 offset:0
  ds_read_b128 v[158:161], v3 offset:16384
  s_waitcnt lgkmcnt(3)
  v_mfma_f32_16x16x32_bf16 v[114:117], a[128:131], v[146:149], 0
  ds_read_b128 v[162:165], v2 offset:1024
  v_mfma_f32_16x16x32_bf16 v[122:125], a[192:195], v[146:149], 0
  s_waitcnt lgkmcnt(3)
  v_mfma_f32_16x16x32_bf16 v[118:121], a[128:131], v[150:153], 0
  ds_read_b128 v[166:169], v2 offset:17408
  v_mfma_f32_16x16x32_bf16 v[126:129], a[192:195], v[150:153], 0
  s_waitcnt lgkmcnt(3)
  v_mfma_f32_16x16x32_bf16 v[114:117], a[132:135], v[154:157], v[114:117]
  ds_read_b128 v[146:149], v3 offset:1024
  v_mfma_f32_16x16x32_bf16 v[122:125], a[196:199], v[154:157], v[122:125]
  s_waitcnt lgkmcnt(3)
  v_mfma_f32_16x16x32_bf16 v[118:121], a[132:135], v[158:161], v[118:121]
  ds_read_b128 v[150:153], v3 offset:17408
  v_mfma_f32_16x16x32_bf16 v[126:129], a[196:199], v[158:161], v[126:129]
  s_waitcnt lgkmcnt(3)
  v_mfma_f32_16x16x32_bf16 v[114:117], a[136:139], v[162:165], v[114:117]
  ds_read_b128 v[154:157], v2 offset:2048
  v_mfma_f32_16x16x32_bf16 v[122:125], a[200:203], v[162:165], v[122:125]
  s_waitcnt lgkmcnt(3)
  v_mfma_f32_16x16x32_bf16 v[118:121], a[136:139], v[166:169], v[118:121]
  ds_read_b128 v[158:161], v2 offset:18432
  v_mfma_f32_16x16x32_bf16 v[126:129], a[200:203], v[166:169], v[126:129]
  s_waitcnt lgkmcnt(3)
  v_mfma_f32_16x16x32_bf16 v[114:117], a[140:143], v[146:149], v[114:117]
  ds_read_b128 v[162:165], v3 offset:2048
  v_mfma_f32_16x16x32_bf16 v[122:125], a[204:207], v[146:149], v[122:125]
  s_waitcnt lgkmcnt(3)
  v_mfma_f32_16x16x32_bf16 v[118:121], a[140:143], v[150:153], v[118:121]
  ds_read_b128 v[166:169], v3 offset:18432
  v_mfma_f32_16x16x32_bf16 v[126:129], a[204:207], v[150:153], v[126:129]
  s_waitcnt lgkmcnt(3)
  v_mfma_f32_16x16x32_bf16 v[114:117], a[144:147], v[154:157], v[114:117]
  ds_read_b128 v[146:149], v2 offset:3072
  v_mfma_f32_16x16x32_bf16 v[122:125], a[208:211], v[154:157], v[122:125]
  s_waitcnt lgkmcnt(3)
  v_mfma_f32_16x16x32_bf16 v[118:121], a[144:147], v[158:161], v[118:121]
  ds_read_b128 v[150:153], v2 offset:19456
  v_mfma_f32_16x16x32_bf16 v[126:129], a[208:211], v[158:161], v[126:129]
  s_waitcnt lgkmcnt(3)
  v_mfma_f32_16x16x32_bf16 v[114:117], a[148:151], v[162:165], v[114:117]
  ds_read_b128 v[154:157], v3 offset:3072
  v_mfma_f32_16x16x32_bf16 v[122:125], a[212:215], v[162:165], v[122:125]
  s_waitcnt lgkmcnt(3)
  v_mfma_f32_16x16x32_bf16 v[118:121], a[148:151], v[166:169], v[118:121]
  ds_read_b128 v[158:161], v3 offset:19456
  v_mfma_f32_16x16x32_bf16 v[126:129], a[212:215], v[166:169], v[126:129]
  s_waitcnt vmcnt(0)
  s_barrier
  s_waitcnt lgkmcnt(3)
  v_mfma_f32_16x16x32_bf16 v[114:117], a[152:155], v[146:149], v[114:117]
  ds_read_b128 v[162:165], v2 offset:4096
  s_add_u32 s19, s34, 0
  v_mfma_f32_16x16x32_bf16 v[122:125], a[216:219], v[146:149], v[122:125]
  buffer_load_dwordx4 v[36:39], v0, s[4:7], s19 offen offset:0 sc1
  s_waitcnt lgkmcnt(3)
  v_mfma_f32_16x16x32_bf16 v[118:121], a[152:155], v[150:153], v[118:121]
  ds_read_b128 v[166:169], v3 offset:4096
  v_mfma_f32_16x16x32_bf16 v[126:129], a[216:219], v[150:153], v[126:129]
  s_waitcnt lgkmcnt(3)
  v_mfma_f32_16x16x32_bf16 v[114:117], a[156:159], v[154:157], v[114:117]
  ds_read_b128 v[146:149], v2 offset:5120
  s_add_u32 s19, s34, 0
  v_mfma_f32_16x16x32_bf16 v[122:125], a[220:223], v[154:157], v[122:125]
  buffer_load_dwordx4 v[40:43], v0, s[4:7], s19 offen offset:1024 sc1
  s_waitcnt lgkmcnt(3)
  v_mfma_f32_16x16x32_bf16 v[118:121], a[156:159], v[158:161], v[118:121]
  ds_read_b128 v[150:153], v3 offset:5120
  v_mfma_f32_16x16x32_bf16 v[126:129], a[220:223], v[158:161], v[126:129]
  s_waitcnt lgkmcnt(3)
  v_mfma_f32_16x16x32_bf16 v[114:117], a[160:163], v[162:165], v[114:117]
  ds_read_b128 v[154:157], v2 offset:6144
  s_add_u32 s19, s34, 2048
  v_mfma_f32_16x16x32_bf16 v[122:125], a[224:227], v[162:165], v[122:125]
  buffer_load_dwordx4 v[44:47], v0, s[4:7], s19 offen offset:0 sc1
  s_waitcnt lgkmcnt(3)
  v_mfma_f32_16x16x32_bf16 v[114:117], a[164:167], v[166:169], v[114:117]
  ds_read_b128 v[158:161], v3 offset:6144
  v_mfma_f32_16x16x32_bf16 v[122:125], a[228:231], v[166:169], v[122:125]
  s_waitcnt lgkmcnt(3)
  v_mfma_f32_16x16x32_bf16 v[114:117], a[168:171], v[146:149], v[114:117]
  ds_read_b128 v[162:165], v2 offset:7168
  s_add_u32 s19, s34, 2048
  v_mfma_f32_16x16x32_bf16 v[122:125], a[232:235], v[146:149], v[122:125]
  buffer_load_dwordx4 v[48:51], v0, s[4:7], s19 offen offset:1024 sc1
  s_waitcnt lgkmcnt(3)
  v_mfma_f32_16x16x32_bf16 v[114:117], a[172:175], v[150:153], v[114:117]
  ds_read_b128 v[166:169], v3 offset:7168
  v_mfma_f32_16x16x32_bf16 v[122:125], a[236:239], v[150:153], v[122:125]
  s_waitcnt lgkmcnt(3)
  v_mfma_f32_16x16x32_bf16 v[114:117], a[176:179], v[154:157], v[114:117]
  ds_read_b128 v[146:149], v2 offset:20480
  s_add_u32 s19, s34, 4096
  v_mfma_f32_16x16x32_bf16 v[122:125], a[240:243], v[154:157], v[122:125]
  buffer_load_dwordx4 v[52:55], v0, s[4:7], s19 offen offset:0 sc1
  s_waitcnt lgkmcnt(3)
  v_mfma_f32_16x16x32_bf16 v[114:117], a[180:183], v[158:161], v[114:117]
  ds_read_b128 v[150:153], v3 offset:20480
  v_mfma_f32_16x16x32_bf16 v[122:125], a[244:247], v[158:161], v[122:125]
  s_waitcnt lgkmcnt(3)
  v_mfma_f32_16x16x32_bf16 v[114:117], a[184:187], v[162:165], v[114:117]
  ds_read_b128 v[154:157], v2 offset:21504
  s_add_u32 s19, s34, 4096
  v_mfma_f32_16x16x32_bf16 v[122:125], a[248:251], v[162:165], v[122:125]
  buffer_load_dwordx4 v[56:59], v0, s[4:7], s19 offen offset:1024 sc1
  s_waitcnt lgkmcnt(3)
  v_mfma_f32_16x16x32_bf16 v[114:117], a[188:191], v[166:169], v[114:117]
  ds_read_b128 v[158:161], v3 offset:21504
  v_mfma_f32_16x16x32_bf16 v[122:125], a[252:255], v[166:169], v[122:125]
  s_waitcnt lgkmcnt(3)
  v_mfma_f32_16x16x32_bf16 v[118:121], a[160:163], v[146:149], v[118:121]
  ds_read_b128 v[162:165], v2 offset:22528
  s_add_u32 s19, s34, 6144
  v_mfma_f32_16x16x32_bf16 v[126:129], a[224:227], v[146:149], v[126:129]
  buffer_load_dwordx4 v[60:63], v0, s[4:7], s19 offen offset:0 sc1
  s_waitcnt lgkmcnt(3)
  v_mfma_f32_16x16x32_bf16 v[118:121], a[164:167], v[150:153], v[118:121]
  ds_read_b128 v[166:169], v3 offset:22528
  v_mfma_f32_16x16x32_bf16 v[126:129], a[228:231], v[150:153], v[126:129]
  s_waitcnt lgkmcnt(3)
  v_mfma_f32_16x16x32_bf16 v[118:121], a[168:171], v[154:157], v[118:121]
  ds_read_b128 v[146:149], v2 offset:23552
  s_add_u32 s19, s34, 6144
  v_mfma_f32_16x16x32_bf16 v[126:129], a[232:235], v[154:157], v[126:129]
  buffer_load_dwordx4 v[64:67], v0, s[4:7], s19 offen offset:1024 sc1
  v_mul_f32 v130, 3216550459, v114
  v_mul_f32 v131, 3216550459, v115
  v_mul_f32 v132, 3216550459, v116
  v_mul_f32 v133, 3216550459, v117
  s_waitcnt lgkmcnt(3)
  v_mfma_f32_16x16x32_bf16 v[118:121], a[172:175], v[158:161], v[118:121]
  ds_read_b128 v[150:153], v3 offset:23552
  v_exp_f32 v130, v130
  v_mfma_f32_16x16x32_bf16 v[126:129], a[236:239], v[158:161], v[126:129]
  v_exp_f32 v131, v131
  v_exp_f32 v132, v132
  v_exp_f32 v133, v133
  s_waitcnt lgkmcnt(3)
  v_mfma_f32_16x16x32_bf16 v[118:121], a[176:179], v[162:165], v[118:121]
  s_add_u32 s34, s34, 57344
  v_mul_f32 v114, v114, v122
  v_mfma_f32_16x16x32_bf16 v[126:129], a[240:243], v[162:165], v[126:129]
  v_mul_f32 v115, v115, v123
  v_mul_f32 v116, v116, v124
  v_mul_f32 v117, v117, v125
  s_waitcnt lgkmcnt(2)
  v_mfma_f32_16x16x32_bf16 v[118:121], a[180:183], v[166:169], v[118:121]
  v_add_f32 v130, 1.0, v130
  v_add_f32 v131, 1.0, v131
  v_mfma_f32_16x16x32_bf16 v[126:129], a[244:247], v[166:169], v[126:129]
  v_add_f32 v132, 1.0, v132
  v_add_f32 v133, 1.0, v133
  s_waitcnt lgkmcnt(1)
  v_mfma_f32_16x16x32_bf16 v[118:121], a[184:187], v[146:149], v[118:121]
  v_rcp_f32 v130, v130
  v_rcp_f32 v131, v131
  v_mfma_f32_16x16x32_bf16 v[126:129], a[248:251], v[146:149], v[126:129]
  v_rcp_f32 v132, v132
  v_rcp_f32 v133, v133
  s_waitcnt lgkmcnt(0)
  v_mfma_f32_16x16x32_bf16 v[118:121], a[188:191], v[150:153], v[118:121]
  v_mul_f32 v114, v114, v130
  v_mul_f32 v115, v115, v131
  v_mfma_f32_16x16x32_bf16 v[126:129], a[252:255], v[150:153], v[126:129]
  v_mul_f32 v116, v116, v132
  v_mul_f32 v117, v117, v133
  v_cvt_pk_bf16_f32 v130, v114, v115
  v_cvt_pk_bf16_f32 v131, v116, v117
  ds_write_b64 v8, v[130:131] offset:0
  v_mul_f32 v134, 3216550459, v118
  v_mul_f32 v135, 3216550459, v119
  v_mul_f32 v136, 3216550459, v120
  v_mul_f32 v137, 3216550459, v121
  v_exp_f32 v134, v134
  v_exp_f32 v135, v135
  v_exp_f32 v136, v136
  v_exp_f32 v137, v137
  v_mul_f32 v118, v118, v126
  v_mul_f32 v119, v119, v127
  v_mul_f32 v120, v120, v128
  v_mul_f32 v121, v121, v129
  v_add_f32 v134, 1.0, v134
  v_add_f32 v135, 1.0, v135
  v_add_f32 v136, 1.0, v136
  v_add_f32 v137, 1.0, v137
  v_rcp_f32 v134, v134
  v_rcp_f32 v135, v135
  v_rcp_f32 v136, v136
  v_rcp_f32 v137, v137
  v_mul_f32 v118, v118, v134
  v_mul_f32 v119, v119, v135
  v_mul_f32 v120, v120, v136
  v_mul_f32 v121, v121, v137
  v_cvt_pk_bf16_f32 v134, v118, v119
  v_cvt_pk_bf16_f32 v135, v120, v121
  ds_write_b64 v8, v[134:135] offset:2048
  s_waitcnt lgkmcnt(0)
  s_barrier
  ds_read_b128 v[84:87], v0 offset:40960
  ds_read_b128 v[88:91], v0 offset:41984
  ds_read_b128 v[92:95], v0 offset:43008
  ds_read_b128 v[96:99], v0 offset:44032
  s_waitcnt lgkmcnt(3)
  v_mfma_f32_16x16x32_bf16 v[114:117], v[84:87], v[192:195], 0
  v_mfma_f32_16x16x32_bf16 v[118:121], v[84:87], v[196:199], 0
  s_waitcnt lgkmcnt(2)
  v_mfma_f32_16x16x32_bf16 v[114:117], v[88:91], v[224:227], v[114:117]
  v_mfma_f32_16x16x32_bf16 v[118:121], v[88:91], v[228:231], v[118:121]
  v_mfma_f32_16x16x32_bf16 v[122:125], v[84:87], v[200:203], 0
  v_mfma_f32_16x16x32_bf16 v[126:129], v[84:87], v[204:207], 0
  v_mfma_f32_16x16x32_bf16 v[122:125], v[88:91], v[232:235], v[122:125]
  v_mfma_f32_16x16x32_bf16 v[126:129], v[88:91], v[236:239], v[126:129]
  v_mfma_f32_16x16x32_bf16 v[130:133], v[84:87], v[208:211], 0
  s_nop 2
  v_add_u32 v118, s26, v118
  v_and_or_b32 v118, v118, v187, s27
  v_cvt_pk_bf16_f32 v100, v114, v118
  v_mfma_f32_16x16x32_bf16 v[134:137], v[84:87], v[212:215], 0
  v_add_u32 v119, s26, v119
  v_and_or_b32 v119, v119, v187, s27
  v_cvt_pk_bf16_f32 v104, v115, v119
  v_mfma_f32_16x16x32_bf16 v[130:133], v[88:91], v[240:243], v[130:133]
  v_add_u32 v120, s26, v120
  v_and_or_b32 v120, v120, v187, s27
  v_cvt_pk_bf16_f32 v178, v116, v120
  v_mfma_f32_16x16x32_bf16 v[134:137], v[88:91], v[244:247], v[134:137]
  v_add_u32 v121, s26, v121
  v_and_or_b32 v121, v121, v187, s27
  v_cvt_pk_bf16_f32 v182, v117, v121
  v_mfma_f32_16x16x32_bf16 v[138:141], v[84:87], v[216:219], 0
  v_cvt_pk_bf16_f32 v101, v122, v126
  v_mfma_f32_16x16x32_bf16 v[142:145], v[84:87], v[220:223], 0
  v_cvt_pk_bf16_f32 v105, v123, v127
  v_mfma_f32_16x16x32_bf16 v[138:141], v[88:91], v[248:251], v[138:141]
  v_cvt_pk_bf16_f32 v179, v124, v128
  v_mfma_f32_16x16x32_bf16 v[142:145], v[88:91], v[252:255], v[142:145]
  v_cvt_pk_bf16_f32 v183, v125, v129
  s_waitcnt lgkmcnt(1)
  v_mfma_f32_16x16x32_bf16 v[146:149], v[92:95], v[192:195], 0
  v_cvt_pk_bf16_f32 v102, v130, v134
  v_mfma_f32_16x16x32_bf16 v[150:153], v[92:95], v[196:199], 0
  v_cvt_pk_bf16_f32 v106, v131, v135
  s_waitcnt lgkmcnt(0)
  v_mfma_f32_16x16x32_bf16 v[146:149], v[96:99], v[224:227], v[146:149]
  v_cvt_pk_bf16_f32 v180, v132, v136
  v_mfma_f32_16x16x32_bf16 v[150:153], v[96:99], v[228:231], v[150:153]
  v_cvt_pk_bf16_f32 v184, v133, v137
  v_mfma_f32_16x16x32_bf16 v[154:157], v[92:95], v[200:203], 0
  v_cvt_pk_bf16_f32 v103, v138, v142
  v_mfma_f32_16x16x32_bf16 v[158:161], v[92:95], v[204:207], 0
  v_cvt_pk_bf16_f32 v107, v139, v143
  v_mfma_f32_16x16x32_bf16 v[154:157], v[96:99], v[232:235], v[154:157]
  v_cvt_pk_bf16_f32 v181, v140, v144
  v_mfma_f32_16x16x32_bf16 v[158:161], v[96:99], v[236:239], v[158:161]
  v_cvt_pk_bf16_f32 v185, v141, v145
  s_add_u32 s18, s42, 0
  buffer_store_dwordx4 v[100:103], v4, s[4:7], s18 offen
  v_mfma_f32_16x16x32_bf16 v[162:165], v[92:95], v[208:211], 0
  v_add_u32 v150, s26, v150
  v_and_or_b32 v150, v150, v187, s27
  v_cvt_pk_bf16_f32 v114, v146, v150
  v_mfma_f32_16x16x32_bf16 v[166:169], v[92:95], v[212:215], 0
  v_add_u32 v151, s26, v151
  v_and_or_b32 v151, v151, v187, s27
  v_cvt_pk_bf16_f32 v118, v147, v151
  s_add_u32 s18, s42, 32768
  buffer_store_dwordx4 v[104:107], v4, s[4:7], s18 offen
  v_mfma_f32_16x16x32_bf16 v[162:165], v[96:99], v[240:243], v[162:165]
  v_add_u32 v152, s26, v152
  v_and_or_b32 v152, v152, v187, s27
  v_cvt_pk_bf16_f32 v122, v148, v152
  v_mfma_f32_16x16x32_bf16 v[166:169], v[96:99], v[244:247], v[166:169]
  v_add_u32 v153, s26, v153
  v_and_or_b32 v153, v153, v187, s27
  v_cvt_pk_bf16_f32 v126, v149, v153
  s_add_u32 s18, s42, 65536
  buffer_store_dwordx4 v[178:181], v4, s[4:7], s18 offen
  v_mfma_f32_16x16x32_bf16 v[170:173], v[92:95], v[216:219], 0
  v_cvt_pk_bf16_f32 v115, v154, v158
  v_mfma_f32_16x16x32_bf16 v[174:177], v[92:95], v[220:223], 0
  v_cvt_pk_bf16_f32 v119, v155, v159
  s_add_u32 s18, s42, 98304
  buffer_store_dwordx4 v[182:185], v4, s[4:7], s18 offen
  v_mfma_f32_16x16x32_bf16 v[170:173], v[96:99], v[248:251], v[170:173]
  v_cvt_pk_bf16_f32 v123, v156, v160
  v_mfma_f32_16x16x32_bf16 v[174:177], v[96:99], v[252:255], v[174:177]
  v_cvt_pk_bf16_f32 v127, v157, v161
  v_cvt_pk_bf16_f32 v116, v162, v166
  v_cvt_pk_bf16_f32 v120, v163, v167
  v_cvt_pk_bf16_f32 v124, v164, v168
  v_cvt_pk_bf16_f32 v128, v165, v169
  s_nop 2
  v_cvt_pk_bf16_f32 v117, v170, v174
  v_cvt_pk_bf16_f32 v121, v171, v175
  v_cvt_pk_bf16_f32 v125, v172, v176
  v_cvt_pk_bf16_f32 v129, v173, v177
  s_add_u32 s18, s42, 524288
  buffer_store_dwordx4 v[114:117], v4, s[4:7], s18 offen
  s_add_u32 s18, s42, 557056
  buffer_store_dwordx4 v[118:121], v4, s[4:7], s18 offen
  s_add_u32 s18, s42, 589824
  buffer_store_dwordx4 v[122:125], v4, s[4:7], s18 offen
  s_add_u32 s18, s42, 622592
  buffer_store_dwordx4 v[126:129], v4, s[4:7], s18 offen
  s_waitcnt vmcnt(2)
  s_cmp_lg_u32 s16, 1
  s_cbranch_scc1 L_ns_cfast
  s_waitcnt vmcnt(0)
  v_mov_b32 v114, s16
  buffer_store_dword v114, off, s[4:7], s31 offset:1024
L_ns_cfast:
L_noffn_fast:
  s_cmp_lg_u32 s16, 1
  s_cbranch_scc1 L_nf_cfast
  v_lshrrev_b32 v115, 2, v0
  v_min_u32 v115, 108, v115
L_pf_cfast:
  buffer_load_dword v114, v115, s[4:7], s30 offen offset:1024 sc1
  s_add_u32 s24, s24, 1
  s_cmp_gt_u32 s24, 0x200000
  s_cbranch_scc1 L_bail
  s_waitcnt vmcnt(0)
  v_cmp_gt_u32 vcc, s16, v114
  s_cbranch_vccnz L_pf_cfast
L_nf_cfast:
  s_add_u32 s18, s42, 0
  buffer_load_dwordx4 v[122:125], v5, s[4:7], s18 offen sc1
  s_add_u32 s18, s42, 4096
  buffer_load_dwordx4 v[126:129], v5, s[4:7], s18 offen sc1
  s_add_u32 s18, s42, 8192
  buffer_load_dwordx4 v[130:133], v5, s[4:7], s18 offen sc1
  s_add_u32 s18, s42, 12288
  buffer_load_dwordx4 v[134:137], v5, s[4:7], s18 offen sc1
  s_add_u32 s18, s42, 16384
  buffer_load_dwordx4 v[138:141], v5, s[4:7], s18 offen sc1
  s_add_u32 s18, s42, 20480
  buffer_load_dwordx4 v[142:145], v5, s[4:7], s18 offen sc1
  s_add_u32 s18, s42, 24576
  buffer_load_dwordx4 v[146:149], v5, s[4:7], s18 offen sc1
  s_add_u32 s24, s24, 1
  s_cmp_gt_u32 s24, 0x200000
  s_cbranch_scc1 L_bail
  s_waitcnt vmcnt(6)
  v_mfma_f32_16x16x32_bf16 v[114:117], v[12:15], v[122:125], 0
  v_xor_b32 v118, s27, v122
  s_waitcnt vmcnt(5)
  v_mfma_f32_16x16x32_bf16 v[114:117], v[12:15], v[126:129], v[114:117]
  v_bitop3_b32 v118, v118, v126, s27 bitop3:0xf6
  s_waitcnt vmcnt(4)
  v_mfma_f32_16x16x32_bf16 v[114:117], v[12:15], v[130:133], v[114:117]
  v_bitop3_b32 v118, v118, v130, s27 bitop3:0xf6
  s_waitcnt vmcnt(3)
  v_mfma_f32_16x16x32_bf16 v[114:117], v[12:15], v[134:137], v[114:117]
  v_bitop3_b32 v118, v118, v134, s27 bitop3:0xf6
  s_waitcnt vmcnt(2)
  v_mfma_f32_16x16x32_bf16 v[114:117], v[12:15], v[138:141], v[114:117]
  v_bitop3_b32 v118, v118, v138, s27 bitop3:0xf6
  s_waitcnt vmcnt(1)
  v_mfma_f32_16x16x32_bf16 v[114:117], v[12:15], v[142:145], v[114:117]
  v_bitop3_b32 v118, v118, v142, s27 bitop3:0xf6
  s_waitcnt vmcnt(0)
  v_mfma_f32_16x16x32_bf16 v[114:117], v[12:15], v[146:149], v[114:117]
  v_bitop3_b32 v118, v118, v146, s27 bitop3:0xf6
  v_and_b32 v118, 0x10000, v118
  v_cmp_ne_u32 vcc, 0, v118
  s_cbranch_vccnz L_nf_cfast
  s_nop 3
  v_add_f32 v114, v114, v108
  v_add_f32 v115, v115, v109
  v_add_f32 v116, v116, v110
  v_add_f32 v117, v117, v111
  v_cvt_pk_bf16_f32 v114, v114, v115
  v_cvt_pk_bf16_f32 v115, v116, v117
  buffer_store_dwordx2 v[114:115], v6, s[72:75], s76 offen
  s_add_u32 s76, s76, 229376
  s_add_u32 s17, s17, 7
  s_add_u32 s16, s16, 1
  s_cmp_le_u32 s16, s15
  s_cbranch_scc1 L_p2top_fast
  s_endpgm
L_skip_fast:
  s_add_u32 s19, s34, 0
  buffer_load_dwordx4 v[36:39], v0, s[4:7], s19 offen offset:0 sc1
  s_add_u32 s19, s34, 0
  buffer_load_dwordx4 v[40:43], v0, s[4:7], s19 offen offset:1024 sc1
  s_add_u32 s19, s34, 2048
  buffer_load_dwordx4 v[44:47], v0, s[4:7], s19 offen offset:0 sc1
  s_add_u32 s19, s34, 2048
  buffer_load_dwordx4 v[48:51], v0, s[4:7], s19 offen offset:1024 sc1
  s_add_u32 s19, s34, 4096
  buffer_load_dwordx4 v[52:55], v0, s[4:7], s19 offen offset:0 sc1
  s_add_u32 s19, s34, 4096
  buffer_load_dwordx4 v[56:59], v0, s[4:7], s19 offen offset:1024 sc1
  s_add_u32 s19, s34, 6144
  buffer_load_dwordx4 v[60:63], v0, s[4:7], s19 offen offset:0 sc1
  s_add_u32 s19, s34, 6144
  buffer_load_dwordx4 v[64:67], v0, s[4:7], s19 offen offset:1024 sc1
  s_add_u32 s34, s34, 57344
  s_sleep 8
  s_branch L_noffn_fast
L_p2_slow:
  s_add_u32 s19, s33, 0
  buffer_load_dwordx4 v[20:23], v0, s[4:7], s19 offen sc1
  s_add_u32 s19, s33, 2048
  buffer_load_dwordx4 v[24:27], v0, s[4:7], s19 offen sc1
  s_add_u32 s19, s33, 4096
  buffer_load_dwordx4 v[28:31], v0, s[4:7], s19 offen sc1
  s_add_u32 s19, s33, 6144
  buffer_load_dwordx4 v[32:35], v0, s[4:7], s19 offen sc1
  s_xor_b32 s19, s35, 0
  buffer_load_dwordx4 v[68:71], v0, s[4:7], s19 offen offset:0 sc1
  s_xor_b32 s19, s35, 0
  buffer_load_dwordx4 v[72:75], v0, s[4:7], s19 offen offset:1024 sc1
  s_xor_b32 s19, s35, 2048
  buffer_load_dwordx4 v[76:79], v0, s[4:7], s19 offen offset:0 sc1
  s_xor_b32 s19, s35, 2048
  buffer_load_dwordx4 v[80:83], v0, s[4:7], s19 offen offset:1024 sc1
  s_add_u32 s33, s33, 57344
  s_add_u32 s35, s35, 57344
  s_add_u32 s19, s34, 0
  buffer_load_dwordx4 v[36:39], v0, s[4:7], s19 offen offset:0 sc1
  s_add_u32 s19, s34, 0
  buffer_load_dwordx4 v[40:43], v0, s[4:7], s19 offen offset:1024 sc1
  s_add_u32 s19, s34, 2048
  buffer_load_dwordx4 v[44:47], v0, s[4:7], s19 offen offset:0 sc1
  s_add_u32 s19, s34, 2048
  buffer_load_dwordx4 v[48:51], v0, s[4:7], s19 offen offset:1024 sc1
  s_add_u32 s19, s34, 4096
  buffer_load_dwordx4 v[52:55], v0, s[4:7], s19 offen offset:0 sc1
  s_add_u32 s19, s34, 4096
  buffer_load_dwordx4 v[56:59], v0, s[4:7], s19 offen offset:1024 sc1
  s_add_u32 s19, s34, 6144
  buffer_load_dwordx4 v[60:63], v0, s[4:7], s19 offen offset:0 sc1
  s_add_u32 s19, s34, 6144
  buffer_load_dwordx4 v[64:67], v0, s[4:7], s19 offen offset:1024 sc1
  s_add_u32 s34, s34, 57344
L_p2top_slow:
  buffer_load_dwordx2 v[112:113], v9, s[8:11], s76 offen
  s_waitcnt vmcnt(8)
  v_mfma_f32_16x16x32_bf16 v[118:121], v[36:39], v[20:23], 0
  s_waitcnt vmcnt(7)
  v_mfma_f32_16x16x32_bf16 v[122:125], v[40:43], v[20:23], 0
  s_waitcnt vmcnt(6)
  v_mfma_f32_16x16x32_bf16 v[118:121], v[44:47], v[24:27], v[118:121]
  s_waitcnt vmcnt(5)
  v_mfma_f32_16x16x32_bf16 v[122:125], v[48:51], v[24:27], v[122:125]
  s_waitcnt vmcnt(4)
  v_mfma_f32_16x16x32_bf16 v[118:121], v[52:55], v[28:31], v[118:121]
  s_waitcnt vmcnt(3)
  v_mfma_f32_16x16x32_bf16 v[122:125], v[56:59], v[28:31], v[122:125]
  s_waitcnt vmcnt(2)
  v_mfma_f32_16x16x32_bf16 v[118:121], v[60:63], v[32:35], v[118:121]
  s_waitcnt vmcnt(1)
  v_mfma_f32_16x16x32_bf16 v[122:125], v[64:67], v[32:35], v[122:125]
  v_mov_b32 v130, s23
  s_nop 4
  v_cndmask_b32 v118, v130, v118, s[78:79]
  v_cndmask_b32 v119, v130, v119, s[80:81]
  v_cndmask_b32 v120, v130, v120, s[82:83]
  v_cndmask_b32 v121, v130, v121, s[84:85]
  v_cndmask_b32 v122, v130, v122, s[86:87]
  v_cndmask_b32 v123, v130, v123, s[88:89]
  v_cndmask_b32 v124, v130, v124, s[90:91]
  v_cndmask_b32 v125, v130, v125, s[20:21]
  v_max3_f32 v130, v118, v119, v120
  v_max3_f32 v130, v130, v121, v122
  v_max3_f32 v130, v130, v123, v124
  v_max_f32 v130, v130, v125
L_xl_slow:
  buffer_load_dwordx4 v[100:103], v0, s[4:7], s36 offen sc1
  s_xor_b32 s18, s36, 1024
  buffer_load_dwordx4 v[104:107], v0, s[4:7], s18 offen sc1
  s_add_u32 s24, s24, 1
  s_cmp_gt_u32 s24, 0x200000
  s_cbranch_scc1 L_bail
  s_waitcnt vmcnt(0)
  v_max_u32 v114, v100, v104
  v_cmp_eq_u32 vcc, -1, v114
  s_cbranch_vccz L_xd_slow
  s_cmp_eq_u32 s16, s15
  s_cbranch_scc1 L_xq_slow
  s_sleep 12
L_xq_slow:
  s_sleep 1
  s_branch L_xl_slow
L_xd_slow:
  ds_write2st64_b32 v189, v101, v103 offset0:0 offset1:2
  s_add_u32 s36, s36, 28672
  s_waitcnt lgkmcnt(0)
  s_barrier
  ds_read_b64_tr_b16 v[84:85], v190 offset:0
  ds_read_b64_tr_b16 v[86:87], v190 offset:512
  ds_read_b64_tr_b16 v[88:89], v190 offset:128
  ds_read_b64_tr_b16 v[90:91], v190 offset:640
  ds_read_b64_tr_b16 v[92:93], v190 offset:256
  ds_read_b64_tr_b16 v[94:95], v190 offset:768
  ds_read_b64_tr_b16 v[96:97], v190 offset:384
  ds_read_b64_tr_b16 v[98:99], v190 offset:896
  s_waitcnt lgkmcnt(6)
  v_mfma_f32_16x16x32_bf16 v[126:129], v[84:87], v[20:23], 0
  s_waitcnt lgkmcnt(4)
  v_mfma_f32_16x16x32_bf16 v[126:129], v[88:91], v[24:27], v[126:129]
  s_waitcnt lgkmcnt(2)
  v_mfma_f32_16x16x32_bf16 v[126:129], v[92:95], v[28:31], v[126:129]
  s_waitcnt lgkmcnt(0)
  v_mfma_f32_16x16x32_bf16 v[126:129], v[96:99], v[32:35], v[126:129]
  s_nop 7
  v_mul_f32 v126, s22, v126
  v_mul_f32 v127, s22, v127
  v_max3_f32 v130, v130, v126, v127
  v_mov_b32 v131, v130
  s_nop 1
  v_permlane16_swap_b32 v130, v131
  v_max_f32 v130, v130, v131
  v_mov_b32 v131, v130
  s_nop 1
  v_permlane32_swap_b32 v130, v131
  v_max_f32 v130, v130, v131
  v_sub_f32 v118, v118, v130
  v_sub_f32 v119, v119, v130
  v_sub_f32 v120, v120, v130
  v_sub_f32 v121, v121, v130
  v_sub_f32 v122, v122, v130
  v_sub_f32 v123, v123, v130
  v_sub_f32 v124, v124, v130
  v_sub_f32 v125, v125, v130
  v_sub_f32 v126, v126, v130
  v_sub_f32 v127, v127, v130
  v_exp_f32 v118, v118
  v_exp_f32 v119, v119
  v_exp_f32 v120, v120
  v_exp_f32 v121, v121
  v_exp_f32 v122, v122
  v_exp_f32 v123, v123
  v_exp_f32 v124, v124
  v_exp_f32 v125, v125
  v_exp_f32 v126, v126
  v_exp_f32 v127, v127
  v_cvt_pk_bf16_f32 v134, v118, v119
  v_cvt_pk_bf16_f32 v135, v122, v123
  v_cvt_pk_bf16_f32 v136, v120, v121
  v_cvt_pk_bf16_f32 v137, v124, v125
  v_cvt_pk_bf16_f32 v10, v126, v127
  s_nop 0
  v_mfma_f32_16x16x32_bf16 v[138:141], v[16:19], v[134:137], 0
  v_mfma_f32_16x16x32_bf16 v[142:145], v[68:71], v[134:137], 0
  v_mfma_f32_16x16x32_bf16 v[146:149], v[72:75], v[134:137], 0
  v_mfma_f32_16x16x32_bf16 v[150:153], v[76:79], v[134:137], 0
  v_mfma_f32_16x16x32_bf16 v[154:157], v[80:83], v[134:137], 0
  s_nop 1
  v_mfma_f32_16x16x16_bf16 v[138:141], v[16:17], v[10:11], v[138:141]
  v_mfma_f32_16x16x16_bf16 v[142:145], v[100:101], v[10:11], v[142:145]
  v_mfma_f32_16x16x16_bf16 v[146:149], v[102:103], v[10:11], v[146:149]
  v_mfma_f32_16x16x16_bf16 v[150:153], v[104:105], v[10:11], v[150:153]
  v_mfma_f32_16x16x16_bf16 v[154:157], v[106:107], v[10:11], v[154:157]
  s_nop 3
  v_rcp_f32 v138, v138
  s_nop 0
  v_mul_f32 v142, v142, v138
  v_mul_f32 v143, v143, v138
  v_mul_f32 v144, v144, v138
  v_mul_f32 v145, v145, v138
  v_mul_f32 v146, v146, v138
  v_mul_f32 v147, v147, v138
  v_mul_f32 v148, v148, v138
  v_mul_f32 v149, v149, v138
  v_mul_f32 v150, v150, v138
  v_mul_f32 v151, v151, v138
  v_mul_f32 v152, v152, v138
  v_mul_f32 v153, v153, v138
  v_mul_f32 v154, v154, v138
  v_mul_f32 v155, v155, v138
  v_mul_f32 v156, v156, v138
  v_mul_f32 v157, v157, v138
  v_cvt_pk_bf16_f32 v118, v142, v146
  v_cvt_pk_bf16_f32 v119, v143, v147
  v_cvt_pk_bf16_f32 v120, v144, v148
  v_cvt_pk_bf16_f32 v121, v145, v149
  ds_write_b128 v7, v[118:121]
  v_cvt_pk_bf16_f32 v122, v150, v154
  v_cvt_pk_bf16_f32 v123, v151, v155
  v_cvt_pk_bf16_f32 v124, v152, v156
  v_cvt_pk_bf16_f32 v125, v153, v157
  ds_write_b128 v188, v[122:125]
  s_waitcnt lgkmcnt(0)
  s_barrier
  ds_read_b128 v[36:39], v0 offset:32768
  ds_read_b128 v[40:43], v0 offset:33792
  ds_read_b128 v[44:47], v0 offset:34816
  ds_read_b128 v[48:51], v0 offset:35840
  ds_read_b128 v[52:55], v0 offset:36864
  ds_read_b128 v[56:59], v0 offset:37888
  ds_read_b128 v[60:63], v0 offset:38912
  ds_read_b128 v[64:67], v0 offset:39936
  s_and_b32 s27, s16, 1
  s_lshl_b32 s27, s27, 16
  s_xor_b32 s26, s27, 0x10000
  s_cmp_lt_u32 s16, s15
  s_cselect_b32 s18, 0, 57344
  s_sub_u32 s33, s33, s18
  s_sub_u32 s34, s34, s18
  s_sub_u32 s35, s35, s18
  s_waitcnt lgkmcnt(7)
  v_mfma_f32_16x16x32_bf16 v[114:117], v[36:39], a[0:3], 0
  v_mfma_f32_16x16x32_bf16 v[118:121], v[36:39], a[4:7], 0
  s_add_u32 s19, s33, 0
  buffer_load_dwordx4 v[20:23], v0, s[4:7], s19 offen sc1
  s_waitcnt lgkmcnt(6)
  v_mfma_f32_16x16x32_bf16 v[114:117], v[40:43], a[32:35], v[114:117]
  v_mfma_f32_16x16x32_bf16 v[118:121], v[40:43], a[36:39], v[118:121]
  s_waitcnt lgkmcnt(5)
  v_mfma_f32_16x16x32_bf16 v[114:117], v[44:47], a[64:67], v[114:117]
  v_mfma_f32_16x16x32_bf16 v[118:121], v[44:47], a[68:71], v[118:121]
  s_add_u32 s19, s33, 2048
  buffer_load_dwordx4 v[24:27], v0, s[4:7], s19 offen sc1
  s_waitcnt lgkmcnt(4)
  v_mfma_f32_16x16x32_bf16 v[114:117], v[48:51], a[96:99], v[114:117]
  v_mfma_f32_16x16x32_bf16 v[118:121], v[48:51], a[100:103], v[118:121]
  v_mfma_f32_16x16x32_bf16 v[122:125], v[36:39], a[8:11], 0
  v_mfma_f32_16x16x32_bf16 v[126:129], v[36:39], a[12:15], 0
  s_add_u32 s19, s33, 4096
  buffer_load_dwordx4 v[28:31], v0, s[4:7], s19 offen sc1
  v_mfma_f32_16x16x32_bf16 v[122:125], v[40:43], a[40:43], v[122:125]
  v_mfma_f32_16x16x32_bf16 v[126:129], v[40:43], a[44:47], v[126:129]
  s_nop 1
  v_add_u32 v118, s26, v118
  v_and_or_b32 v118, v118, v187, s27
  v_cvt_pk_bf16_f32 v84, v114, v118
  v_mfma_f32_16x16x32_bf16 v[122:125], v[44:47], a[72:75], v[122:125]
  v_add_u32 v119, s26, v119
  v_and_or_b32 v119, v119, v187, s27
  v_cvt_pk_bf16_f32 v88, v115, v119
  v_mfma_f32_16x16x32_bf16 v[126:129], v[44:47], a[76:79], v[126:129]
  v_add_u32 v120, s26, v120
  v_and_or_b32 v120, v120, v187, s27
  s_add_u32 s19, s33, 6144
  buffer_load_dwordx4 v[32:35], v0, s[4:7], s19 offen sc1
  v_mfma_f32_16x16x32_bf16 v[122:125], v[48:51], a[104:107], v[122:125]
  v_cvt_pk_bf16_f32 v92, v116, v120
  v_add_u32 v121, s26, v121
  v_mfma_f32_16x16x32_bf16 v[126:129], v[48:51], a[108:111], v[126:129]
  v_and_or_b32 v121, v121, v187, s27
  v_cvt_pk_bf16_f32 v96, v117, v121
  v_mfma_f32_16x16x32_bf16 v[130:133], v[36:39], a[16:19], 0
  v_mfma_f32_16x16x32_bf16 v[134:137], v[36:39], a[20:23], 0
  s_xor_b32 s19, s35, 0
  buffer_load_dwordx4 v[68:71], v0, s[4:7], s19 offen offset:0 sc1
  v_mfma_f32_16x16x32_bf16 v[130:133], v[40:43], a[48:51], v[130:133]
  v_mfma_f32_16x16x32_bf16 v[134:137], v[40:43], a[52:55], v[134:137]
  v_cvt_pk_bf16_f32 v85, v122, v126
  v_mfma_f32_16x16x32_bf16 v[130:133], v[44:47], a[80:83], v[130:133]
  v_cvt_pk_bf16_f32 v89, v123, v127
  v_mfma_f32_16x16x32_bf16 v[134:137], v[44:47], a[84:87], v[134:137]
  v_cvt_pk_bf16_f32 v93, v124, v128
  s_xor_b32 s19, s35, 0
  buffer_load_dwordx4 v[72:75], v0, s[4:7], s19 offen offset:1024 sc1
  v_mfma_f32_16x16x32_bf16 v[130:133], v[48:51], a[112:115], v[130:133]
  v_cvt_pk_bf16_f32 v97, v125, v129
  v_mfma_f32_16x16x32_bf16 v[134:137], v[48:51], a[116:119], v[134:137]
  v_mfma_f32_16x16x32_bf16 v[138:141], v[36:39], a[24:27], 0
  v_mfma_f32_16x16x32_bf16 v[142:145], v[36:39], a[28:31], 0
  s_xor_b32 s19, s35, 2048
  buffer_load_dwordx4 v[76:79], v0, s[4:7], s19 offen offset:0 sc1
  v_mfma_f32_16x16x32_bf16 v[138:141], v[40:43], a[56:59], v[138:141]
  v_mfma_f32_16x16x32_bf16 v[142:145], v[40:43], a[60:63], v[142:145]
  s_nop 1
  v_cvt_pk_bf16_f32 v86, v130, v134
  v_mfma_f32_16x16x32_bf16 v[138:141], v[44:47], a[88:91], v[138:141]
  v_cvt_pk_bf16_f32 v90, v131, v135
  v_mfma_f32_16x16x32_bf16 v[142:145], v[44:47], a[92:95], v[142:145]
  v_cvt_pk_bf16_f32 v94, v132, v136
  s_xor_b32 s19, s35, 2048
  buffer_load_dwordx4 v[80:83], v0, s[4:7], s19 offen offset:1024 sc1
  v_mfma_f32_16x16x32_bf16 v[138:141], v[48:51], a[120:123], v[138:141]
  v_cvt_pk_bf16_f32 v98, v133, v137
  v_mfma_f32_16x16x32_bf16 v[142:145], v[48:51], a[124:127], v[142:145]
  s_waitcnt lgkmcnt(3)
  v_mfma_f32_16x16x32_bf16 v[146:149], v[52:55], a[0:3], 0
  v_mfma_f32_16x16x32_bf16 v[150:153], v[52:55], a[4:7], 0
  s_add_u32 s33, s33, 57344
  s_add_u32 s35, s35, 57344
  s_waitcnt lgkmcnt(2)
  v_mfma_f32_16x16x32_bf16 v[146:149], v[56:59], a[32:35], v[146:149]
  v_mfma_f32_16x16x32_bf16 v[150:153], v[56:59], a[36:39], v[150:153]
  v_cvt_pk_bf16_f32 v87, v138, v142
  s_waitcnt lgkmcnt(1)
  v_mfma_f32_16x16x32_bf16 v[146:149], v[60:63], a[64:67], v[146:149]
  v_cvt_pk_bf16_f32 v91, v139, v143
  v_mfma_f32_16x16x32_bf16 v[150:153], v[60:63], a[68:71], v[150:153]
  v_cvt_pk_bf16_f32 v95, v140, v144
  s_waitcnt lgkmcnt(0)
  v_mfma_f32_16x16x32_bf16 v[146:149], v[64:67], a[96:99], v[146:149]
  v_cvt_pk_bf16_f32 v99, v141, v145
  s_add_u32 s18, s39, 0
  buffer_store_dwordx4 v[84:87], v4, s[4:7], s18 offen sc1
  v_mfma_f32_16x16x32_bf16 v[150:153], v[64:67], a[100:103], v[150:153]
  v_mfma_f32_16x16x32_bf16 v[154:157], v[52:55], a[8:11], 0
  v_mfma_f32_16x16x32_bf16 v[158:161], v[52:55], a[12:15], 0
  v_mfma_f32_16x16x32_bf16 v[154:157], v[56:59], a[40:43], v[154:157]
  v_mfma_f32_16x16x32_bf16 v[158:161], v[56:59], a[44:47], v[158:161]
  s_nop 3
  v_add_u32 v150, s26, v150
  v_and_or_b32 v150, v150, v187, s27
  v_cvt_pk_bf16_f32 v114, v146, v150
  s_add_u32 s18, s39, 32768
  buffer_store_dwordx4 v[88:91], v4, s[4:7], s18 offen sc1
  v_mfma_f32_16x16x32_bf16 v[154:157], v[60:63], a[72:75], v[154:157]
  v_add_u32 v151, s26, v151
  v_and_or_b32 v151, v151, v187, s27
  v_cvt_pk_bf16_f32 v118, v147, v151
  v_mfma_f32_16x16x32_bf16 v[158:161], v[60:63], a[76:79], v[158:161]
  v_add_u32 v152, s26, v152
  v_and_or_b32 v152, v152, v187, s27
  v_mfma_f32_16x16x32_bf16 v[154:157], v[64:67], a[104:107], v[154:157]
  v_cvt_pk_bf16_f32 v122, v148, v152
  v_add_u32 v153, s26, v153
  v_mfma_f32_16x16x32_bf16 v[158:161], v[64:67], a[108:111], v[158:161]
  v_and_or_b32 v153, v153, v187, s27
  v_cvt_pk_bf16_f32 v126, v149, v153
  v_mfma_f32_16x16x32_bf16 v[162:165], v[52:55], a[16:19], 0
  s_add_u32 s18, s39, 65536
  buffer_store_dwordx4 v[92:95], v4, s[4:7], s18 offen sc1
  v_mfma_f32_16x16x32_bf16 v[166:169], v[52:55], a[20:23], 0
  v_mfma_f32_16x16x32_bf16 v[162:165], v[56:59], a[48:51], v[162:165]
  v_mfma_f32_16x16x32_bf16 v[166:169], v[56:59], a[52:55], v[166:169]
  v_cvt_pk_bf16_f32 v115, v154, v158
  v_mfma_f32_16x16x32_bf16 v[162:165], v[60:63], a[80:83], v[162:165]
  v_cvt_pk_bf16_f32 v119, v155, v159
  v_mfma_f32_16x16x32_bf16 v[166:169], v[60:63], a[84:87], v[166:169]
  v_cvt_pk_bf16_f32 v123, v156, v160
  s_add_u32 s18, s39, 98304
  buffer_store_dwordx4 v[96:99], v4, s[4:7], s18 offen sc1
  v_mfma_f32_16x16x32_bf16 v[162:165], v[64:67], a[112:115], v[162:165]
  v_cvt_pk_bf16_f32 v127, v157, v161
  v_mfma_f32_16x16x32_bf16 v[166:169], v[64:67], a[116:119], v[166:169]
  v_mfma_f32_16x16x32_bf16 v[170:173], v[52:55], a[24:27], 0
  v_mfma_f32_16x16x32_bf16 v[174:177], v[52:55], a[28:31], 0
  v_mfma_f32_16x16x32_bf16 v[170:173], v[56:59], a[56:59], v[170:173]
  v_mfma_f32_16x16x32_bf16 v[174:177], v[56:59], a[60:63], v[174:177]
  s_nop 3
  v_cvt_pk_bf16_f32 v116, v162, v166
  v_mfma_f32_16x16x32_bf16 v[170:173], v[60:63], a[88:91], v[170:173]
  v_cvt_pk_bf16_f32 v120, v163, v167
  v_mfma_f32_16x16x32_bf16 v[174:177], v[60:63], a[92:95], v[174:177]
  v_cvt_pk_bf16_f32 v124, v164, v168
  v_mfma_f32_16x16x32_bf16 v[170:173], v[64:67], a[120:123], v[170:173]
  v_cvt_pk_bf16_f32 v128, v165, v169
  v_mfma_f32_16x16x32_bf16 v[174:177], v[64:67], a[124:127], v[174:177]
  s_nop 7
  v_cvt_pk_bf16_f32 v117, v170, v174
  v_cvt_pk_bf16_f32 v121, v171, v175
  v_cvt_pk_bf16_f32 v125, v172, v176
  v_cvt_pk_bf16_f32 v129, v173, v177
  s_add_u32 s18, s39, 524288
  buffer_store_dwordx4 v[114:117], v4, s[4:7], s18 offen sc1
  s_add_u32 s18, s39, 557056
  buffer_store_dwordx4 v[118:121], v4, s[4:7], s18 offen sc1
  s_add_u32 s18, s39, 589824
  buffer_store_dwordx4 v[122:125], v4, s[4:7], s18 offen sc1
  s_add_u32 s18, s39, 622592
  buffer_store_dwordx4 v[126:129], v4, s[4:7], s18 offen sc1
  s_waitcnt vmcnt(2)
  s_cmp_lg_u32 s16, 1
  s_cbranch_scc1 L_ns_aslow
  s_waitcnt vmcnt(0)
  v_mov_b32 v114, s16
  buffer_store_dword v114, off, s[4:7], s31 offset:0 sc1
L_ns_aslow:
  s_cmp_lg_u32 s16, 1
  s_cbranch_scc1 L_nf_aslow
  v_lshrrev_b32 v115, 2, v0
  v_min_u32 v115, 124, v115
L_pf_aslow:
  buffer_load_dword v114, v115, s[4:7], s30 offen offset:0 sc1
  s_add_u32 s24, s24, 1
  s_cmp_gt_u32 s24, 0x200000
  s_cbranch_scc1 L_bail
  s_waitcnt vmcnt(0)
  v_cmp_gt_u32 vcc, s16, v114
  s_cbranch_vccnz L_pf_aslow
L_nf_aslow:
  s_add_u32 s18, s39, 0
  buffer_load_dwordx4 v[122:125], v5, s[4:7], s18 offen sc1
  s_add_u32 s18, s39, 4096
  buffer_load_dwordx4 v[126:129], v5, s[4:7], s18 offen sc1
  s_add_u32 s18, s39, 8192
  buffer_load_dwordx4 v[130:133], v5, s[4:7], s18 offen sc1
  s_add_u32 s18, s39, 12288
  buffer_load_dwordx4 v[134:137], v5, s[4:7], s18 offen sc1
  s_add_u32 s18, s39, 16384
  buffer_load_dwordx4 v[138:141], v5, s[4:7], s18 offen sc1
  s_add_u32 s18, s39, 20480
  buffer_load_dwordx4 v[142:145], v5, s[4:7], s18 offen sc1
  s_add_u32 s18, s39, 24576
  buffer_load_dwordx4 v[146:149], v5, s[4:7], s18 offen sc1
  s_add_u32 s18, s39, 28672
  buffer_load_dwordx4 v[150:153], v5, s[4:7], s18 offen sc1
  s_add_u32 s24, s24, 1
  s_cmp_gt_u32 s24, 0x200000
  s_cbranch_scc1 L_bail
  s_waitcnt vmcnt(7)
  v_mfma_f32_16x16x32_bf16 v[114:117], v[12:15], v[122:125], 0
  v_xor_b32 v118, s27, v122
  s_waitcnt vmcnt(6)
  v_mfma_f32_16x16x32_bf16 v[114:117], v[12:15], v[126:129], v[114:117]
  v_bitop3_b32 v118, v118, v126, s27 bitop3:0xf6
  s_waitcnt vmcnt(5)
  v_mfma_f32_16x16x32_bf16 v[114:117], v[12:15], v[130:133], v[114:117]
  v_bitop3_b32 v118, v118, v130, s27 bitop3:0xf6
  s_waitcnt vmcnt(4)
  v_mfma_f32_16x16x32_bf16 v[114:117], v[12:15], v[134:137], v[114:117]
  v_bitop3_b32 v118, v118, v134, s27 bitop3:0xf6
  s_waitcnt vmcnt(3)
  v_mfma_f32_16x16x32_bf16 v[114:117], v[12:15], v[138:141], v[114:117]
  v_bitop3_b32 v118, v118, v138, s27 bitop3:0xf6
  s_waitcnt vmcnt(2)
  v_mfma_f32_16x16x32_bf16 v[114:117], v[12:15], v[142:145], v[114:117]
  v_bitop3_b32 v118, v118, v142, s27 bitop3:0xf6
  s_waitcnt vmcnt(1)
  v_mfma_f32_16x16x32_bf16 v[114:117], v[12:15], v[146:149], v[114:117]
  v_bitop3_b32 v118, v118, v146, s27 bitop3:0xf6
  s_waitcnt vmcnt(0)
  v_mfma_f32_16x16x32_bf16 v[114:117], v[12:15], v[150:153], v[114:117]
  v_bitop3_b32 v118, v118, v150, s27 bitop3:0xf6
  v_and_b32 v118, 0x10000, v118
  v_cmp_ne_u32 vcc, 0, v118
  s_cbranch_vccnz L_nf_aslow
  v_lshlrev_b32 v108, 16, v112
  v_and_b32 v109, 0xffff0000, v112
  v_lshlrev_b32 v110, 16, v113
  v_and_b32 v111, 0xffff0000, v113
  v_add_f32 v108, v108, v114
  v_add_f32 v109, v109, v115
  v_add_f32 v110, v110, v116
  v_add_f32 v111, v111, v117
  v_cvt_pk_bf16_f32 v114, v108, v109
  v_cvt_pk_bf16_f32 v115, v110, v111
  v_lshlrev_b32 v108, 16, v114
  v_and_b32 v109, 0xffff0000, v114
  v_lshlrev_b32 v110, 16, v115
  v_and_b32 v111, 0xffff0000, v115
  v_readfirstlane_b32 s25, v108
  s_nop 1
  v_subrev_f32 v114, s25, v108
  v_subrev_f32 v115, s25, v109
  v_subrev_f32 v116, s25, v110
  v_subrev_f32 v117, s25, v111
  v_add_f32 v118, v114, v115
  v_mul_f32 v120, v114, v114
  v_add_f32 v119, v116, v117
  v_fmac_f32 v120, v115, v115
  v_add_f32 v118, v118, v119
  v_fmac_f32 v120, v116, v116
  v_fmac_f32 v120, v117, v117
  v_add_f32_dpp v118, v118, v118 row_ror:8 row_mask:0xf bank_mask:0xf
  s_nop 0
  v_add_f32_dpp v120, v120, v120 row_ror:8 row_mask:0xf bank_mask:0xf
  v_add_f32_dpp v118, v118, v118 row_ror:4 row_mask:0xf bank_mask:0xf
  s_nop 0
  v_add_f32_dpp v120, v120, v120 row_ror:4 row_mask:0xf bank_mask:0xf
  v_add_f32_dpp v118, v118, v118 row_ror:2 row_mask:0xf bank_mask:0xf
  s_nop 0
  v_add_f32_dpp v120, v120, v120 row_ror:2 row_mask:0xf bank_mask:0xf
  v_add_f32_dpp v118, v118, v118 row_ror:1 row_mask:0xf bank_mask:0xf
  s_nop 0
  v_add_f32_dpp v120, v120, v120 row_ror:1 row_mask:0xf bank_mask:0xf
  v_mov_b32 v119, v118
  v_mov_b32 v121, v120
  s_nop 0
  v_permlane16_swap_b32 v118, v119
  v_permlane16_swap_b32 v120, v121
  v_add_f32 v118, v118, v119
  v_add_f32 v120, v120, v121
  v_mul_f32 v119, 1006632960, v118
  s_lshl_b32 s18, s13, 3
  v_mov_b32 v121, s18
  v_fma_f32 v120, -v119, v118, v120
  v_add_f32 v118, s25, v119
  v_mov_b32 v119, v120
  ds_write_b64 v121, v[118:119] offset:45056
  s_waitcnt lgkmcnt(0)
  s_barrier
  ds_read_b128 v[122:125], v11 offset:45056
  ds_read_b128 v[126:129], v11 offset:45072
  s_waitcnt lgkmcnt(1)
  v_add_f32 v118, v122, v124
  v_add_f32 v120, v123, v125
  s_waitcnt lgkmcnt(0)
  v_add_f32 v119, v126, v128
  v_add_f32 v121, v127, v129
  v_add_f32 v118, v118, v119
  v_add_f32 v120, v120, v121
  v_mul_f32 v118, 1048576000, v118
  v_mul_f32 v120, 1006632960, v120
  v_sub_f32 v122, v122, v118
  v_sub_f32 v124, v124, v118
  v_sub_f32 v126, v126, v118
  v_sub_f32 v128, v128, v118
  v_fmac_f32 v120, v122, v122
  v_fmac_f32 v120, v124, v124
  v_fmac_f32 v120, v126, v126
  v_fmac_f32 v120, v128, v128
  v_mov_b32 v119, 925353388
  v_fmac_f32 v119, 1048576000, v120
  v_rsq_f32 v120, v119
  v_sub_f32 v114, v108, v118
  v_sub_f32 v115, v109, v118
  v_sub_f32 v116, v110, v118
  v_sub_f32 v117, v111, v118
  v_mul_f32 v114, v114, v120
  v_mul_f32 v115, v115, v120
  v_mul_f32 v116, v116, v120
  v_mul_f32 v117, v117, v120
  v_cvt_pk_bf16_f32 v114, v114, v115
  v_cvt_pk_bf16_f32 v115, v116, v117
  buffer_store_dwordx2 v[114:115], v6, s[4:7], s43 offen sc1
  s_waitcnt vmcnt(0)
  v_mov_b32 v114, s16
  buffer_store_dword v114, off, s[4:7], s32 offset:512 sc1
  s_cmp_ge_u32 s12, 28
  s_cbranch_scc1 L_skip_slow
  v_lshrrev_b32 v115, 2, v0
  v_min_u32 v115, 124, v115
L_pf_bslow:
  buffer_load_dword v114, v115, s[4:7], s30 offen offset:512 sc1
  s_add_u32 s24, s24, 1
  s_cmp_gt_u32 s24, 0x200000
  s_cbranch_scc1 L_bail
  s_waitcnt vmcnt(0)
  v_cmp_gt_u32 vcc, s16, v114
  s_cbranch_vccnz L_pf_bslow
  s_add_u32 m0, s77, 0
  s_nop 0
  buffer_load_dwordx4 v1, s[4:7], s43 offen offset:0 sc1 lds
  s_add_u32 m0, s77, 896
  s_nop 0
  buffer_load_dwordx4 v1, s[4:7], s43 offen offset:128 sc1 lds
  s_add_u32 m0, s77, 1792
  s_nop 0
  buffer_load_dwordx4 v1, s[4:7], s43 offen offset:256 sc1 lds
  s_add_u32 m0, s77, 2688
  s_nop 0
  buffer_load_dwordx4 v1, s[4:7], s43 offen offset:384 sc1 lds
  s_add_u32 m0, s77, 3584
  s_nop 0
  buffer_load_dwordx4 v1, s[4:7], s43 offen offset:512 sc1 lds
  s_add_u32 m0, s77, 4480
  s_nop 0
  buffer_load_dwordx4 v1, s[4:7], s43 offen offset:640 sc1 lds
  s_add_u32 m0, s77, 5376
  s_nop 0
  buffer_load_dwordx4 v1, s[4:7], s43 offen offset:768 sc1 lds
  s_add_u32 m0, s77, 6272
  s_nop 0
  buffer_load_dwordx4 v1, s[4:7], s43 offen offset:896 sc1 lds
  s_waitcnt vmcnt(4)
  s_barrier
  ds_read_b128 v[146:149], v2 offset:0
  ds_read_b128 v[150:153], v2 offset:16384
  ds_read_b128 v[154:157], v3 offset:0
  ds_read_b128 v[158:161], v3 offset:16384
  s_waitcnt lgkmcnt(3)
  v_mfma_f32_16x16x32_bf16 v[114:117], a[128:131], v[146:149], 0
  ds_read_b128 v[162:165], v2 offset:1024
  v_mfma_f32_16x16x32_bf16 v[122:125], a[192:195], v[146:149], 0
  s_waitcnt lgkmcnt(3)
  v_mfma_f32_16x16x32_bf16 v[118:121], a[128:131], v[150:153], 0
  ds_read_b128 v[166:169], v2 offset:17408
  v_mfma_f32_16x16x32_bf16 v[126:129], a[192:195], v[150:153], 0
  s_waitcnt lgkmcnt(3)
  v_mfma_f32_16x16x32_bf16 v[114:117], a[132:135], v[154:157], v[114:117]
  ds_read_b128 v[146:149], v3 offset:1024
  v_mfma_f32_16x16x32_bf16 v[122:125], a[196:199], v[154:157], v[122:125]
  s_waitcnt lgkmcnt(3)
  v_mfma_f32_16x16x32_bf16 v[118:121], a[132:135], v[158:161], v[118:121]
  ds_read_b128 v[150:153], v3 offset:17408
  v_mfma_f32_16x16x32_bf16 v[126:129], a[196:199], v[158:161], v[126:129]
  s_waitcnt lgkmcnt(3)
  v_mfma_f32_16x16x32_bf16 v[114:117], a[136:139], v[162:165], v[114:117]
  ds_read_b128 v[154:157], v2 offset:2048
  v_mfma_f32_16x16x32_bf16 v[122:125], a[200:203], v[162:165], v[122:125]
  s_waitcnt lgkmcnt(3)
  v_mfma_f32_16x16x32_bf16 v[118:121], a[136:139], v[166:169], v[118:121]
  ds_read_b128 v[158:161], v2 offset:18432
  v_mfma_f32_16x16x32_bf16 v[126:129], a[200:203], v[166:169], v[126:129]
  s_waitcnt lgkmcnt(3)
  v_mfma_f32_16x16x32_bf16 v[114:117], a[140:143], v[146:149], v[114:117]
  ds_read_b128 v[162:165], v3 offset:2048
  v_mfma_f32_16x16x32_bf16 v[122:125], a[204:207], v[146:149], v[122:125]
  s_waitcnt lgkmcnt(3)
  v_mfma_f32_16x16x32_bf16 v[118:121], a[140:143], v[150:153], v[118:121]
  ds_read_b128 v[166:169], v3 offset:18432
  v_mfma_f32_16x16x32_bf16 v[126:129], a[204:207], v[150:153], v[126:129]
  s_waitcnt lgkmcnt(3)
  v_mfma_f32_16x16x32_bf16 v[114:117], a[144:147], v[154:157], v[114:117]
  ds_read_b128 v[146:149], v2 offset:3072
  v_mfma_f32_16x16x32_bf16 v[122:125], a[208:211], v[154:157], v[122:125]
  s_waitcnt lgkmcnt(3)
  v_mfma_f32_16x16x32_bf16 v[118:121], a[144:147], v[158:161], v[118:121]
  ds_read_b128 v[150:153], v2 offset:19456
  v_mfma_f32_16x16x32_bf16 v[126:129], a[208:211], v[158:161], v[126:129]
  s_waitcnt lgkmcnt(3)
  v_mfma_f32_16x16x32_bf16 v[114:117], a[148:151], v[162:165], v[114:117]
  ds_read_b128 v[154:157], v3 offset:3072
  v_mfma_f32_16x16x32_bf16 v[122:125], a[212:215], v[162:165], v[122:125]
  s_waitcnt lgkmcnt(3)
  v_mfma_f32_16x16x32_bf16 v[118:121], a[148:151], v[166:169], v[118:121]
  ds_read_b128 v[158:161], v3 offset:19456
  v_mfma_f32_16x16x32_bf16 v[126:129], a[212:215], v[166:169], v[126:129]
  s_waitcnt vmcnt(0)
  s_barrier
  s_waitcnt lgkmcnt(3)
  v_mfma_f32_16x16x32_bf16 v[114:117], a[152:155], v[146:149], v[114:117]
  ds_read_b128 v[162:165], v2 offset:4096
  s_add_u32 s19, s34, 0
  v_mfma_f32_16x16x32_bf16 v[122:125], a[216:219], v[146:149], v[122:125]
  buffer_load_dwordx4 v[36:39], v0, s[4:7], s19 offen offset:0 sc1
  s_waitcnt lgkmcnt(3)
  v_mfma_f32_16x16x32_bf16 v[118:121], a[152:155], v[150:153], v[118:121]
  ds_read_b128 v[166:169], v3 offset:4096
  v_mfma_f32_16x16x32_bf16 v[126:129], a[216:219], v[150:153], v[126:129]
  s_waitcnt lgkmcnt(3)
  v_mfma_f32_16x16x32_bf16 v[114:117], a[156:159], v[154:157], v[114:117]
  ds_read_b128 v[146:149], v2 offset:5120
  s_add_u32 s19, s34, 0
  v_mfma_f32_16x16x32_bf16 v[122:125], a[220:223], v[154:157], v[122:125]
  buffer_load_dwordx4 v[40:43], v0, s[4:7], s19 offen offset:1024 sc1
  s_waitcnt lgkmcnt(3)
  v_mfma_f32_16x16x32_bf16 v[118:121], a[156:159], v[158:161], v[118:121]
  ds_read_b128 v[150:153], v3 offset:5120
  v_mfma_f32_16x16x32_bf16 v[126:129], a[220:223], v[158:161], v[126:129]
  s_waitcnt lgkmcnt(3)
  v_mfma_f32_16x16x32_bf16 v[114:117], a[160:163], v[162:165], v[114:117]
  ds_read_b128 v[154:157], v2 offset:6144
  s_add_u32 s19, s34, 2048
  v_mfma_f32_16x16x32_bf16 v[122:125], a[224:227], v[162:165], v[122:125]
  buffer_load_dwordx4 v[44:47], v0, s[4:7], s19 offen offset:0 sc1
  s_waitcnt lgkmcnt(3)
  v_mfma_f32_16x16x32_bf16 v[114:117], a[164:167], v[166:169], v[114:117]
  ds_read_b128 v[158:161], v3 offset:6144
  v_mfma_f32_16x16x32_bf16 v[122:125], a[228:231], v[166:169], v[122:125]
  s_waitcnt lgkmcnt(3)
  v_mfma_f32_16x16x32_bf16 v[114:117], a[168:171], v[146:149], v[114:117]
  ds_read_b128 v[162:165], v2 offset:7168
  s_add_u32 s19, s34, 2048
  v_mfma_f32_16x16x32_bf16 v[122:125], a[232:235], v[146:149], v[122:125]
  buffer_load_dwordx4 v[48:51], v0, s[4:7], s19 offen offset:1024 sc1
  s_waitcnt lgkmcnt(3)
  v_mfma_f32_16x16x32_bf16 v[114:117], a[172:175], v[150:153], v[114:117]
  ds_read_b128 v[166:169], v3 offset:7168
  v_mfma_f32_16x16x32_bf16 v[122:125], a[236:239], v[150:153], v[122:125]
  s_waitcnt lgkmcnt(3)
  v_mfma_f32_16x16x32_bf16 v[114:117], a[176:179], v[154:157], v[114:117]
  ds_read_b128 v[146:149], v2 offset:20480
  s_add_u32 s19, s34, 4096
  v_mfma_f32_16x16x32_bf16 v[122:125], a[240:243], v[154:157], v[122:125]
  buffer_load_dwordx4 v[52:55], v0, s[4:7], s19 offen offset:0 sc1
  s_waitcnt lgkmcnt(3)
  v_mfma_f32_16x16x32_bf16 v[114:117], a[180:183], v[158:161], v[114:117]
  ds_read_b128 v[150:153], v3 offset:20480
  v_mfma_f32_16x16x32_bf16 v[122:125], a[244:247], v[158:161], v[122:125]
  s_waitcnt lgkmcnt(3)
  v_mfma_f32_16x16x32_bf16 v[114:117], a[184:187], v[162:165], v[114:117]
  ds_read_b128 v[154:157], v2 offset:21504
  s_add_u32 s19, s34, 4096
  v_mfma_f32_16x16x32_bf16 v[122:125], a[248:251], v[162:165], v[122:125]
  buffer_load_dwordx4 v[56:59], v0, s[4:7], s19 offen offset:1024 sc1
  s_waitcnt lgkmcnt(3)
  v_mfma_f32_16x16x32_bf16 v[114:117], a[188:191], v[166:169], v[114:117]
  ds_read_b128 v[158:161], v3 offset:21504
  v_mfma_f32_16x16x32_bf16 v[122:125], a[252:255], v[166:169], v[122:125]
  s_waitcnt lgkmcnt(3)
  v_mfma_f32_16x16x32_bf16 v[118:121], a[160:163], v[146:149], v[118:121]
  ds_read_b128 v[162:165], v2 offset:22528
  s_add_u32 s19, s34, 6144
  v_mfma_f32_16x16x32_bf16 v[126:129], a[224:227], v[146:149], v[126:129]
  buffer_load_dwordx4 v[60:63], v0, s[4:7], s19 offen offset:0 sc1
  s_waitcnt lgkmcnt(3)
  v_mfma_f32_16x16x32_bf16 v[118:121], a[164:167], v[150:153], v[118:121]
  ds_read_b128 v[166:169], v3 offset:22528
  v_mfma_f32_16x16x32_bf16 v[126:129], a[228:231], v[150:153], v[126:129]
  s_waitcnt lgkmcnt(3)
  v_mfma_f32_16x16x32_bf16 v[118:121], a[168:171], v[154:157], v[118:121]
  ds_read_b128 v[146:149], v2 offset:23552
  s_add_u32 s19, s34, 6144
  v_mfma_f32_16x16x32_bf16 v[126:129], a[232:235], v[154:157], v[126:129]
  buffer_load_dwordx4 v[64:67], v0, s[4:7], s19 offen offset:1024 sc1
  v_mul_f32 v130, 3216550459, v114
  v_mul_f32 v131, 3216550459, v115
  v_mul_f32 v132, 3216550459, v116
  v_mul_f32 v133, 3216550459, v117
  s_waitcnt lgkmcnt(3)
  v_mfma_f32_16x16x32_bf16 v[118:121], a[172:175], v[158:161], v[118:121]
  ds_read_b128 v[150:153], v3 offset:23552
  v_exp_f32 v130, v130
  v_mfma_f32_16x16x32_bf16 v[126:129], a[236:239], v[158:161], v[126:129]
  v_exp_f32 v131, v131
  v_exp_f32 v132, v132
  v_exp_f32 v133, v133
  s_waitcnt lgkmcnt(3)
  v_mfma_f32_16x16x32_bf16 v[118:121], a[176:179], v[162:165], v[118:121]
  s_add_u32 s34, s34, 57344
  v_mul_f32 v114, v114, v122
  v_mfma_f32_16x16x32_bf16 v[126:129], a[240:243], v[162:165], v[126:129]
  v_mul_f32 v115, v115, v123
  v_mul_f32 v116, v116, v124
  v_mul_f32 v117, v117, v125
  s_waitcnt lgkmcnt(2)
  v_mfma_f32_16x16x32_bf16 v[118:121], a[180:183], v[166:169], v[118:121]
  v_add_f32 v130, 1.0, v130
  v_add_f32 v131, 1.0, v131
  v_mfma_f32_16x16x32_bf16 v[126:129], a[244:247], v[166:169], v[126:129]
  v_add_f32 v132, 1.0, v132
  v_add_f32 v133, 1.0, v133
  s_waitcnt lgkmcnt(1)
  v_mfma_f32_16x16x32_bf16 v[118:121], a[184:187], v[146:149], v[118:121]
  v_rcp_f32 v130, v130
  v_rcp_f32 v131, v131
  v_mfma_f32_16x16x32_bf16 v[126:129], a[248:251], v[146:149], v[126:129]
  v_rcp_f32 v132, v132
  v_rcp_f32 v133, v133
  s_waitcnt lgkmcnt(0)
  v_mfma_f32_16x16x32_bf16 v[118:121], a[188:191], v[150:153], v[118:121]
  v_mul_f32 v114, v114, v130
  v_mul_f32 v115, v115, v131
  v_mfma_f32_16x16x32_bf16 v[126:129], a[252:255], v[150:153], v[126:129]
  v_mul_f32 v116, v116, v132
  v_mul_f32 v117, v117, v133
  v_cvt_pk_bf16_f32 v130, v114, v115
  v_cvt_pk_bf16_f32 v131, v116, v117
  ds_write_b64 v8, v[130:131] offset:0
  v_mul_f32 v134, 3216550459, v118
  v_mul_f32 v135, 3216550459, v119
  v_mul_f32 v136, 3216550459, v120
  v_mul_f32 v137, 3216550459, v121
  v_exp_f32 v134, v134
  v_exp_f32 v135, v135
  v_exp_f32 v136, v136
  v_exp_f32 v137, v137
  v_mul_f32 v118, v118, v126
  v_mul_f32 v119, v119, v127
  v_mul_f32 v120, v120, v128
  v_mul_f32 v121, v121, v129
  v_add_f32 v134, 1.0, v134
  v_add_f32 v135, 1.0, v135
  v_add_f32 v136, 1.0, v136
  v_add_f32 v137, 1.0, v137
  v_rcp_f32 v134, v134
  v_rcp_f32 v135, v135
  v_rcp_f32 v136, v136
  v_rcp_f32 v137, v137
  v_mul_f32 v118, v118, v134
  v_mul_f32 v119, v119, v135
  v_mul_f32 v120, v120, v136
  v_mul_f32 v121, v121, v137
  v_cvt_pk_bf16_f32 v134, v118, v119
  v_cvt_pk_bf16_f32 v135, v120, v121
  ds_write_b64 v8, v[134:135] offset:2048
  s_waitcnt lgkmcnt(0)
  s_barrier
  ds_read_b128 v[84:87], v0 offset:40960
  ds_read_b128 v[88:91], v0 offset:41984
  ds_read_b128 v[92:95], v0 offset:43008
  ds_read_b128 v[96:99], v0 offset:44032
  s_waitcnt lgkmcnt(3)
  v_mfma_f32_16x16x32_bf16 v[114:117], v[84:87], v[192:195], 0
  v_mfma_f32_16x16x32_bf16 v[118:121], v[84:87], v[196:199], 0
  s_waitcnt lgkmcnt(2)
  v_mfma_f32_16x16x32_bf16 v[114:117], v[88:91], v[224:227], v[114:117]
  v_mfma_f32_16x16x32_bf16 v[118:121], v[88:91], v[228:231], v[118:121]
  v_mfma_f32_16x16x32_bf16 v[122:125], v[84:87], v[200:203], 0
  v_mfma_f32_16x16x32_bf16 v[126:129], v[84:87], v[204:207], 0
  v_mfma_f32_16x16x32_bf16 v[122:125], v[88:91], v[232:235], v[122:125]
  v_mfma_f32_16x16x32_bf16 v[126:129], v[88:91], v[236:239], v[126:129]
  v_mfma_f32_16x16x32_bf16 v[130:133], v[84:87], v[208:211], 0
  s_nop 2
  v_add_u32 v118, s26, v118
  v_and_or_b32 v118, v118, v187, s27
  v_cvt_pk_bf16_f32 v100, v114, v118
  v_mfma_f32_16x16x32_bf16 v[134:137], v[84:87], v[212:215], 0
  v_add_u32 v119, s26, v119
  v_and_or_b32 v119, v119, v187, s27
  v_cvt_pk_bf16_f32 v104, v115, v119
  v_mfma_f32_16x16x32_bf16 v[130:133], v[88:91], v[240:243], v[130:133]
  v_add_u32 v120, s26, v120
  v_and_or_b32 v120, v120, v187, s27
  v_cvt_pk_bf16_f32 v178, v116, v120
  v_mfma_f32_16x16x32_bf16 v[134:137], v[88:91], v[244:247], v[134:137]
  v_add_u32 v121, s26, v121
  v_and_or_b32 v121, v121, v187, s27
  v_cvt_pk_bf16_f32 v182, v117, v121
  v_mfma_f32_16x16x32_bf16 v[138:141], v[84:87], v[216:219], 0
  v_cvt_pk_bf16_f32 v101, v122, v126
  v_mfma_f32_16x16x32_bf16 v[142:145], v[84:87], v[220:223], 0
  v_cvt_pk_bf16_f32 v105, v123, v127
  v_mfma_f32_16x16x32_bf16 v[138:141], v[88:91], v[248:251], v[138:141]
  v_cvt_pk_bf16_f32 v179, v124, v128
  v_mfma_f32_16x16x32_bf16 v[142:145], v[88:91], v[252:255], v[142:145]
  v_cvt_pk_bf16_f32 v183, v125, v129
  s_waitcnt lgkmcnt(1)
  v_mfma_f32_16x16x32_bf16 v[146:149], v[92:95], v[192:195], 0
  v_cvt_pk_bf16_f32 v102, v130, v134
  v_mfma_f32_16x16x32_bf16 v[150:153], v[92:95], v[196:199], 0
  v_cvt_pk_bf16_f32 v106, v131, v135
  s_waitcnt lgkmcnt(0)
  v_mfma_f32_16x16x32_bf16 v[146:149], v[96:99], v[224:227], v[146:149]
  v_cvt_pk_bf16_f32 v180, v132, v136
  v_mfma_f32_16x16x32_bf16 v[150:153], v[96:99], v[228:231], v[150:153]
  v_cvt_pk_bf16_f32 v184, v133, v137
  v_mfma_f32_16x16x32_bf16 v[154:157], v[92:95], v[200:203], 0
  v_cvt_pk_bf16_f32 v103, v138, v142
  v_mfma_f32_16x16x32_bf16 v[158:161], v[92:95], v[204:207], 0
  v_cvt_pk_bf16_f32 v107, v139, v143
  v_mfma_f32_16x16x32_bf16 v[154:157], v[96:99], v[232:235], v[154:157]
  v_cvt_pk_bf16_f32 v181, v140, v144
  v_mfma_f32_16x16x32_bf16 v[158:161], v[96:99], v[236:239], v[158:161]
  v_cvt_pk_bf16_f32 v185, v141, v145
  s_add_u32 s18, s42, 0
  buffer_store_dwordx4 v[100:103], v4, s[4:7], s18 offen sc1
  v_mfma_f32_16x16x32_bf16 v[162:165], v[92:95], v[208:211], 0
  v_add_u32 v150, s26, v150
  v_and_or_b32 v150, v150, v187, s27
  v_cvt_pk_bf16_f32 v114, v146, v150
  v_mfma_f32_16x16x32_bf16 v[166:169], v[92:95], v[212:215], 0
  v_add_u32 v151, s26, v151
  v_and_or_b32 v151, v151, v187, s27
  v_cvt_pk_bf16_f32 v118, v147, v151
  s_add_u32 s18, s42, 32768
  buffer_store_dwordx4 v[104:107], v4, s[4:7], s18 offen sc1
  v_mfma_f32_16x16x32_bf16 v[162:165], v[96:99], v[240:243], v[162:165]
  v_add_u32 v152, s26, v152
  v_and_or_b32 v152, v152, v187, s27
  v_cvt_pk_bf16_f32 v122, v148, v152
  v_mfma_f32_16x16x32_bf16 v[166:169], v[96:99], v[244:247], v[166:169]
  v_add_u32 v153, s26, v153
  v_and_or_b32 v153, v153, v187, s27
  v_cvt_pk_bf16_f32 v126, v149, v153
  s_add_u32 s18, s42, 65536
  buffer_store_dwordx4 v[178:181], v4, s[4:7], s18 offen sc1
  v_mfma_f32_16x16x32_bf16 v[170:173], v[92:95], v[216:219], 0
  v_cvt_pk_bf16_f32 v115, v154, v158
  v_mfma_f32_16x16x32_bf16 v[174:177], v[92:95], v[220:223], 0
  v_cvt_pk_bf16_f32 v119, v155, v159
  s_add_u32 s18, s42, 98304
  buffer_store_dwordx4 v[182:185], v4, s[4:7], s18 offen sc1
  v_mfma_f32_16x16x32_bf16 v[170:173], v[96:99], v[248:251], v[170:173]
  v_cvt_pk_bf16_f32 v123, v156, v160
  v_mfma_f32_16x16x32_bf16 v[174:177], v[96:99], v[252:255], v[174:177]
  v_cvt_pk_bf16_f32 v127, v157, v161
  v_cvt_pk_bf16_f32 v116, v162, v166
  v_cvt_pk_bf16_f32 v120, v163, v167
  v_cvt_pk_bf16_f32 v124, v164, v168
  v_cvt_pk_bf16_f32 v128, v165, v169
  s_nop 2
  v_cvt_pk_bf16_f32 v117, v170, v174
  v_cvt_pk_bf16_f32 v121, v171, v175
  v_cvt_pk_bf16_f32 v125, v172, v176
  v_cvt_pk_bf16_f32 v129, v173, v177
  s_add_u32 s18, s42, 524288
  buffer_store_dwordx4 v[114:117], v4, s[4:7], s18 offen sc1
  s_add_u32 s18, s42, 557056
  buffer_store_dwordx4 v[118:121], v4, s[4:7], s18 offen sc1
  s_add_u32 s18, s42, 589824
  buffer_store_dwordx4 v[122:125], v4, s[4:7], s18 offen sc1
  s_add_u32 s18, s42, 622592
  buffer_store_dwordx4 v[126:129], v4, s[4:7], s18 offen sc1
  s_waitcnt vmcnt(2)
  s_cmp_lg_u32 s16, 1
  s_cbranch_scc1 L_ns_cslow
  s_waitcnt vmcnt(0)
  v_mov_b32 v114, s16
  buffer_store_dword v114, off, s[4:7], s31 offset:1024 sc1
L_ns_cslow:
L_noffn_slow:
  s_cmp_lg_u32 s16, 1
  s_cbranch_scc1 L_nf_cslow
  v_lshrrev_b32 v115, 2, v0
  v_min_u32 v115, 108, v115
L_pf_cslow:
  buffer_load_dword v114, v115, s[4:7], s30 offen offset:1024 sc1
  s_add_u32 s24, s24, 1
  s_cmp_gt_u32 s24, 0x200000
  s_cbranch_scc1 L_bail
  s_waitcnt vmcnt(0)
  v_cmp_gt_u32 vcc, s16, v114
  s_cbranch_vccnz L_pf_cslow
L_nf_cslow:
  s_add_u32 s18, s42, 0
  buffer_load_dwordx4 v[122:125], v5, s[4:7], s18 offen sc1
  s_add_u32 s18, s42, 4096
  buffer_load_dwordx4 v[126:129], v5, s[4:7], s18 offen sc1
  s_add_u32 s18, s42, 8192
  buffer_load_dwordx4 v[130:133], v5, s[4:7], s18 offen sc1
  s_add_u32 s18, s42, 12288
  buffer_load_dwordx4 v[134:137], v5, s[4:7], s18 offen sc1
  s_add_u32 s18, s42, 16384
  buffer_load_dwordx4 v[138:141], v5, s[4:7], s18 offen sc1
  s_add_u32 s18, s42, 20480
  buffer_load_dwordx4 v[142:145], v5, s[4:7], s18 offen sc1
  s_add_u32 s18, s42, 24576
  buffer_load_dwordx4 v[146:149], v5, s[4:7], s18 offen sc1
  s_add_u32 s24, s24, 1
  s_cmp_gt_u32 s24, 0x200000
  s_cbranch_scc1 L_bail
  s_waitcnt vmcnt(6)
  v_mfma_f32_16x16x32_bf16 v[114:117], v[12:15], v[122:125], 0
  v_xor_b32 v118, s27, v122
  s_waitcnt vmcnt(5)
  v_mfma_f32_16x16x32_bf16 v[114:117], v[12:15], v[126:129], v[114:117]
  v_bitop3_b32 v118, v118, v126, s27 bitop3:0xf6
  s_waitcnt vmcnt(4)
  v_mfma_f32_16x16x32_bf16 v[114:117], v[12:15], v[130:133], v[114:117]
  v_bitop3_b32 v118, v118, v130, s27 bitop3:0xf6
  s_waitcnt vmcnt(3)
  v_mfma_f32_16x16x32_bf16 v[114:117], v[12:15], v[134:137], v[114:117]
  v_bitop3_b32 v118, v118, v134, s27 bitop3:0xf6
  s_waitcnt vmcnt(2)
  v_mfma_f32_16x16x32_bf16 v[114:117], v[12:15], v[138:141], v[114:117]
  v_bitop3_b32 v118, v118, v138, s27 bitop3:0xf6
  s_waitcnt vmcnt(1)
  v_mfma_f32_16x16x32_bf16 v[114:117], v[12:15], v[142:145], v[114:117]
  v_bitop3_b32 v118, v118, v142, s27 bitop3:0xf6
  s_waitcnt vmcnt(0)
  v_mfma_f32_16x16x32_bf16 v[114:117], v[12:15], v[146:149], v[114:117]
  v_bitop3_b32 v118, v118, v146, s27 bitop3:0xf6
  v_and_b32 v118, 0x10000, v118
  v_cmp_ne_u32 vcc, 0, v118
  s_cbranch_vccnz L_nf_cslow
  s_nop 3
  v_add_f32 v114, v114, v108
  v_add_f32 v115, v115, v109
  v_add_f32 v116, v116, v110
  v_add_f32 v117, v117, v111
  v_cvt_pk_bf16_f32 v114, v114, v115
  v_cvt_pk_bf16_f32 v115, v116, v117
  buffer_store_dwordx2 v[114:115], v6, s[72:75], s76 offen
  s_add_u32 s76, s76, 229376
  s_add_u32 s17, s17, 7
  s_add_u32 s16, s16, 1
  s_cmp_le_u32 s16, s15
  s_cbranch_scc1 L_p2top_slow
  s_endpgm
L_skip_slow:
  s_add_u32 s19, s34, 0
  buffer_load_dwordx4 v[36:39], v0, s[4:7], s19 offen offset:0 sc1
  s_add_u32 s19, s34, 0
  buffer_load_dwordx4 v[40:43], v0, s[4:7], s19 offen offset:1024 sc1
  s_add_u32 s19, s34, 2048
  buffer_load_dwordx4 v[44:47], v0, s[4:7], s19 offen offset:0 sc1
  s_add_u32 s19, s34, 2048
  buffer_load_dwordx4 v[48:51], v0, s[4:7], s19 offen offset:1024 sc1
  s_add_u32 s19, s34, 4096
  buffer_load_dwordx4 v[52:55], v0, s[4:7], s19 offen offset:0 sc1
  s_add_u32 s19, s34, 4096
  buffer_load_dwordx4 v[56:59], v0, s[4:7], s19 offen offset:1024 sc1
  s_add_u32 s19, s34, 6144
  buffer_load_dwordx4 v[60:63], v0, s[4:7], s19 offen offset:0 sc1
  s_add_u32 s19, s34, 6144
  buffer_load_dwordx4 v[64:67], v0, s[4:7], s19 offen offset:1024 sc1
  s_add_u32 s34, s34, 57344
  s_sleep 8
  s_branch L_noffn_slow
L_over:
  v_mov_b32 v2, 1
  s_mov_b64 exec, 1
  buffer_atomic_add v2, off, s[92:95], 0 offset:8 sc0
  s_waitcnt vmcnt(0)
  v_readfirstlane_b32 s19, v2
  s_mov_b64 exec, -1
  v_lshlrev_b32 v4, 2, v0
L_over_poll:
  buffer_load_dword v2, v4, s[92:95], 0 offen sc1
  s_add_u32 s24, s24, 1
  s_cmp_gt_u32 s24, 0x100000
  s_cbranch_scc1 L_quit
  s_mov_b32 s18, 0
  s_waitcnt vmcnt(0)
  v_readlane_b32 s20, v2, 0
  s_nop 0
  s_add_u32 s18, s18, s20
  v_readlane_b32 s20, v2, 4
  s_nop 0
  s_add_u32 s18, s18, s20
  v_readlane_b32 s20, v2, 8
  s_nop 0
  s_add_u32 s18, s18, s20
  v_readlane_b32 s20, v2, 12
  s_nop 0
  s_add_u32 s18, s18, s20
  v_readlane_b32 s20, v2, 16
  s_nop 0
  s_add_u32 s18, s18, s20
  v_readlane_b32 s20, v2, 20
  s_nop 0
  s_add_u32 s18, s18, s20
  v_readlane_b32 s20, v2, 24
  s_nop 0
  s_add_u32 s18, s18, s20
  v_readlane_b32 s20, v2, 28
  s_nop 0
  s_add_u32 s18, s18, s20
  v_readlane_b32 s20, v2, 32
  s_nop 0
  s_add_u32 s18, s18, s20
  v_readlane_b32 s20, v2, 36
  s_nop 0
  s_add_u32 s18, s18, s20
  v_readlane_b32 s20, v2, 40
  s_nop 0
  s_add_u32 s18, s18, s20
  v_readlane_b32 s20, v2, 44
  s_nop 0
  s_add_u32 s18, s18, s20
  v_readlane_b32 s20, v2, 48
  s_nop 0
  s_add_u32 s18, s18, s20
  v_readlane_b32 s20, v2, 52
  s_nop 0
  s_add_u32 s18, s18, s20
  v_readlane_b32 s20, v2, 56
  s_nop 0
  s_add_u32 s18, s18, s20
  v_readlane_b32 s20, v2, 60
  s_nop 0
  s_add_u32 s18, s18, s20
  s_cmp_lt_u32 s18, 256
  s_cbranch_scc1 L_over_poll
  v_readlane_b32 s20, v2, 0
  s_nop 0
  s_min_u32 s20, s20, 32
  s_mov_b32 s14, 0
  s_add_u32 s12, s20, s19
  s_cmp_lt_u32 s12, 32
  s_cbranch_scc1 L_role
  s_sub_u32 s19, s12, 32
  v_readlane_b32 s20, v2, 8
  s_nop 0
  s_min_u32 s20, s20, 32
  s_mov_b32 s14, 1
  s_add_u32 s12, s20, s19
  s_cmp_lt_u32 s12, 32
  s_cbranch_scc1 L_role
  s_sub_u32 s19, s12, 32
  v_readlane_b32 s20, v2, 16
  s_nop 0
  s_min_u32 s20, s20, 32
  s_mov_b32 s14, 2
  s_add_u32 s12, s20, s19
  s_cmp_lt_u32 s12, 32
  s_cbranch_scc1 L_role
  s_sub_u32 s19, s12, 32
  v_readlane_b32 s20, v2, 24
  s_nop 0
  s_min_u32 s20, s20, 32
  s_mov_b32 s14, 3
  s_add_u32 s12, s20, s19
  s_cmp_lt_u32 s12, 32
  s_cbranch_scc1 L_role
  s_sub_u32 s19, s12, 32
  v_readlane_b32 s20, v2, 32
  s_nop 0
  s_min_u32 s20, s20, 32
  s_mov_b32 s14, 4
  s_add_u32 s12, s20, s19
  s_cmp_lt_u32 s12, 32
  s_cbranch_scc1 L_role
  s_sub_u32 s19, s12, 32
  v_readlane_b32 s20, v2, 40
  s_nop 0
  s_min_u32 s20, s20, 32
  s_mov_b32 s14, 5
  s_add_u32 s12, s20, s19
  s_cmp_lt_u32 s12, 32
  s_cbranch_scc1 L_role
  s_sub_u32 s19, s12, 32
  v_readlane_b32 s20, v2, 48
  s_nop 0
  s_min_u32 s20, s20, 32
  s_mov_b32 s14, 6
  s_add_u32 s12, s20, s19
  s_cmp_lt_u32 s12, 32
  s_cbranch_scc1 L_role
  s_sub_u32 s19, s12, 32
  v_readlane_b32 s20, v2, 56
  s_nop 0
  s_min_u32 s20, s20, 32
  s_mov_b32 s14, 7
  s_add_u32 s12, s20, s19
  s_cmp_lt_u32 s12, 32
  s_cbranch_scc1 L_role
  s_sub_u32 s19, s12, 32
L_quit:
  s_mov_b32 s14, 8
  s_mov_b32 s12, 0
  s_branch L_role
L_chain:
  s_mov_b32 s8, s96
  s_mov_b32 s9, s97
  s_mov_b32 s10, 8192
  v_lshrrev_b32 v40, 6, v0
  v_and_b32 v43, 63, v0
  v_readfirstlane_b32 s13, v40
  v_and_b32 v44, 15, v43
  v_lshrrev_b32 v45, 4, v43
  v_lshlrev_b32 v0, 4, v43
  s_mov_b32 s20, 0x33333333
  s_mov_b32 s21, 0x33333333
  s_mov_b64 vcc, s[20:21]
  v_mov_b32 v40, 0xeeeeeeee
  v_mov_b32 v41, 0x44444444
  v_cndmask_b32 v1, v40, v41, vcc
  v_mov_b32 v40, 0xffff0000
  v_mov_b32 v41, 0x0000ffff
  v_cndmask_b32 v13, v40, v41, vcc
  v_mov_b32 v15, 0
  v_mov_b32 v17, 0
  v_mov_b32 v19, 0
  v_mov_b32 v20, 0x3f803f80
  v_mov_b32 v21, 0x3f803f80
  v_mov_b32 v22, 0x3f803f80
  v_mov_b32 v23, 0x3f803f80
  s_mov_b32 s22, 1040356334
  s_mov_b32 s39, 562036736
  s_mov_b32 s23, 838860800
  s_lshl_b32 s18, s13, 11
  s_add_u32 s19, s18, 16384
  v_add_u32 v2, s19, v0
  s_xor_b32 s19, s18, 4096
  s_add_u32 s19, s19, 16384
  v_add_u32 v3, s19, v0
  s_xor_b32 s19, s18, 6144
  s_add_u32 s19, s19, 16384
  v_add_u32 v4, s19, v0
  s_xor_b32 s19, s18, 2048
  s_add_u32 s19, s19, 16384
  v_add_u32 v5, s19, v0
  s_lshl_b32 s19, s13, 15
  s_add_u32 s19, s19, 32768
  v_add_u32 v6, s19, v0
  v_mul_u32_u24 v40, 1088, v45
  v_lshlrev_b32 v41, 3, v44
  v_add_u32 v7, v40, v41
  s_lshl_b32 s19, s13, 7
  s_add_u32 s19, s19, 16384
  v_add_u32 v7, s19, v7
  v_and_b32 v40, 3, v43
  v_mul_u32_u24 v40, 1088, v40
  v_lshrrev_b32 v41, 2, v43
  v_lshlrev_b32 v41, 3, v41
  v_add_u32 v40, v40, v41
  v_add_u32 v8, 16384, v40
  v_lshrrev_b32 v40, 2, v44
  v_lshlrev_b32 v40, 14, v40
  v_lshlrev_b32 v41, 12, v45
  v_add_u32 v40, v40, v41
  v_and_b32 v41, 3, v44
  v_lshlrev_b32 v41, 4, v41
  v_add_u32 v40, v40, v41
  s_lshl_b32 s18, s13, 16
  s_lshl_b32 s19, s12, 6
  s_add_u32 s18, s18, s19
  v_add_u32 v10, s18, v40
  v_lshlrev_b32 v40, 8, v45
  v_and_b32 v41, 8, v44
  v_lshlrev_b32 v41, 4, v41
  v_add_u32 v40, v40, v41
  v_and_b32 v41, 2, v44
  v_lshlrev_b32 v41, 5, v41
  v_add_u32 v40, v40, v41
  v_and_b32 v41, 4, v44
  v_lshlrev_b32 v41, 3, v41
  v_add_u32 v40, v40, v41
  v_and_b32 v41, 1, v44
  v_lshlrev_b32 v41, 4, v41
  v_add_u32 v40, v40, v41
  s_lshl_b32 s18, s12, 2
  s_add_u32 s18, s18, s13
  s_lshl_b32 s18, s18, 11
  v_add_u32 v11, s18, v40
  s_lshr_b32 s18, s12, 2
  s_lshl_b32 s18, s18, 10
  s_and_b32 s19, s12, 2
  s_lshl_b32 s19, s19, 8
  s_add_u32 s18, s18, s19
  s_and_b32 s19, s12, 1
  s_lshl_b32 s19, s19, 7
  s_add_u32 s18, s18, s19
  s_and_b32 s19, s13, 2
  s_lshl_b32 s19, s19, 5
  s_add_u32 s18, s18, s19
  s_and_b32 s19, s13, 1
  s_lshl_b32 s19, s19, 3
  s_add_u32 s18, s18, s19
  v_and_b32 v40, 1, v45
  v_lshlrev_b32 v40, 8, v40
  v_and_b32 v41, 2, v45
  v_lshlrev_b32 v41, 4, v41
  v_add_u32 v40, v40, v41
  v_and_b32 v41, 4, v44
  v_lshlrev_b32 v41, 2, v41
  v_add_u32 v40, v40, v41
  v_and_b32 v41, 2, v44
  v_lshlrev_b32 v41, 1, v41
  v_add_u32 v40, v40, v41
  v_add_u32 v40, s18, v40
  v_and_b32 v41, 9, v44
  v_cmp_eq_u32 vcc, 0, v41
  v_mov_b32 v41, 0x40000000
  s_nop 0
  v_cndmask_b32 v12, v41, v40, vcc
  v_and_b32 v40, 1, v44
  v_lshlrev_b32 v40, 4, v40
  v_mov_b32 v41, 0x3f80
  v_lshlrev_b32 v40, v40, v41
  v_lshrrev_b32 v41, 1, v44
  v_cmp_eq_u32 vcc, 0, v41
  s_nop 1
  v_cndmask_b32 v48, 0, v40, vcc
  v_cmp_eq_u32 vcc, 1, v41
  s_nop 1
  v_cndmask_b32 v49, 0, v40, vcc
  v_cmp_eq_u32 vcc, 2, v41
  s_nop 1
  v_cndmask_b32 v50, 0, v40, vcc
  v_cmp_eq_u32 vcc, 3, v41
  s_nop 1
  v_cndmask_b32 v51, 0, v40, vcc
  ds_write_b128 v0, v[48:51] offset:28928
  s_mov_b32 s26, 0
  s_mov_b32 s27, 0x10000
  s_mov_b32 s36, 0xfffe0000
  s_mov_b32 s30, 524288
  s_mov_b32 s31, 532480
  s_lshl_b32 s18, s13, 11
  s_add_u32 s28, s18, 524288
  s_add_u32 s29, s18, 532480
  s_mov_b32 s34, s18
  s_add_u32 s35, s18, 8192
  s_mul_i32 s19, s12, 2097152
  s_add_u32 s16, s19, s18
  s_add_u32 s37, s16, 17301504
  s_add_u32 s16, s16, 16777216
  s_lshr_b32 s18, s18, 1
  s_add_u32 s38, s19, s18
  s_add_u32 s38, s38, 18350080
  s_mov_b32 s17, 0x40000000
  s_lshl_b32 s18, s12, 9
  s_lshl_b32 s19, s13, 7
  s_add_u32 s33, s18, s19
  s_add_u32 s33, s33, 589824
  s_mov_b32 s15, 0
  s_mov_b32 s14, 0
  s_mov_b32 s24, 0
  v_mov_b64 v[48:49], 0
  v_mov_b64 v[50:51], 0
  v_mov_b32 v52, -1
  buffer_store_dwordx4 v[48:51], v11, s[4:7], s26 offen sc1
  buffer_store_dwordx4 v[48:51], v11, s[4:7], s26 offen offset:1024 sc1
  buffer_store_dword v52, v12, s[4:7], s30 offen sc1
  buffer_store_dword v52, v12, s[4:7], s31 offen sc1
  v_lshrrev_b32 v61, 4, v0
  v_and_b32 v126, 12, v61
  v_lshlrev_b32 v126, 9, v126
  v_and_b32 v127, 1, v61
  v_lshlrev_b32 v127, 10, v127
  v_add_u32 v126, v126, v127
  v_and_b32 v127, 2, v61
  v_lshlrev_b32 v127, 3, v127
  v_add_u32 v126, v126, v127
  v_and_b32 v127, 48, v61
  v_lshlrev_b32 v127, 1, v127
  v_add_u32 v126, v126, v127
  s_lshl_b32 s18, s13, 8
  buffer_load_dwordx4 v[40:43], v126, s[8:11], s18 offen
  buffer_load_dwordx4 v[44:47], v126, s[8:11], s18 offen offset:128
  s_add_u32 s18, s16, 0x1c0000
  buffer_load_dword v54, off, s[4:7], s18
  s_mov_b32 s40, 0x05040100
  s_mov_b32 s41, 0x07060302
  v_lshrrev_b32 v61, 4, v0
  s_lshl_b32 s42, s13, 15
  s_add_u32 s42, s42, 32768
  v_and_b32 v59, 32, v61
  v_lshlrev_b32 v59, 10, v59
  v_and_b32 v60, 16, v61
  v_lshlrev_b32 v60, 12, v60
  v_add_u32 v59, v59, v60
  v_and_b32 v60, 8, v61
  v_lshlrev_b32 v60, 10, v60
  v_add_u32 v59, v59, v60
  v_lshrrev_b32 v60, 3, v61
  v_and_b32 v60, 6, v60
  v_xor_b32 v60, v60, v61
  v_and_b32 v60, 7, v60
  v_lshlrev_b32 v60, 4, v60
  v_add_u32 v59, v59, v60
  s_lshl_b32 s18, s12, 8
  s_and_b32 s19, s13, 2
  s_lshl_b32 s19, s19, 6
  s_add_u32 s18, s18, s19
  v_add_u32 v56, s18, v59
  s_and_b32 s19, s13, 1
  s_lshl_b32 s18, s19, 17
  v_add_u32 v56, s18, v56
  s_mul_i32 s19, s19, 32768
  v_lshrrev_b32 v60, 5, v61
  v_mul_u32_u24 v60, 32768, v60
  v_subrev_u32 v60, s19, v60
  v_bfe_u32 v59, v61, 2, 3
  v_lshlrev_b32 v59, 7, v59
  v_add_u32 v59, v59, v60
  v_bfe_u32 v60, v61, 3, 2
  s_and_b32 s19, s13, 1
  s_lshl_b32 s19, s19, 1
  v_xor_b32 v60, s19, v60
  v_lshlrev_b32 v60, 5, v60
  v_add_u32 v59, v59, v60
  v_and_b32 v60, 3, v61
  v_lshlrev_b32 v60, 3, v60
  v_add_u32 v59, v59, v60
  v_add_u32 v57, s42, v59
  v_xor_b32 v126, 32, v57
  s_lshl_b32 s18, s13, 1
  s_xor_b32 s18, s18, 0
  s_lshl_b32 s76, s18, 19
  s_lshl_b32 s18, s13, 1
  s_xor_b32 s18, s18, 1
  s_lshl_b32 s77, s18, 19
  s_lshl_b32 s18, s13, 1
  s_xor_b32 s18, s18, 4
  s_lshl_b32 s78, s18, 19
  s_lshl_b32 s18, s13, 1
  s_xor_b32 s18, s18, 5
  s_lshl_b32 s79, s18, 19
  s_lshl_b32 s18, s13, 1
  s_xor_b32 s18, s18, 6
  s_lshl_b32 s80, s18, 19
  s_lshl_b32 s18, s13, 1
  s_xor_b32 s18, s18, 7
  s_lshl_b32 s81, s18, 19
  s_lshl_b32 s18, s13, 1
  s_xor_b32 s18, s18, 2
  s_lshl_b32 s82, s18, 19
  s_lshl_b32 s18, s13, 1
  s_xor_b32 s18, s18, 3
  s_lshl_b32 s83, s18, 19
  s_bitcmp1_b32 s13, 0
  s_cbranch_scc1 L_lw_odd
  s_add_u32 s18, s76, 0
  s_add_u32 m0, s42, 0
  s_nop 0
  buffer_load_dwordx4 v56, s[48:51], s18 offen lds
  s_add_u32 s18, s76, 16384
  s_add_u32 m0, s42, 1024
  s_nop 0
  buffer_load_dwordx4 v56, s[48:51], s18 offen lds
  s_add_u32 s18, s76, 262144
  s_add_u32 m0, s42, 2048
  s_nop 0
  buffer_load_dwordx4 v56, s[48:51], s18 offen lds
  s_add_u32 s18, s76, 278528
  s_add_u32 m0, s42, 3072
  s_nop 0
  buffer_load_dwordx4 v56, s[48:51], s18 offen lds
  s_add_u32 s18, s77, 0
  s_add_u32 m0, s42, 4096
  s_nop 0
  buffer_load_dwordx4 v56, s[48:51], s18 offen lds
  s_add_u32 s18, s77, 16384
  s_add_u32 m0, s42, 5120
  s_nop 0
  buffer_load_dwordx4 v56, s[48:51], s18 offen lds
  s_add_u32 s18, s77, 262144
  s_add_u32 m0, s42, 6144
  s_nop 0
  buffer_load_dwordx4 v56, s[48:51], s18 offen lds
  s_add_u32 s18, s77, 278528
  s_add_u32 m0, s42, 7168
  s_nop 0
  buffer_load_dwordx4 v56, s[48:51], s18 offen lds
  s_add_u32 s18, s78, 0
  s_add_u32 m0, s42, 8192
  s_nop 0
  buffer_load_dwordx4 v56, s[48:51], s18 offen lds
  s_add_u32 s18, s78, 16384
  s_add_u32 m0, s42, 9216
  s_nop 0
  buffer_load_dwordx4 v56, s[48:51], s18 offen lds
  s_add_u32 s18, s78, 262144
  s_add_u32 m0, s42, 10240
  s_nop 0
  buffer_load_dwordx4 v56, s[48:51], s18 offen lds
  s_add_u32 s18, s78, 278528
  s_add_u32 m0, s42, 11264
  s_nop 0
  buffer_load_dwordx4 v56, s[48:51], s18 offen lds
  s_add_u32 s18, s79, 0
  s_add_u32 m0, s42, 12288
  s_nop 0
  buffer_load_dwordx4 v56, s[48:51], s18 offen lds
  s_add_u32 s18, s79, 16384
  s_add_u32 m0, s42, 13312
  s_nop 0
  buffer_load_dwordx4 v56, s[48:51], s18 offen lds
  s_add_u32 s18, s79, 262144
  s_add_u32 m0, s42, 14336
  s_nop 0
  buffer_load_dwordx4 v56, s[48:51], s18 offen lds
  s_add_u32 s18, s79, 278528
  s_add_u32 m0, s42, 15360
  s_nop 0
  buffer_load_dwordx4 v56, s[48:51], s18 offen lds
  s_add_u32 s18, s80, 0
  s_add_u32 m0, s42, 16384
  s_nop 0
  buffer_load_dwordx4 v56, s[48:51], s18 offen lds
  s_add_u32 s18, s80, 16384
  s_add_u32 m0, s42, 17408
  s_nop 0
  buffer_load_dwordx4 v56, s[48:51], s18 offen lds
  s_add_u32 s18, s80, 262144
  s_add_u32 m0, s42, 18432
  s_nop 0
  buffer_load_dwordx4 v56, s[48:51], s18 offen lds
  s_add_u32 s18, s80, 278528
  s_add_u32 m0, s42, 19456
  s_nop 0
  buffer_load_dwordx4 v56, s[48:51], s18 offen lds
  s_add_u32 s18, s81, 0
  s_add_u32 m0, s42, 20480
  s_nop 0
  buffer_load_dwordx4 v56, s[48:51], s18 offen lds
  s_add_u32 s18, s81, 16384
  s_add_u32 m0, s42, 21504
  s_nop 0
  buffer_load_dwordx4 v56, s[48:51], s18 offen lds
  s_add_u32 s18, s81, 262144
  s_add_u32 m0, s42, 22528
  s_nop 0
  buffer_load_dwordx4 v56, s[48:51], s18 offen lds
  s_add_u32 s18, s81, 278528
  s_add_u32 m0, s42, 23552
  s_nop 0
  buffer_load_dwordx4 v56, s[48:51], s18 offen lds
  v_and_b32 v58, 32, v61
  v_lshlrev_b32 v58, 7, v58
  v_and_b32 v60, 16, v61
  v_lshlrev_b32 v60, 11, v60
  v_add_u32 v58, v58, v60
  v_and_b32 v60, 15, v61
  v_lshlrev_b32 v60, 4, v60
  v_add_u32 v58, v58, v60
  s_lshl_b32 s18, s12, 17
  s_lshl_b32 s19, s13, 8
  s_add_u32 s18, s18, s19
  v_add_u32 v58, s18, v58
  s_waitcnt vmcnt(20)
  s_waitcnt lgkmcnt(0)
  s_barrier
  ds_read_b64_tr_b16 a[64:65], v57 offset:0
  ds_read_b64_tr_b16 a[72:73], v126 offset:0
  s_mov_b32 s18, 0
  buffer_load_dwordx4 a[0:3], v58, s[56:59], s18 offen
  s_mov_b32 s18, 1024
  buffer_load_dwordx4 a[4:7], v58, s[56:59], s18 offen
  ds_read_b64_tr_b16 a[66:67], v57 offset:1024
  ds_read_b64_tr_b16 a[74:75], v126 offset:1024
  s_mov_b32 s18, 16384
  buffer_load_dwordx4 a[8:11], v58, s[56:59], s18 offen
  s_mov_b32 s18, 17408
  buffer_load_dwordx4 a[12:15], v58, s[56:59], s18 offen
  ds_read_b64_tr_b16 a[68:69], v57 offset:2048
  ds_read_b64_tr_b16 a[76:77], v126 offset:2048
  s_mov_b32 s18, 2048
  buffer_load_dwordx4 a[16:19], v58, s[56:59], s18 offen
  s_mov_b32 s18, 3072
  buffer_load_dwordx4 a[20:23], v58, s[56:59], s18 offen
  ds_read_b64_tr_b16 a[70:71], v57 offset:3072
  ds_read_b64_tr_b16 a[78:79], v126 offset:3072
  s_mov_b32 s18, 18432
  buffer_load_dwordx4 a[24:27], v58, s[56:59], s18 offen
  s_mov_b32 s18, 19456
  buffer_load_dwordx4 a[28:31], v58, s[56:59], s18 offen
  s_waitcnt vmcnt(24)
  s_waitcnt lgkmcnt(0)
  s_barrier
  s_add_u32 s18, s82, 0
  s_add_u32 m0, s42, 24576
  s_nop 0
  buffer_load_dwordx4 v56, s[48:51], s18 offen lds
  s_add_u32 s18, s82, 16384
  s_add_u32 m0, s42, 25600
  s_nop 0
  buffer_load_dwordx4 v56, s[48:51], s18 offen lds
  s_add_u32 s18, s82, 262144
  s_add_u32 m0, s42, 26624
  s_nop 0
  buffer_load_dwordx4 v56, s[48:51], s18 offen lds
  s_add_u32 s18, s82, 278528
  s_add_u32 m0, s42, 27648
  s_nop 0
  buffer_load_dwordx4 v56, s[48:51], s18 offen lds
  ds_read_b64_tr_b16 a[80:81], v57 offset:4096
  ds_read_b64_tr_b16 a[88:89], v126 offset:4096
  s_mov_b32 s18, 8192
  buffer_load_dwordx4 a[32:35], v58, s[56:59], s18 offen
  s_mov_b32 s18, 9216
  buffer_load_dwordx4 a[36:39], v58, s[56:59], s18 offen
  ds_read_b64_tr_b16 a[82:83], v57 offset:5120
  ds_read_b64_tr_b16 a[90:91], v126 offset:5120
  s_mov_b32 s18, 24576
  buffer_load_dwordx4 a[40:43], v58, s[56:59], s18 offen
  s_mov_b32 s18, 25600
  buffer_load_dwordx4 a[44:47], v58, s[56:59], s18 offen
  ds_read_b64_tr_b16 a[84:85], v57 offset:6144
  ds_read_b64_tr_b16 a[92:93], v126 offset:6144
  s_lshl_b32 s25, 0, 5
  s_barrier
  s_cmp_lg_u32 s13, 0
  s_cbranch_scc1 L_ao_c0
  v_mov_b32 v53, 1
  s_mov_b64 exec, 1
  buffer_atomic_add v53, off, s[92:95], s25 offset:4
  s_mov_b64 exec, -1
  s_branch L_ad_c0
L_ao_c0:
  buffer_load_dword v53, off, s[4:7], 0
L_ad_c0:
  s_mov_b32 s18, 10240
  buffer_load_dwordx4 a[48:51], v58, s[56:59], s18 offen
  s_mov_b32 s18, 11264
  buffer_load_dwordx4 a[52:55], v58, s[56:59], s18 offen
  ds_read_b64_tr_b16 a[86:87], v57 offset:7168
  ds_read_b64_tr_b16 a[94:95], v126 offset:7168
  s_mov_b32 s18, 26624
  buffer_load_dwordx4 a[56:59], v58, s[56:59], s18 offen
  s_mov_b32 s18, 27648
  buffer_load_dwordx4 a[60:63], v58, s[56:59], s18 offen
  s_waitcnt vmcnt(33)
  s_waitcnt lgkmcnt(0)
  s_barrier
  s_add_u32 s18, s83, 0
  s_add_u32 m0, s42, 28672
  s_nop 0
  buffer_load_dwordx4 v56, s[48:51], s18 offen lds
  s_add_u32 s18, s83, 16384
  s_add_u32 m0, s42, 29696
  s_nop 0
  buffer_load_dwordx4 v56, s[48:51], s18 offen lds
  s_add_u32 s18, s83, 262144
  s_add_u32 m0, s42, 30720
  s_nop 0
  buffer_load_dwordx4 v56, s[48:51], s18 offen lds
  s_add_u32 s18, s83, 278528
  s_add_u32 m0, s42, 31744
  s_nop 0
  buffer_load_dwordx4 v56, s[48:51], s18 offen lds
  ds_read_b64_tr_b16 a[96:97], v57 offset:8192
  ds_read_b64_tr_b16 a[104:105], v126 offset:8192
  ds_read_b64_tr_b16 a[98:99], v57 offset:9216
  ds_read_b64_tr_b16 a[106:107], v126 offset:9216
  ds_read_b64_tr_b16 a[100:101], v57 offset:10240
  ds_read_b64_tr_b16 a[108:109], v126 offset:10240
  ds_read_b64_tr_b16 a[102:103], v57 offset:11264
  ds_read_b64_tr_b16 a[110:111], v126 offset:11264
  s_waitcnt vmcnt(33)
  s_waitcnt lgkmcnt(0)
  s_barrier
  s_add_u32 s18, s76, 0
  s_add_u32 m0, s42, 0
  s_nop 0
  buffer_load_dwordx4 v56, s[52:55], s18 offen lds
  s_add_u32 s18, s76, 16384
  s_add_u32 m0, s42, 1024
  s_nop 0
  buffer_load_dwordx4 v56, s[52:55], s18 offen lds
  s_add_u32 s18, s76, 262144
  s_add_u32 m0, s42, 2048
  s_nop 0
  buffer_load_dwordx4 v56, s[52:55], s18 offen lds
  s_add_u32 s18, s76, 278528
  s_add_u32 m0, s42, 3072
  s_nop 0
  buffer_load_dwordx4 v56, s[52:55], s18 offen lds
  ds_read_b64_tr_b16 a[112:113], v57 offset:12288
  ds_read_b64_tr_b16 a[120:121], v126 offset:12288
  ds_read_b64_tr_b16 a[114:115], v57 offset:13312
  ds_read_b64_tr_b16 a[122:123], v126 offset:13312
  ds_read_b64_tr_b16 a[116:117], v57 offset:14336
  ds_read_b64_tr_b16 a[124:125], v126 offset:14336
  ds_read_b64_tr_b16 a[118:119], v57 offset:15360
  ds_read_b64_tr_b16 a[126:127], v126 offset:15360
  s_waitcnt vmcnt(33)
  s_waitcnt lgkmcnt(0)
  s_barrier
  s_add_u32 s18, s77, 0
  s_add_u32 m0, s42, 4096
  s_nop 0
  buffer_load_dwordx4 v56, s[52:55], s18 offen lds
  s_add_u32 s18, s77, 16384
  s_add_u32 m0, s42, 5120
  s_nop 0
  buffer_load_dwordx4 v56, s[52:55], s18 offen lds
  s_add_u32 s18, s77, 262144
  s_add_u32 m0, s42, 6144
  s_nop 0
  buffer_load_dwordx4 v56, s[52:55], s18 offen lds
  s_add_u32 s18, s77, 278528
  s_add_u32 m0, s42, 7168
  s_nop 0
  buffer_load_dwordx4 v56, s[52:55], s18 offen lds
  ds_read_b64_tr_b16 a[128:129], v57 offset:16384
  ds_read_b64_tr_b16 a[136:137], v126 offset:16384
  ds_read_b64_tr_b16 a[130:131], v57 offset:17408
  ds_read_b64_tr_b16 a[138:139], v126 offset:17408
  ds_read_b64_tr_b16 a[132:133], v57 offset:18432
  ds_read_b64_tr_b16 a[140:141], v126 offset:18432
  ds_read_b64_tr_b16 a[134:135], v57 offset:19456
  ds_read_b64_tr_b16 a[142:143], v126 offset:19456
  s_waitcnt vmcnt(33)
  s_waitcnt lgkmcnt(0)
  s_barrier
  s_add_u32 s18, s78, 0
  s_add_u32 m0, s42, 8192
  s_nop 0
  buffer_load_dwordx4 v56, s[52:55], s18 offen lds
  s_add_u32 s18, s78, 16384
  s_add_u32 m0, s42, 9216
  s_nop 0
  buffer_load_dwordx4 v56, s[52:55], s18 offen lds
  s_add_u32 s18, s78, 262144
  s_add_u32 m0, s42, 10240
  s_nop 0
  buffer_load_dwordx4 v56, s[52:55], s18 offen lds
  s_add_u32 s18, s78, 278528
  s_add_u32 m0, s42, 11264
  s_nop 0
  buffer_load_dwordx4 v56, s[52:55], s18 offen lds
  ds_read_b64_tr_b16 a[144:145], v57 offset:20480
  ds_read_b64_tr_b16 a[152:153], v126 offset:20480
  s_waitcnt vmcnt(36)
  v_accvgpr_read_b32 v118, a0
  v_accvgpr_read_b32 v119, a1
  v_accvgpr_read_b32 v120, a2
  v_accvgpr_read_b32 v121, a3
  s_waitcnt vmcnt(35)
  v_accvgpr_read_b32 v122, a4
  v_accvgpr_read_b32 v123, a5
  v_accvgpr_read_b32 v124, a6
  v_accvgpr_read_b32 v125, a7
  v_perm_b32 v32, v122, v118, s40
  v_perm_b32 v70, v122, v118, s41
  v_perm_b32 v192, v123, v119, s40
  v_perm_b32 v200, v123, v119, s41
  v_perm_b32 v86, v124, v120, s40
  v_perm_b32 v208, v124, v120, s41
  v_perm_b32 v216, v125, v121, s40
  v_perm_b32 v102, v125, v121, s41
  s_mov_b32 s18, 65536
  buffer_load_dwordx4 a[0:3], v58, s[56:59], s18 offen
  s_mov_b32 s18, 66560
  buffer_load_dwordx4 a[4:7], v58, s[56:59], s18 offen
  ds_read_b64_tr_b16 a[146:147], v57 offset:21504
  ds_read_b64_tr_b16 a[154:155], v126 offset:21504
  s_waitcnt vmcnt(36)
  v_accvgpr_read_b32 v118, a8
  v_accvgpr_read_b32 v119, a9
  v_accvgpr_read_b32 v120, a10
  v_accvgpr_read_b32 v121, a11
  s_waitcnt vmcnt(35)
  v_accvgpr_read_b32 v122, a12
  v_accvgpr_read_b32 v123, a13
  v_accvgpr_read_b32 v124, a14
  v_accvgpr_read_b32 v125, a15
  v_perm_b32 v33, v122, v118, s40
  v_perm_b32 v71, v122, v118, s41
  v_perm_b32 v193, v123, v119, s40
  v_perm_b32 v201, v123, v119, s41
  v_perm_b32 v87, v124, v120, s40
  v_perm_b32 v209, v124, v120, s41
  v_perm_b32 v217, v125, v121, s40
  v_perm_b32 v103, v125, v121, s41
  s_mov_b32 s18, 81920
  buffer_load_dwordx4 a[8:11], v58, s[56:59], s18 offen
  s_mov_b32 s18, 82944
  buffer_load_dwordx4 a[12:15], v58, s[56:59], s18 offen
  ds_read_b64_tr_b16 a[148:149], v57 offset:22528
  ds_read_b64_tr_b16 a[156:157], v126 offset:22528
  s_waitcnt vmcnt(36)
  v_accvgpr_read_b32 v118, a16
  v_accvgpr_read_b32 v119, a17
  v_accvgpr_read_b32 v120, a18
  v_accvgpr_read_b32 v121, a19
  s_waitcnt vmcnt(35)
  v_accvgpr_read_b32 v122, a20
  v_accvgpr_read_b32 v123, a21
  v_accvgpr_read_b32 v124, a22
  v_accvgpr_read_b32 v125, a23
  v_perm_b32 v34, v122, v118, s40
  v_perm_b32 v72, v122, v118, s41
  v_perm_b32 v194, v123, v119, s40
  v_perm_b32 v202, v123, v119, s41
  v_perm_b32 v88, v124, v120, s40
  v_perm_b32 v210, v124, v120, s41
  v_perm_b32 v218, v125, v121, s40
  v_perm_b32 v104, v125, v121, s41
  s_mov_b32 s18, 67584
  buffer_load_dwordx4 a[16:19], v58, s[56:59], s18 offen
  s_mov_b32 s18, 68608
  buffer_load_dwordx4 a[20:23], v58, s[56:59], s18 offen
  ds_read_b64_tr_b16 a[150:151], v57 offset:23552
  ds_read_b64_tr_b16 a[158:159], v126 offset:23552
  s_waitcnt vmcnt(36)
  v_accvgpr_read_b32 v118, a24
  v_accvgpr_read_b32 v119, a25
  v_accvgpr_read_b32 v120, a26
  v_accvgpr_read_b32 v121, a27
  s_waitcnt vmcnt(35)
  v_accvgpr_read_b32 v122, a28
  v_accvgpr_read_b32 v123, a29
  v_accvgpr_read_b32 v124, a30
  v_accvgpr_read_b32 v125, a31
  v_perm_b32 v35, v122, v118, s40
  v_perm_b32 v73, v122, v118, s41
  v_perm_b32 v195, v123, v119, s40
  v_perm_b32 v203, v123, v119, s41
  v_perm_b32 v89, v124, v120, s40
  v_perm_b32 v211, v124, v120, s41
  v_perm_b32 v219, v125, v121, s40
  v_perm_b32 v105, v125, v121, s41
  s_mov_b32 s18, 83968
  buffer_load_dwordx4 a[24:27], v58, s[56:59], s18 offen
  s_mov_b32 s18, 84992
  buffer_load_dwordx4 a[28:31], v58, s[56:59], s18 offen
  s_waitcnt vmcnt(33)
  s_waitcnt lgkmcnt(0)
  s_barrier
  s_add_u32 s18, s79, 0
  s_add_u32 m0, s42, 12288
  s_nop 0
  buffer_load_dwordx4 v56, s[52:55], s18 offen lds
  s_add_u32 s18, s79, 16384
  s_add_u32 m0, s42, 13312
  s_nop 0
  buffer_load_dwordx4 v56, s[52:55], s18 offen lds
  s_add_u32 s18, s79, 262144
  s_add_u32 m0, s42, 14336
  s_nop 0
  buffer_load_dwordx4 v56, s[52:55], s18 offen lds
  s_add_u32 s18, s79, 278528
  s_add_u32 m0, s42, 15360
  s_nop 0
  buffer_load_dwordx4 v56, s[52:55], s18 offen lds
  ds_read_b64_tr_b16 a[160:161], v57 offset:24576
  ds_read_b64_tr_b16 a[168:169], v126 offset:24576
  s_waitcnt vmcnt(36)
  v_accvgpr_read_b32 v118, a32
  v_accvgpr_read_b32 v119, a33
  v_accvgpr_read_b32 v120, a34
  v_accvgpr_read_b32 v121, a35
  s_waitcnt vmcnt(35)
  v_accvgpr_read_b32 v122, a36
  v_accvgpr_read_b32 v123, a37
  v_accvgpr_read_b32 v124, a38
  v_accvgpr_read_b32 v125, a39
  v_perm_b32 v36, v122, v118, s40
  v_perm_b32 v74, v122, v118, s41
  v_perm_b32 v196, v123, v119, s40
  v_perm_b32 v204, v123, v119, s41
  v_perm_b32 v90, v124, v120, s40
  v_perm_b32 v212, v124, v120, s41
  v_perm_b32 v220, v125, v121, s40
  v_perm_b32 v106, v125, v121, s41
  s_mov_b32 s18, 73728
  buffer_load_dwordx4 a[32:35], v58, s[56:59], s18 offen
  s_mov_b32 s18, 74752
  buffer_load_dwordx4 a[36:39], v58, s[56:59], s18 offen
  ds_read_b64_tr_b16 a[162:163], v57 offset:25600
  ds_read_b64_tr_b16 a[170:171], v126 offset:25600
  s_waitcnt vmcnt(36)
  v_accvgpr_read_b32 v118, a40
  v_accvgpr_read_b32 v119, a41
  v_accvgpr_read_b32 v120, a42
  v_accvgpr_read_b32 v121, a43
  s_waitcnt vmcnt(35)
  v_accvgpr_read_b32 v122, a44
  v_accvgpr_read_b32 v123, a45
  v_accvgpr_read_b32 v124, a46
  v_accvgpr_read_b32 v125, a47
  v_perm_b32 v37, v122, v118, s40
  v_perm_b32 v75, v122, v118, s41
  v_perm_b32 v197, v123, v119, s40
  v_perm_b32 v205, v123, v119, s41
  v_perm_b32 v91, v124, v120, s40
  v_perm_b32 v213, v124, v120, s41
  v_perm_b32 v221, v125, v121, s40
  v_perm_b32 v107, v125, v121, s41
  s_mov_b32 s18, 90112
  buffer_load_dwordx4 a[40:43], v58, s[56:59], s18 offen
  s_mov_b32 s18, 91136
  buffer_load_dwordx4 a[44:47], v58, s[56:59], s18 offen
  ds_read_b64_tr_b16 a[164:165], v57 offset:26624
  ds_read_b64_tr_b16 a[172:173], v126 offset:26624
  s_waitcnt vmcnt(35)
  v_accvgpr_read_b32 v118, a48
  v_accvgpr_read_b32 v119, a49
  v_accvgpr_read_b32 v120, a50
  v_accvgpr_read_b32 v121, a51
  s_waitcnt vmcnt(34)
  v_accvgpr_read_b32 v122, a52
  v_accvgpr_read_b32 v123, a53
  v_accvgpr_read_b32 v124, a54
  v_accvgpr_read_b32 v125, a55
  v_perm_b32 v38, v122, v118, s40
  v_perm_b32 v76, v122, v118, s41
  v_perm_b32 v198, v123, v119, s40
  v_perm_b32 v206, v123, v119, s41
  v_perm_b32 v92, v124, v120, s40
  v_perm_b32 v214, v124, v120, s41
  v_perm_b32 v222, v125, v121, s40
  v_perm_b32 v108, v125, v121, s41
  s_mov_b32 s18, 75776
  buffer_load_dwordx4 a[48:51], v58, s[56:59], s18 offen
  s_mov_b32 s18, 76800
  buffer_load_dwordx4 a[52:55], v58, s[56:59], s18 offen
  ds_read_b64_tr_b16 a[166:167], v57 offset:27648
  ds_read_b64_tr_b16 a[174:175], v126 offset:27648
  s_waitcnt vmcnt(35)
  v_accvgpr_read_b32 v118, a56
  v_accvgpr_read_b32 v119, a57
  v_accvgpr_read_b32 v120, a58
  v_accvgpr_read_b32 v121, a59
  s_waitcnt vmcnt(34)
  v_accvgpr_read_b32 v122, a60
  v_accvgpr_read_b32 v123, a61
  v_accvgpr_read_b32 v124, a62
  v_accvgpr_read_b32 v125, a63
  v_perm_b32 v39, v122, v118, s40
  v_perm_b32 v77, v122, v118, s41
  v_perm_b32 v199, v123, v119, s40
  v_perm_b32 v207, v123, v119, s41
  v_perm_b32 v93, v124, v120, s40
  v_perm_b32 v215, v124, v120, s41
  v_perm_b32 v223, v125, v121, s40
  v_perm_b32 v109, v125, v121, s41
  s_mov_b32 s18, 92160
  buffer_load_dwordx4 a[56:59], v58, s[56:59], s18 offen
  s_mov_b32 s18, 93184
  buffer_load_dwordx4 a[60:63], v58, s[56:59], s18 offen
  s_waitcnt vmcnt(32)
  s_waitcnt lgkmcnt(0)
  s_barrier
  s_add_u32 s18, s80, 0
  s_add_u32 m0, s42, 16384
  s_nop 0
  buffer_load_dwordx4 v56, s[52:55], s18 offen lds
  s_add_u32 s18, s80, 16384
  s_add_u32 m0, s42, 17408
  s_nop 0
  buffer_load_dwordx4 v56, s[52:55], s18 offen lds
  s_add_u32 s18, s80, 262144
  s_add_u32 m0, s42, 18432
  s_nop 0
  buffer_load_dwordx4 v56, s[52:55], s18 offen lds
  s_add_u32 s18, s80, 278528
  s_add_u32 m0, s42, 19456
  s_nop 0
  buffer_load_dwordx4 v56, s[52:55], s18 offen lds
  ds_read_b64_tr_b16 a[176:177], v57 offset:28672
  ds_read_b64_tr_b16 a[184:185], v126 offset:28672
  ds_read_b64_tr_b16 a[178:179], v57 offset:29696
  ds_read_b64_tr_b16 a[186:187], v126 offset:29696
  ds_read_b64_tr_b16 a[180:181], v57 offset:30720
  ds_read_b64_tr_b16 a[188:189], v126 offset:30720
  ds_read_b64_tr_b16 a[182:183], v57 offset:31744
  ds_read_b64_tr_b16 a[190:191], v126 offset:31744
  s_waitcnt vmcnt(32)
  s_waitcnt lgkmcnt(0)
  s_barrier
  s_add_u32 s18, s81, 0
  s_add_u32 m0, s42, 20480
  s_nop 0
  buffer_load_dwordx4 v56, s[52:55], s18 offen lds
  s_add_u32 s18, s81, 16384
  s_add_u32 m0, s42, 21504
  s_nop 0
  buffer_load_dwordx4 v56, s[52:55], s18 offen lds
  s_add_u32 s18, s81, 262144
  s_add_u32 m0, s42, 22528
  s_nop 0
  buffer_load_dwordx4 v56, s[52:55], s18 offen lds
  s_add_u32 s18, s81, 278528
  s_add_u32 m0, s42, 23552
  s_nop 0
  buffer_load_dwordx4 v56, s[52:55], s18 offen lds
  ds_read_b64_tr_b16 a[192:193], v57 offset:0
  ds_read_b64_tr_b16 a[200:201], v126 offset:0
  ds_read_b64_tr_b16 a[194:195], v57 offset:1024
  ds_read_b64_tr_b16 a[202:203], v126 offset:1024
  ds_read_b64_tr_b16 a[196:197], v57 offset:2048
  ds_read_b64_tr_b16 a[204:205], v126 offset:2048
  ds_read_b64_tr_b16 a[198:199], v57 offset:3072
  ds_read_b64_tr_b16 a[206:207], v126 offset:3072
  s_waitcnt vmcnt(32)
  s_waitcnt lgkmcnt(0)
  s_barrier
  s_add_u32 s18, s82, 0
  s_add_u32 m0, s42, 24576
  s_nop 0
  buffer_load_dwordx4 v56, s[52:55], s18 offen lds
  s_add_u32 s18, s82, 16384
  s_add_u32 m0, s42, 25600
  s_nop 0
  buffer_load_dwordx4 v56, s[52:55], s18 offen lds
  s_add_u32 s18, s82, 262144
  s_add_u32 m0, s42, 26624
  s_nop 0
  buffer_load_dwordx4 v56, s[52:55], s18 offen lds
  s_add_u32 s18, s82, 278528
  s_add_u32 m0, s42, 27648
  s_nop 0
  buffer_load_dwordx4 v56, s[52:55], s18 offen lds
  ds_read_b64_tr_b16 a[208:209], v57 offset:4096
  ds_read_b64_tr_b16 a[216:217], v126 offset:4096
  ds_read_b64_tr_b16 a[210:211], v57 offset:5120
  ds_read_b64_tr_b16 a[218:219], v126 offset:5120
  ds_read_b64_tr_b16 a[212:213], v57 offset:6144
  ds_read_b64_tr_b16 a[220:221], v126 offset:6144
  ds_read_b64_tr_b16 a[214:215], v57 offset:7168
  ds_read_b64_tr_b16 a[222:223], v126 offset:7168
  s_waitcnt vmcnt(32)
  s_waitcnt lgkmcnt(0)
  s_barrier
  s_add_u32 s18, s83, 0
  s_add_u32 m0, s42, 28672
  s_nop 0
  buffer_load_dwordx4 v56, s[52:55], s18 offen lds
  s_add_u32 s18, s83, 16384
  s_add_u32 m0, s42, 29696
  s_nop 0
  buffer_load_dwordx4 v56, s[52:55], s18 offen lds
  s_add_u32 s18, s83, 262144
  s_add_u32 m0, s42, 30720
  s_nop 0
  buffer_load_dwordx4 v56, s[52:55], s18 offen lds
  s_add_u32 s18, s83, 278528
  s_add_u32 m0, s42, 31744
  s_nop 0
  buffer_load_dwordx4 v56, s[52:55], s18 offen lds
  ds_read_b64_tr_b16 a[224:225], v57 offset:8192
  ds_read_b64_tr_b16 a[232:233], v126 offset:8192
  s_waitcnt vmcnt(35)
  v_accvgpr_read_b32 v118, a0
  v_accvgpr_read_b32 v119, a1
  v_accvgpr_read_b32 v120, a2
  v_accvgpr_read_b32 v121, a3
  s_waitcnt vmcnt(34)
  v_accvgpr_read_b32 v122, a4
  v_accvgpr_read_b32 v123, a5
  v_accvgpr_read_b32 v124, a6
  v_accvgpr_read_b32 v125, a7
  v_perm_b32 v62, v122, v118, s40
  v_perm_b32 v78, v122, v118, s41
  v_perm_b32 v224, v123, v119, s40
  v_perm_b32 v232, v123, v119, s41
  v_perm_b32 v94, v124, v120, s40
  v_perm_b32 v240, v124, v120, s41
  v_perm_b32 v248, v125, v121, s40
  v_perm_b32 v110, v125, v121, s41
  ds_read_b64_tr_b16 a[226:227], v57 offset:9216
  ds_read_b64_tr_b16 a[234:235], v126 offset:9216
  s_waitcnt vmcnt(33)
  v_accvgpr_read_b32 v118, a8
  v_accvgpr_read_b32 v119, a9
  v_accvgpr_read_b32 v120, a10
  v_accvgpr_read_b32 v121, a11
  s_waitcnt vmcnt(32)
  v_accvgpr_read_b32 v122, a12
  v_accvgpr_read_b32 v123, a13
  v_accvgpr_read_b32 v124, a14
  v_accvgpr_read_b32 v125, a15
  v_perm_b32 v63, v122, v118, s40
  v_perm_b32 v79, v122, v118, s41
  v_perm_b32 v225, v123, v119, s40
  v_perm_b32 v233, v123, v119, s41
  v_perm_b32 v95, v124, v120, s40
  v_perm_b32 v241, v124, v120, s41
  v_perm_b32 v249, v125, v121, s40
  v_perm_b32 v111, v125, v121, s41
  ds_read_b64_tr_b16 a[228:229], v57 offset:10240
  ds_read_b64_tr_b16 a[236:237], v126 offset:10240
  s_waitcnt vmcnt(31)
  v_accvgpr_read_b32 v118, a16
  v_accvgpr_read_b32 v119, a17
  v_accvgpr_read_b32 v120, a18
  v_accvgpr_read_b32 v121, a19
  s_waitcnt vmcnt(30)
  v_accvgpr_read_b32 v122, a20
  v_accvgpr_read_b32 v123, a21
  v_accvgpr_read_b32 v124, a22
  v_accvgpr_read_b32 v125, a23
  v_perm_b32 v64, v122, v118, s40
  v_perm_b32 v80, v122, v118, s41
  v_perm_b32 v226, v123, v119, s40
  v_perm_b32 v234, v123, v119, s41
  v_perm_b32 v96, v124, v120, s40
  v_perm_b32 v242, v124, v120, s41
  v_perm_b32 v250, v125, v121, s40
  v_perm_b32 v112, v125, v121, s41
  ds_read_b64_tr_b16 a[230:231], v57 offset:11264
  ds_read_b64_tr_b16 a[238:239], v126 offset:11264
  s_waitcnt vmcnt(29)
  v_accvgpr_read_b32 v118, a24
  v_accvgpr_read_b32 v119, a25
  v_accvgpr_read_b32 v120, a26
  v_accvgpr_read_b32 v121, a27
  s_waitcnt vmcnt(28)
  v_accvgpr_read_b32 v122, a28
  v_accvgpr_read_b32 v123, a29
  v_accvgpr_read_b32 v124, a30
  v_accvgpr_read_b32 v125, a31
  v_perm_b32 v65, v122, v118, s40
  v_perm_b32 v81, v122, v118, s41
  v_perm_b32 v227, v123, v119, s40
  v_perm_b32 v235, v123, v119, s41
  v_perm_b32 v97, v124, v120, s40
  v_perm_b32 v243, v124, v120, s41
  v_perm_b32 v251, v125, v121, s40
  v_perm_b32 v113, v125, v121, s41
  s_waitcnt vmcnt(24)
  s_waitcnt lgkmcnt(0)
  s_barrier
  s_add_u32 s18, s78, 0
  s_add_u32 m0, s42, 0
  s_nop 0
  buffer_load_dwordx4 v56, s[44:47], s18 offen lds
  s_add_u32 s18, s78, 16384
  s_add_u32 m0, s42, 1024
  s_nop 0
  buffer_load_dwordx4 v56, s[44:47], s18 offen lds
  s_add_u32 s18, s78, 262144
  s_add_u32 m0, s42, 2048
  s_nop 0
  buffer_load_dwordx4 v56, s[44:47], s18 offen lds
  s_add_u32 s18, s78, 278528
  s_add_u32 m0, s42, 3072
  s_nop 0
  buffer_load_dwordx4 v56, s[44:47], s18 offen lds
  ds_read_b64_tr_b16 a[240:241], v57 offset:12288
  ds_read_b64_tr_b16 a[248:249], v126 offset:12288
  s_waitcnt vmcnt(27)
  v_accvgpr_read_b32 v118, a32
  v_accvgpr_read_b32 v119, a33
  v_accvgpr_read_b32 v120, a34
  v_accvgpr_read_b32 v121, a35
  s_waitcnt vmcnt(26)
  v_accvgpr_read_b32 v122, a36
  v_accvgpr_read_b32 v123, a37
  v_accvgpr_read_b32 v124, a38
  v_accvgpr_read_b32 v125, a39
  v_perm_b32 v66, v122, v118, s40
  v_perm_b32 v82, v122, v118, s41
  v_perm_b32 v228, v123, v119, s40
  v_perm_b32 v236, v123, v119, s41
  v_perm_b32 v98, v124, v120, s40
  v_perm_b32 v244, v124, v120, s41
  v_perm_b32 v252, v125, v121, s40
  v_perm_b32 v114, v125, v121, s41
  ds_read_b64_tr_b16 a[242:243], v57 offset:13312
  ds_read_b64_tr_b16 a[250:251], v126 offset:13312
  s_waitcnt vmcnt(25)
  v_accvgpr_read_b32 v118, a40
  v_accvgpr_read_b32 v119, a41
  v_accvgpr_read_b32 v120, a42
  v_accvgpr_read_b32 v121, a43
  s_waitcnt vmcnt(24)
  v_accvgpr_read_b32 v122, a44
  v_accvgpr_read_b32 v123, a45
  v_accvgpr_read_b32 v124, a46
  v_accvgpr_read_b32 v125, a47
  v_perm_b32 v67, v122, v118, s40
  v_perm_b32 v83, v122, v118, s41
  v_perm_b32 v229, v123, v119, s40
  v_perm_b32 v237, v123, v119, s41
  v_perm_b32 v99, v124, v120, s40
  v_perm_b32 v245, v124, v120, s41
  v_perm_b32 v253, v125, v121, s40
  v_perm_b32 v115, v125, v121, s41
  ds_read_b64_tr_b16 a[244:245], v57 offset:14336
  ds_read_b64_tr_b16 a[252:253], v126 offset:14336
  s_waitcnt vmcnt(23)
  v_accvgpr_read_b32 v118, a48
  v_accvgpr_read_b32 v119, a49
  v_accvgpr_read_b32 v120, a50
  v_accvgpr_read_b32 v121, a51
  s_waitcnt vmcnt(22)
  v_accvgpr_read_b32 v122, a52
  v_accvgpr_read_b32 v123, a53
  v_accvgpr_read_b32 v124, a54
  v_accvgpr_read_b32 v125, a55
  v_perm_b32 v68, v122, v118, s40
  v_perm_b32 v84, v122, v118, s41
  v_perm_b32 v230, v123, v119, s40
  v_perm_b32 v238, v123, v119, s41
  v_perm_b32 v100, v124, v120, s40
  v_perm_b32 v246, v124, v120, s41
  v_perm_b32 v254, v125, v121, s40
  v_perm_b32 v116, v125, v121, s41
  ds_read_b64_tr_b16 a[246:247], v57 offset:15360
  ds_read_b64_tr_b16 a[254:255], v126 offset:15360
  s_waitcnt vmcnt(21)
  v_accvgpr_read_b32 v118, a56
  v_accvgpr_read_b32 v119, a57
  v_accvgpr_read_b32 v120, a58
  v_accvgpr_read_b32 v121, a59
  s_waitcnt vmcnt(20)
  v_accvgpr_read_b32 v122, a60
  v_accvgpr_read_b32 v123, a61
  v_accvgpr_read_b32 v124, a62
  v_accvgpr_read_b32 v125, a63
  v_perm_b32 v69, v122, v118, s40
  v_perm_b32 v85, v122, v118, s41
  v_perm_b32 v231, v123, v119, s40
  v_perm_b32 v239, v123, v119, s41
  v_perm_b32 v101, v124, v120, s40
  v_perm_b32 v247, v124, v120, s41
  v_perm_b32 v255, v125, v121, s40
  v_perm_b32 v117, v125, v121, s41
  s_waitcnt vmcnt(16)
  s_waitcnt lgkmcnt(0)
  s_barrier
  s_add_u32 s18, s79, 0
  s_add_u32 m0, s42, 4096
  s_nop 0
  buffer_load_dwordx4 v56, s[44:47], s18 offen lds
  s_add_u32 s18, s79, 16384
  s_add_u32 m0, s42, 5120
  s_nop 0
  buffer_load_dwordx4 v56, s[44:47], s18 offen lds
  s_add_u32 s18, s79, 262144
  s_add_u32 m0, s42, 6144
  s_nop 0
  buffer_load_dwordx4 v56, s[44:47], s18 offen lds
  s_add_u32 s18, s79, 278528
  s_add_u32 m0, s42, 7168
  s_nop 0
  buffer_load_dwordx4 v56, s[44:47], s18 offen lds
  ds_read_b64_tr_b16 v[128:129], v57 offset:16384
  ds_read_b64_tr_b16 v[136:137], v126 offset:16384
  ds_read_b64_tr_b16 v[130:131], v57 offset:17408
  ds_read_b64_tr_b16 v[138:139], v126 offset:17408
  ds_read_b64_tr_b16 v[132:133], v57 offset:18432
  ds_read_b64_tr_b16 v[140:141], v126 offset:18432
  ds_read_b64_tr_b16 v[134:135], v57 offset:19456
  ds_read_b64_tr_b16 v[142:143], v126 offset:19456
  s_waitcnt vmcnt(16)
  s_waitcnt lgkmcnt(0)
  s_barrier
  ds_read_b64_tr_b16 v[144:145], v57 offset:20480
  ds_read_b64_tr_b16 v[152:153], v126 offset:20480
  ds_read_b64_tr_b16 v[146:147], v57 offset:21504
  ds_read_b64_tr_b16 v[154:155], v126 offset:21504
  ds_read_b64_tr_b16 v[148:149], v57 offset:22528
  ds_read_b64_tr_b16 v[156:157], v126 offset:22528
  ds_read_b64_tr_b16 v[150:151], v57 offset:23552
  ds_read_b64_tr_b16 v[158:159], v126 offset:23552
  s_waitcnt vmcnt(12)
  s_waitcnt lgkmcnt(0)
  s_barrier
  ds_read_b64_tr_b16 v[160:161], v57 offset:24576
  ds_read_b64_tr_b16 v[168:169], v126 offset:24576
  s_getpc_b64 s[86:87]
L_pc1:
  s_add_u32 s86, s86, L_chain_fast-L_pc1
  s_addc_u32 s87, s87, 0
  s_lshl_b32 s18, s13, 11
  v_add_u32 v59, s18, v0
  global_load_dwordx4 v[118:121], v59, s[86:87]
  global_load_dwordx4 v[118:121], v59, s[86:87] offset:1024
  ds_read_b64_tr_b16 v[162:163], v57 offset:25600
  ds_read_b64_tr_b16 v[170:171], v126 offset:25600
  ds_read_b64_tr_b16 v[164:165], v57 offset:26624
  ds_read_b64_tr_b16 v[172:173], v126 offset:26624
  ds_read_b64_tr_b16 v[166:167], v57 offset:27648
  ds_read_b64_tr_b16 v[174:175], v126 offset:27648
  s_waitcnt vmcnt(10)
  s_waitcnt lgkmcnt(0)
  s_barrier
  s_add_u32 s18, s80, 0
  s_add_u32 m0, s42, 24576
  s_nop 0
  buffer_load_dwordx4 v56, s[44:47], s18 offen lds
  s_add_u32 s18, s80, 16384
  s_add_u32 m0, s42, 25600
  s_nop 0
  buffer_load_dwordx4 v56, s[44:47], s18 offen lds
  s_add_u32 s18, s80, 262144
  s_add_u32 m0, s42, 26624
  s_nop 0
  buffer_load_dwordx4 v56, s[44:47], s18 offen lds
  s_add_u32 s18, s80, 278528
  s_add_u32 m0, s42, 27648
  s_nop 0
  buffer_load_dwordx4 v56, s[44:47], s18 offen lds
  ds_read_b64_tr_b16 v[176:177], v57 offset:28672
  ds_read_b64_tr_b16 v[184:185], v126 offset:28672
  ds_read_b64_tr_b16 v[178:179], v57 offset:29696
  ds_read_b64_tr_b16 v[186:187], v126 offset:29696
  ds_read_b64_tr_b16 v[180:181], v57 offset:30720
  ds_read_b64_tr_b16 v[188:189], v126 offset:30720
  ds_read_b64_tr_b16 v[182:183], v57 offset:31744
  ds_read_b64_tr_b16 v[190:191], v126 offset:31744
  s_waitcnt vmcnt(10)
  s_waitcnt lgkmcnt(0)
  s_barrier
  s_add_u32 s18, s81, 0
  s_add_u32 m0, s42, 28672
  s_nop 0
  buffer_load_dwordx4 v56, s[44:47], s18 offen lds
  s_add_u32 s18, s81, 16384
  s_add_u32 m0, s42, 29696
  s_nop 0
  buffer_load_dwordx4 v56, s[44:47], s18 offen lds
  s_add_u32 s18, s81, 262144
  s_add_u32 m0, s42, 30720
  s_nop 0
  buffer_load_dwordx4 v56, s[44:47], s18 offen lds
  s_add_u32 s18, s81, 278528
  s_add_u32 m0, s42, 31744
  s_nop 0
  buffer_load_dwordx4 v56, s[44:47], s18 offen lds
  s_add_u32 s18, s76, 0
  s_add_u32 m0, s42, 16384
  s_nop 0
  buffer_load_dwordx4 v56, s[44:47], s18 offen lds
  s_add_u32 s18, s76, 16384
  s_add_u32 m0, s42, 17408
  s_nop 0
  buffer_load_dwordx4 v56, s[44:47], s18 offen lds
  s_add_u32 s18, s76, 262144
  s_add_u32 m0, s42, 18432
  s_nop 0
  buffer_load_dwordx4 v56, s[44:47], s18 offen lds
  s_add_u32 s18, s76, 278528
  s_add_u32 m0, s42, 19456
  s_nop 0
  buffer_load_dwordx4 v56, s[44:47], s18 offen lds
  s_add_u32 s18, s77, 0
  s_add_u32 m0, s42, 20480
  s_nop 0
  buffer_load_dwordx4 v56, s[44:47], s18 offen lds
  s_add_u32 s18, s77, 16384
  s_add_u32 m0, s42, 21504
  s_nop 0
  buffer_load_dwordx4 v56, s[44:47], s18 offen lds
  s_add_u32 s18, s77, 262144
  s_add_u32 m0, s42, 22528
  s_nop 0
  buffer_load_dwordx4 v56, s[44:47], s18 offen lds
  s_add_u32 s18, s77, 278528
  s_add_u32 m0, s42, 23552
  s_nop 0
  buffer_load_dwordx4 v56, s[44:47], s18 offen lds
  ds_read_b64_tr_b16 a[0:1], v57 offset:0
  ds_read_b64_tr_b16 a[8:9], v126 offset:0
  ds_read_b64_tr_b16 a[2:3], v57 offset:1024
  ds_read_b64_tr_b16 a[10:11], v126 offset:1024
  ds_read_b64_tr_b16 a[4:5], v57 offset:2048
  ds_read_b64_tr_b16 a[12:13], v126 offset:2048
  ds_read_b64_tr_b16 a[6:7], v57 offset:3072
  ds_read_b64_tr_b16 a[14:15], v126 offset:3072
  s_waitcnt vmcnt(18)
  s_waitcnt lgkmcnt(0)
  s_barrier
  ds_read_b64_tr_b16 a[16:17], v57 offset:4096
  ds_read_b64_tr_b16 a[24:25], v126 offset:4096
  ds_read_b64_tr_b16 a[18:19], v57 offset:5120
  ds_read_b64_tr_b16 a[26:27], v126 offset:5120
  ds_read_b64_tr_b16 a[20:21], v57 offset:6144
  ds_read_b64_tr_b16 a[28:29], v126 offset:6144
  ds_read_b64_tr_b16 a[22:23], v57 offset:7168
  ds_read_b64_tr_b16 a[30:31], v126 offset:7168
  s_waitcnt vmcnt(12)
  s_waitcnt lgkmcnt(0)
  s_barrier
  ds_read_b64_tr_b16 a[32:33], v57 offset:24576
  ds_read_b64_tr_b16 a[40:41], v126 offset:24576
  ds_read_b64_tr_b16 a[34:35], v57 offset:25600
  ds_read_b64_tr_b16 a[42:43], v126 offset:25600
  ds_read_b64_tr_b16 a[36:37], v57 offset:26624
  ds_read_b64_tr_b16 a[44:45], v126 offset:26624
  ds_read_b64_tr_b16 a[38:39], v57 offset:27648
  ds_read_b64_tr_b16 a[46:47], v126 offset:27648
  s_waitcnt vmcnt(8)
  s_waitcnt lgkmcnt(0)
  s_barrier
  s_add_u32 s18, s82, 0
  s_add_u32 m0, s42, 24576
  s_nop 0
  buffer_load_dwordx4 v56, s[44:47], s18 offen lds
  s_add_u32 s18, s82, 16384
  s_add_u32 m0, s42, 25600
  s_nop 0
  buffer_load_dwordx4 v56, s[44:47], s18 offen lds
  s_add_u32 s18, s82, 262144
  s_add_u32 m0, s42, 26624
  s_nop 0
  buffer_load_dwordx4 v56, s[44:47], s18 offen lds
  s_add_u32 s18, s82, 278528
  s_add_u32 m0, s42, 27648
  s_nop 0
  buffer_load_dwordx4 v56, s[44:47], s18 offen lds
  ds_read_b64_tr_b16 a[48:49], v57 offset:28672
  ds_read_b64_tr_b16 a[56:57], v126 offset:28672
  ds_read_b64_tr_b16 a[50:51], v57 offset:29696
  ds_read_b64_tr_b16 a[58:59], v126 offset:29696
  ds_read_b64_tr_b16 a[52:53], v57 offset:30720
  ds_read_b64_tr_b16 a[60:61], v126 offset:30720
  ds_read_b64_tr_b16 a[54:55], v57 offset:31744
  ds_read_b64_tr_b16 a[62:63], v126 offset:31744
  v_lshlrev_b32 v59, 1, v0
  v_and_b32 v59, 0xe0, v59
  buffer_load_dwordx2 v[24:25], v59, s[92:95], 0 offen sc1
  s_waitcnt vmcnt(9)
  s_waitcnt lgkmcnt(0)
  s_barrier
  s_add_u32 s18, s83, 0
  s_add_u32 m0, s42, 28672
  s_nop 0
  buffer_load_dwordx4 v56, s[44:47], s18 offen lds
  s_add_u32 s18, s83, 16384
  s_add_u32 m0, s42, 29696
  s_nop 0
  buffer_load_dwordx4 v56, s[44:47], s18 offen lds
  s_add_u32 s18, s83, 262144
  s_add_u32 m0, s42, 30720
  s_nop 0
  buffer_load_dwordx4 v56, s[44:47], s18 offen lds
  s_add_u32 s18, s83, 278528
  s_add_u32 m0, s42, 31744
  s_nop 0
  buffer_load_dwordx4 v56, s[44:47], s18 offen lds
  ds_read_b64_tr_b16 v[48:49], v57 offset:16384
  ds_read_b64_tr_b16 v[118:119], v126 offset:16384
  ds_read_b64_tr_b16 v[50:51], v57 offset:17408
  ds_read_b64_tr_b16 v[120:121], v126 offset:17408
  ds_read_b64_tr_b16 v[52:53], v57 offset:18432
  ds_read_b64_tr_b16 v[122:123], v126 offset:18432
  ds_read_b64_tr_b16 v[54:55], v57 offset:19456
  ds_read_b64_tr_b16 v[124:125], v126 offset:19456
  s_waitcnt lgkmcnt(5)
  ds_write_b128 v6, v[48:51] offset:0
  s_waitcnt lgkmcnt(2)
  ds_write_b128 v6, v[52:55] offset:1024
  ds_write_b128 v6, v[118:121] offset:2048
  s_waitcnt lgkmcnt(3)
  ds_write_b128 v6, v[122:125] offset:3072
  s_waitcnt vmcnt(9)
  s_waitcnt lgkmcnt(0)
  s_barrier
  ds_read_b64_tr_b16 v[48:49], v57 offset:20480
  ds_read_b64_tr_b16 v[118:119], v126 offset:20480
  ds_read_b64_tr_b16 v[50:51], v57 offset:21504
  ds_read_b64_tr_b16 v[120:121], v126 offset:21504
  ds_read_b64_tr_b16 v[52:53], v57 offset:22528
  ds_read_b64_tr_b16 v[122:123], v126 offset:22528
  ds_read_b64_tr_b16 v[54:55], v57 offset:23552
  ds_read_b64_tr_b16 v[124:125], v126 offset:23552
  s_waitcnt lgkmcnt(5)
  ds_write_b128 v6, v[48:51] offset:4096
  s_waitcnt lgkmcnt(2)
  ds_write_b128 v6, v[52:55] offset:5120
  ds_write_b128 v6, v[118:121] offset:6144
  s_waitcnt lgkmcnt(3)
  ds_write_b128 v6, v[122:125] offset:7168
  s_waitcnt vmcnt(4)
  v_cmp_gt_u32 vcc, 32, v25
  v_readfirstlane_b32 s25, v24
  v_and_b32 v60, 0x70, v0
  s_cmp_eq_u64 vcc, 0
  s_cselect_b32 s43, 64, 0
  buffer_load_dword v58, v60, s[4:7], s33 offen sc1
  s_waitcnt lgkmcnt(0)
  s_barrier
  ds_read_b64_tr_b16 v[48:49], v57 offset:24576
  ds_read_b64_tr_b16 v[118:119], v126 offset:24576
  ds_read_b64_tr_b16 v[50:51], v57 offset:25600
  ds_read_b64_tr_b16 v[120:121], v126 offset:25600
  ds_read_b64_tr_b16 v[52:53], v57 offset:26624
  ds_read_b64_tr_b16 v[122:123], v126 offset:26624
  ds_read_b64_tr_b16 v[54:55], v57 offset:27648
  ds_read_b64_tr_b16 v[124:125], v126 offset:27648
  s_waitcnt lgkmcnt(5)
  ds_write_b128 v6, v[48:51] offset:8192
  s_waitcnt lgkmcnt(2)
  ds_write_b128 v6, v[52:55] offset:9216
  ds_write_b128 v6, v[118:121] offset:10240
  s_waitcnt lgkmcnt(3)
  ds_write_b128 v6, v[122:125] offset:11264
  s_waitcnt vmcnt(1)
  s_waitcnt lgkmcnt(0)
  s_barrier
  ds_read_b64_tr_b16 v[48:49], v57 offset:28672
  ds_read_b64_tr_b16 v[118:119], v126 offset:28672
  ds_read_b64_tr_b16 v[50:51], v57 offset:29696
  ds_read_b64_tr_b16 v[120:121], v126 offset:29696
  ds_read_b64_tr_b16 v[52:53], v57 offset:30720
  ds_read_b64_tr_b16 v[122:123], v126 offset:30720
  ds_read_b64_tr_b16 v[54:55], v57 offset:31744
  ds_read_b64_tr_b16 v[124:125], v126 offset:31744
  s_waitcnt lgkmcnt(5)
  ds_write_b128 v6, v[48:51] offset:12288
  s_waitcnt lgkmcnt(2)
  ds_write_b128 v6, v[52:55] offset:13312
  ds_write_b128 v6, v[118:121] offset:14336
  s_waitcnt lgkmcnt(3)
  ds_write_b128 v6, v[122:125] offset:15360
  s_mov_b32 s15, 64
  s_waitcnt vmcnt(0)
  v_readlane_b32 s19, v58, 1
  s_nop 0
  s_cmp_lt_u32 s19, 10
  s_cselect_b32 s19, s19, 64
  s_mul_i32 s19, s19, 7
  s_add_u32 s19, s19, 0
  s_min_u32 s15, s15, s19
  v_readlane_b32 s19, v58, 2
  s_nop 0
  s_cmp_lt_u32 s19, 9
  s_cselect_b32 s19, s19, 64
  s_mul_i32 s19, s19, 7
  s_add_u32 s19, s19, 1
  s_min_u32 s15, s15, s19
  v_readlane_b32 s19, v58, 3
  s_nop 0
  s_cmp_lt_u32 s19, 9
  s_cselect_b32 s19, s19, 64
  s_mul_i32 s19, s19, 7
  s_add_u32 s19, s19, 2
  s_min_u32 s15, s15, s19
  v_readlane_b32 s19, v58, 4
  s_nop 0
  s_cmp_lt_u32 s19, 9
  s_cselect_b32 s19, s19, 64
  s_mul_i32 s19, s19, 7
  s_add_u32 s19, s19, 3
  s_min_u32 s15, s15, s19
  v_readlane_b32 s19, v58, 5
  s_nop 0
  s_cmp_lt_u32 s19, 9
  s_cselect_b32 s19, s19, 64
  s_mul_i32 s19, s19, 7
  s_add_u32 s19, s19, 4
  s_min_u32 s15, s15, s19
  v_readlane_b32 s19, v58, 6
  s_nop 0
  s_cmp_lt_u32 s19, 9
  s_cselect_b32 s19, s19, 64
  s_mul_i32 s19, s19, 7
  s_add_u32 s19, s19, 5
  s_min_u32 s15, s15, s19
  v_readlane_b32 s19, v58, 7
  s_nop 0
  s_cmp_lt_u32 s19, 9
  s_cselect_b32 s19, s19, 64
  s_mul_i32 s19, s19, 7
  s_add_u32 s19, s19, 6
  s_min_u32 s15, s15, s19
  s_min_u32 s15, s15, s43
  s_mov_b32 m0, s34
  buffer_load_dwordx4 v[24:27], v0, s[4:7], s37 offen sc1
  buffer_load_dwordx4 v0, s[4:7], s16 offen sc1 lds
  buffer_load_dwordx4 v[28:31], v0, s[4:7], s37 offen offset:1024 sc1
  buffer_load_dwordx4 v0, s[4:7], s16 offen offset:1024 sc1 lds
  s_add_u32 s16, s16, 8192
  s_add_u32 s37, s37, 8192
  s_waitcnt lgkmcnt(0)
  s_barrier
  s_waitcnt lgkmcnt(0)
  ds_write_b128 v6, v[32:35] offset:16384
  ds_write_b128 v6, v[36:39] offset:17408
  ds_write_b128 v6, v[62:65] offset:18432
  ds_write_b128 v6, v[66:69] offset:19456
  ds_write_b128 v6, v[70:73] offset:20480
  ds_write_b128 v6, v[74:77] offset:21504
  ds_write_b128 v6, v[78:81] offset:22528
  ds_write_b128 v6, v[82:85] offset:23552
  ds_write_b128 v6, v[86:89] offset:24576
  ds_write_b128 v6, v[90:93] offset:25600
  ds_write_b128 v6, v[94:97] offset:26624
  ds_write_b128 v6, v[98:101] offset:27648
  ds_write_b128 v6, v[102:105] offset:28672
  ds_write_b128 v6, v[106:109] offset:29696
  ds_write_b128 v6, v[110:113] offset:30720
  ds_write_b128 v6, v[114:117] offset:31744
  s_branch L_lw_done
L_lw_odd:
  s_add_u32 s18, s82, 0
  s_add_u32 m0, s42, 0
  s_nop 0
  buffer_load_dwordx4 v56, s[48:51], s18 offen lds
  s_add_u32 s18, s82, 16384
  s_add_u32 m0, s42, 1024
  s_nop 0
  buffer_load_dwordx4 v56, s[48:51], s18 offen lds
  s_add_u32 s18, s82, 262144
  s_add_u32 m0, s42, 2048
  s_nop 0
  buffer_load_dwordx4 v56, s[48:51], s18 offen lds
  s_add_u32 s18, s82, 278528
  s_add_u32 m0, s42, 3072
  s_nop 0
  buffer_load_dwordx4 v56, s[48:51], s18 offen lds
  s_add_u32 s18, s83, 0
  s_add_u32 m0, s42, 4096
  s_nop 0
  buffer_load_dwordx4 v56, s[48:51], s18 offen lds
  s_add_u32 s18, s83, 16384
  s_add_u32 m0, s42, 5120
  s_nop 0
  buffer_load_dwordx4 v56, s[48:51], s18 offen lds
  s_add_u32 s18, s83, 262144
  s_add_u32 m0, s42, 6144
  s_nop 0
  buffer_load_dwordx4 v56, s[48:51], s18 offen lds
  s_add_u32 s18, s83, 278528
  s_add_u32 m0, s42, 7168
  s_nop 0
  buffer_load_dwordx4 v56, s[48:51], s18 offen lds
  s_add_u32 s18, s80, 0
  s_add_u32 m0, s42, 8192
  s_nop 0
  buffer_load_dwordx4 v56, s[48:51], s18 offen lds
  s_add_u32 s18, s80, 16384
  s_add_u32 m0, s42, 9216
  s_nop 0
  buffer_load_dwordx4 v56, s[48:51], s18 offen lds
  s_add_u32 s18, s80, 262144
  s_add_u32 m0, s42, 10240
  s_nop 0
  buffer_load_dwordx4 v56, s[48:51], s18 offen lds
  s_add_u32 s18, s80, 278528
  s_add_u32 m0, s42, 11264
  s_nop 0
  buffer_load_dwordx4 v56, s[48:51], s18 offen lds
  s_add_u32 s18, s81, 0
  s_add_u32 m0, s42, 12288
  s_nop 0
  buffer_load_dwordx4 v56, s[48:51], s18 offen lds
  s_add_u32 s18, s81, 16384
  s_add_u32 m0, s42, 13312
  s_nop 0
  buffer_load_dwordx4 v56, s[48:51], s18 offen lds
  s_add_u32 s18, s81, 262144
  s_add_u32 m0, s42, 14336
  s_nop 0
  buffer_load_dwordx4 v56, s[48:51], s18 offen lds
  s_add_u32 s18, s81, 278528
  s_add_u32 m0, s42, 15360
  s_nop 0
  buffer_load_dwordx4 v56, s[48:51], s18 offen lds
  s_add_u32 s18, s78, 0
  s_add_u32 m0, s42, 16384
  s_nop 0
  buffer_load_dwordx4 v56, s[48:51], s18 offen lds
  s_add_u32 s18, s78, 16384
  s_add_u32 m0, s42, 17408
  s_nop 0
  buffer_load_dwordx4 v56, s[48:51], s18 offen lds
  s_add_u32 s18, s78, 262144
  s_add_u32 m0, s42, 18432
  s_nop 0
  buffer_load_dwordx4 v56, s[48:51], s18 offen lds
  s_add_u32 s18, s78, 278528
  s_add_u32 m0, s42, 19456
  s_nop 0
  buffer_load_dwordx4 v56, s[48:51], s18 offen lds
  s_add_u32 s18, s79, 0
  s_add_u32 m0, s42, 20480
  s_nop 0
  buffer_load_dwordx4 v56, s[48:51], s18 offen lds
  s_add_u32 s18, s79, 16384
  s_add_u32 m0, s42, 21504
  s_nop 0
  buffer_load_dwordx4 v56, s[48:51], s18 offen lds
  s_add_u32 s18, s79, 262144
  s_add_u32 m0, s42, 22528
  s_nop 0
  buffer_load_dwordx4 v56, s[48:51], s18 offen lds
  s_add_u32 s18, s79, 278528
  s_add_u32 m0, s42, 23552
  s_nop 0
  buffer_load_dwordx4 v56, s[48:51], s18 offen lds
  v_and_b32 v58, 32, v61
  v_lshlrev_b32 v58, 7, v58
  v_and_b32 v60, 16, v61
  v_lshlrev_b32 v60, 11, v60
  v_add_u32 v58, v58, v60
  v_and_b32 v60, 15, v61
  v_lshlrev_b32 v60, 4, v60
  v_add_u32 v58, v58, v60
  s_lshl_b32 s18, s12, 17
  s_lshl_b32 s19, s13, 8
  s_add_u32 s18, s18, s19
  v_add_u32 v58, s18, v58
  s_waitcnt vmcnt(20)
  s_waitcnt lgkmcnt(0)
  s_barrier
  ds_read_b64_tr_b16 a[160:161], v57 offset:0
  ds_read_b64_tr_b16 a[168:169], v126 offset:0
  s_mov_b32 s18, 0
  buffer_load_dwordx4 a[0:3], v58, s[56:59], s18 offen
  s_mov_b32 s18, 1024
  buffer_load_dwordx4 a[4:7], v58, s[56:59], s18 offen
  ds_read_b64_tr_b16 a[162:163], v57 offset:1024
  ds_read_b64_tr_b16 a[170:171], v126 offset:1024
  s_mov_b32 s18, 16384
  buffer_load_dwordx4 a[8:11], v58, s[56:59], s18 offen
  s_mov_b32 s18, 17408
  buffer_load_dwordx4 a[12:15], v58, s[56:59], s18 offen
  ds_read_b64_tr_b16 a[164:165], v57 offset:2048
  ds_read_b64_tr_b16 a[172:173], v126 offset:2048
  s_mov_b32 s18, 2048
  buffer_load_dwordx4 a[16:19], v58, s[56:59], s18 offen
  s_mov_b32 s18, 3072
  buffer_load_dwordx4 a[20:23], v58, s[56:59], s18 offen
  ds_read_b64_tr_b16 a[166:167], v57 offset:3072
  ds_read_b64_tr_b16 a[174:175], v126 offset:3072
  s_mov_b32 s18, 18432
  buffer_load_dwordx4 a[24:27], v58, s[56:59], s18 offen
  s_mov_b32 s18, 19456
  buffer_load_dwordx4 a[28:31], v58, s[56:59], s18 offen
  s_waitcnt vmcnt(24)
  s_waitcnt lgkmcnt(0)
  s_barrier
  s_add_u32 s18, s76, 0
  s_add_u32 m0, s42, 24576
  s_nop 0
  buffer_load_dwordx4 v56, s[48:51], s18 offen lds
  s_add_u32 s18, s76, 16384
  s_add_u32 m0, s42, 25600
  s_nop 0
  buffer_load_dwordx4 v56, s[48:51], s18 offen lds
  s_add_u32 s18, s76, 262144
  s_add_u32 m0, s42, 26624
  s_nop 0
  buffer_load_dwordx4 v56, s[48:51], s18 offen lds
  s_add_u32 s18, s76, 278528
  s_add_u32 m0, s42, 27648
  s_nop 0
  buffer_load_dwordx4 v56, s[48:51], s18 offen lds
  ds_read_b64_tr_b16 a[176:177], v57 offset:4096
  ds_read_b64_tr_b16 a[184:185], v126 offset:4096
  s_mov_b32 s18, 8192
  buffer_load_dwordx4 a[32:35], v58, s[56:59], s18 offen
  s_mov_b32 s18, 9216
  buffer_load_dwordx4 a[36:39], v58, s[56:59], s18 offen
  ds_read_b64_tr_b16 a[178:179], v57 offset:5120
  ds_read_b64_tr_b16 a[186:187], v126 offset:5120
  s_mov_b32 s18, 24576
  buffer_load_dwordx4 a[40:43], v58, s[56:59], s18 offen
  s_mov_b32 s18, 25600
  buffer_load_dwordx4 a[44:47], v58, s[56:59], s18 offen
  ds_read_b64_tr_b16 a[180:181], v57 offset:6144
  ds_read_b64_tr_b16 a[188:189], v126 offset:6144
  s_lshl_b32 s25, 0, 5
  s_barrier
  s_cmp_lg_u32 s13, 0
  s_cbranch_scc1 L_ao_c1
  v_mov_b32 v53, 1
  s_mov_b64 exec, 1
  buffer_atomic_add v53, off, s[92:95], s25 offset:4
  s_mov_b64 exec, -1
  s_branch L_ad_c1
L_ao_c1:
  buffer_load_dword v53, off, s[4:7], 0
L_ad_c1:
  s_mov_b32 s18, 10240
  buffer_load_dwordx4 a[48:51], v58, s[56:59], s18 offen
  s_mov_b32 s18, 11264
  buffer_load_dwordx4 a[52:55], v58, s[56:59], s18 offen
  ds_read_b64_tr_b16 a[182:183], v57 offset:7168
  ds_read_b64_tr_b16 a[190:191], v126 offset:7168
  s_mov_b32 s18, 26624
  buffer_load_dwordx4 a[56:59], v58, s[56:59], s18 offen
  s_mov_b32 s18, 27648
  buffer_load_dwordx4 a[60:63], v58, s[56:59], s18 offen
  s_waitcnt vmcnt(33)
  s_waitcnt lgkmcnt(0)
  s_barrier
  s_add_u32 s18, s77, 0
  s_add_u32 m0, s42, 28672
  s_nop 0
  buffer_load_dwordx4 v56, s[48:51], s18 offen lds
  s_add_u32 s18, s77, 16384
  s_add_u32 m0, s42, 29696
  s_nop 0
  buffer_load_dwordx4 v56, s[48:51], s18 offen lds
  s_add_u32 s18, s77, 262144
  s_add_u32 m0, s42, 30720
  s_nop 0
  buffer_load_dwordx4 v56, s[48:51], s18 offen lds
  s_add_u32 s18, s77, 278528
  s_add_u32 m0, s42, 31744
  s_nop 0
  buffer_load_dwordx4 v56, s[48:51], s18 offen lds
  ds_read_b64_tr_b16 a[128:129], v57 offset:8192
  ds_read_b64_tr_b16 a[136:137], v126 offset:8192
  ds_read_b64_tr_b16 a[130:131], v57 offset:9216
  ds_read_b64_tr_b16 a[138:139], v126 offset:9216
  ds_read_b64_tr_b16 a[132:133], v57 offset:10240
  ds_read_b64_tr_b16 a[140:141], v126 offset:10240
  ds_read_b64_tr_b16 a[134:135], v57 offset:11264
  ds_read_b64_tr_b16 a[142:143], v126 offset:11264
  s_waitcnt vmcnt(33)
  s_waitcnt lgkmcnt(0)
  s_barrier
  s_add_u32 s18, s82, 0
  s_add_u32 m0, s42, 0
  s_nop 0
  buffer_load_dwordx4 v56, s[52:55], s18 offen lds
  s_add_u32 s18, s82, 16384
  s_add_u32 m0, s42, 1024
  s_nop 0
  buffer_load_dwordx4 v56, s[52:55], s18 offen lds
  s_add_u32 s18, s82, 262144
  s_add_u32 m0, s42, 2048
  s_nop 0
  buffer_load_dwordx4 v56, s[52:55], s18 offen lds
  s_add_u32 s18, s82, 278528
  s_add_u32 m0, s42, 3072
  s_nop 0
  buffer_load_dwordx4 v56, s[52:55], s18 offen lds
  ds_read_b64_tr_b16 a[144:145], v57 offset:12288
  ds_read_b64_tr_b16 a[152:153], v126 offset:12288
  ds_read_b64_tr_b16 a[146:147], v57 offset:13312
  ds_read_b64_tr_b16 a[154:155], v126 offset:13312
  ds_read_b64_tr_b16 a[148:149], v57 offset:14336
  ds_read_b64_tr_b16 a[156:157], v126 offset:14336
  ds_read_b64_tr_b16 a[150:151], v57 offset:15360
  ds_read_b64_tr_b16 a[158:159], v126 offset:15360
  s_waitcnt vmcnt(33)
  s_waitcnt lgkmcnt(0)
  s_barrier
  s_add_u32 s18, s83, 0
  s_add_u32 m0, s42, 4096
  s_nop 0
  buffer_load_dwordx4 v56, s[52:55], s18 offen lds
  s_add_u32 s18, s83, 16384
  s_add_u32 m0, s42, 5120
  s_nop 0
  buffer_load_dwordx4 v56, s[52:55], s18 offen lds
  s_add_u32 s18, s83, 262144
  s_add_u32 m0, s42, 6144
  s_nop 0
  buffer_load_dwordx4 v56, s[52:55], s18 offen lds
  s_add_u32 s18, s83, 278528
  s_add_u32 m0, s42, 7168
  s_nop 0
  buffer_load_dwordx4 v56, s[52:55], s18 offen lds
  ds_read_b64_tr_b16 a[96:97], v57 offset:16384
  ds_read_b64_tr_b16 a[104:105], v126 offset:16384
  ds_read_b64_tr_b16 a[98:99], v57 offset:17408
  ds_read_b64_tr_b16 a[106:107], v126 offset:17408
  ds_read_b64_tr_b16 a[100:101], v57 offset:18432
  ds_read_b64_tr_b16 a[108:109], v126 offset:18432
  ds_read_b64_tr_b16 a[102:103], v57 offset:19456
  ds_read_b64_tr_b16 a[110:111], v126 offset:19456
  s_waitcnt vmcnt(33)
  s_waitcnt lgkmcnt(0)
  s_barrier
  s_add_u32 s18, s80, 0
  s_add_u32 m0, s42, 8192
  s_nop 0
  buffer_load_dwordx4 v56, s[52:55], s18 offen lds
  s_add_u32 s18, s80, 16384
  s_add_u32 m0, s42, 9216
  s_nop 0
  buffer_load_dwordx4 v56, s[52:55], s18 offen lds
  s_add_u32 s18, s80, 262144
  s_add_u32 m0, s42, 10240
  s_nop 0
  buffer_load_dwordx4 v56, s[52:55], s18 offen lds
  s_add_u32 s18, s80, 278528
  s_add_u32 m0, s42, 11264
  s_nop 0
  buffer_load_dwordx4 v56, s[52:55], s18 offen lds
  ds_read_b64_tr_b16 a[112:113], v57 offset:20480
  ds_read_b64_tr_b16 a[120:121], v126 offset:20480
  s_waitcnt vmcnt(36)
  v_accvgpr_read_b32 v118, a0
  v_accvgpr_read_b32 v119, a1
  v_accvgpr_read_b32 v120, a2
  v_accvgpr_read_b32 v121, a3
  s_waitcnt vmcnt(35)
  v_accvgpr_read_b32 v122, a4
  v_accvgpr_read_b32 v123, a5
  v_accvgpr_read_b32 v124, a6
  v_accvgpr_read_b32 v125, a7
  v_perm_b32 v32, v122, v118, s40
  v_perm_b32 v70, v122, v118, s41
  v_perm_b32 v192, v123, v119, s40
  v_perm_b32 v200, v123, v119, s41
  v_perm_b32 v86, v124, v120, s40
  v_perm_b32 v208, v124, v120, s41
  v_perm_b32 v216, v125, v121, s40
  v_perm_b32 v102, v125, v121, s41
  s_mov_b32 s18, 65536
  buffer_load_dwordx4 a[0:3], v58, s[56:59], s18 offen
  s_mov_b32 s18, 66560
  buffer_load_dwordx4 a[4:7], v58, s[56:59], s18 offen
  ds_read_b64_tr_b16 a[114:115], v57 offset:21504
  ds_read_b64_tr_b16 a[122:123], v126 offset:21504
  s_waitcnt vmcnt(36)
  v_accvgpr_read_b32 v118, a8
  v_accvgpr_read_b32 v119, a9
  v_accvgpr_read_b32 v120, a10
  v_accvgpr_read_b32 v121, a11
  s_waitcnt vmcnt(35)
  v_accvgpr_read_b32 v122, a12
  v_accvgpr_read_b32 v123, a13
  v_accvgpr_read_b32 v124, a14
  v_accvgpr_read_b32 v125, a15
  v_perm_b32 v33, v122, v118, s40
  v_perm_b32 v71, v122, v118, s41
  v_perm_b32 v193, v123, v119, s40
  v_perm_b32 v201, v123, v119, s41
  v_perm_b32 v87, v124, v120, s40
  v_perm_b32 v209, v124, v120, s41
  v_perm_b32 v217, v125, v121, s40
  v_perm_b32 v103, v125, v121, s41
  s_mov_b32 s18, 81920
  buffer_load_dwordx4 a[8:11], v58, s[56:59], s18 offen
  s_mov_b32 s18, 82944
  buffer_load_dwordx4 a[12:15], v58, s[56:59], s18 offen
  ds_read_b64_tr_b16 a[116:117], v57 offset:22528
  ds_read_b64_tr_b16 a[124:125], v126 offset:22528
  s_waitcnt vmcnt(36)
  v_accvgpr_read_b32 v118, a16
  v_accvgpr_read_b32 v119, a17
  v_accvgpr_read_b32 v120, a18
  v_accvgpr_read_b32 v121, a19
  s_waitcnt vmcnt(35)
  v_accvgpr_read_b32 v122, a20
  v_accvgpr_read_b32 v123, a21
  v_accvgpr_read_b32 v124, a22
  v_accvgpr_read_b32 v125, a23
  v_perm_b32 v34, v122, v118, s40
  v_perm_b32 v72, v122, v118, s41
  v_perm_b32 v194, v123, v119, s40
  v_perm_b32 v202, v123, v119, s41
  v_perm_b32 v88, v124, v120, s40
  v_perm_b32 v210, v124, v120, s41
  v_perm_b32 v218, v125, v121, s40
  v_perm_b32 v104, v125, v121, s41
  s_mov_b32 s18, 67584
  buffer_load_dwordx4 a[16:19], v58, s[56:59], s18 offen
  s_mov_b32 s18, 68608
  buffer_load_dwordx4 a[20:23], v58, s[56:59], s18 offen
  ds_read_b64_tr_b16 a[118:119], v57 offset:23552
  ds_read_b64_tr_b16 a[126:127], v126 offset:23552
  s_waitcnt vmcnt(36)
  v_accvgpr_read_b32 v118, a24
  v_accvgpr_read_b32 v119, a25
  v_accvgpr_read_b32 v120, a26
  v_accvgpr_read_b32 v121, a27
  s_waitcnt vmcnt(35)
  v_accvgpr_read_b32 v122, a28
  v_accvgpr_read_b32 v123, a29
  v_accvgpr_read_b32 v124, a30
  v_accvgpr_read_b32 v125, a31
  v_perm_b32 v35, v122, v118, s40
  v_perm_b32 v73, v122, v118, s41
  v_perm_b32 v195, v123, v119, s40
  v_perm_b32 v203, v123, v119, s41
  v_perm_b32 v89, v124, v120, s40
  v_perm_b32 v211, v124, v120, s41
  v_perm_b32 v219, v125, v121, s40
  v_perm_b32 v105, v125, v121, s41
  s_mov_b32 s18, 83968
  buffer_load_dwordx4 a[24:27], v58, s[56:59], s18 offen
  s_mov_b32 s18, 84992
  buffer_load_dwordx4 a[28:31], v58, s[56:59], s18 offen
  s_waitcnt vmcnt(33)
  s_waitcnt lgkmcnt(0)
  s_barrier
  s_add_u32 s18, s81, 0
  s_add_u32 m0, s42, 12288
  s_nop 0
  buffer_load_dwordx4 v56, s[52:55], s18 offen lds
  s_add_u32 s18, s81, 16384
  s_add_u32 m0, s42, 13312
  s_nop 0
  buffer_load_dwordx4 v56, s[52:55], s18 offen lds
  s_add_u32 s18, s81, 262144
  s_add_u32 m0, s42, 14336
  s_nop 0
  buffer_load_dwordx4 v56, s[52:55], s18 offen lds
  s_add_u32 s18, s81, 278528
  s_add_u32 m0, s42, 15360
  s_nop 0
  buffer_load_dwordx4 v56, s[52:55], s18 offen lds
  ds_read_b64_tr_b16 a[64:65], v57 offset:24576
  ds_read_b64_tr_b16 a[72:73], v126 offset:24576
  s_waitcnt vmcnt(36)
  v_accvgpr_read_b32 v118, a32
  v_accvgpr_read_b32 v119, a33
  v_accvgpr_read_b32 v120, a34
  v_accvgpr_read_b32 v121, a35
  s_waitcnt vmcnt(35)
  v_accvgpr_read_b32 v122, a36
  v_accvgpr_read_b32 v123, a37
  v_accvgpr_read_b32 v124, a38
  v_accvgpr_read_b32 v125, a39
  v_perm_b32 v36, v122, v118, s40
  v_perm_b32 v74, v122, v118, s41
  v_perm_b32 v196, v123, v119, s40
  v_perm_b32 v204, v123, v119, s41
  v_perm_b32 v90, v124, v120, s40
  v_perm_b32 v212, v124, v120, s41
  v_perm_b32 v220, v125, v121, s40
  v_perm_b32 v106, v125, v121, s41
  s_mov_b32 s18, 73728
  buffer_load_dwordx4 a[32:35], v58, s[56:59], s18 offen
  s_mov_b32 s18, 74752
  buffer_load_dwordx4 a[36:39], v58, s[56:59], s18 offen
  ds_read_b64_tr_b16 a[66:67], v57 offset:25600
  ds_read_b64_tr_b16 a[74:75], v126 offset:25600
  s_waitcnt vmcnt(36)
  v_accvgpr_read_b32 v118, a40
  v_accvgpr_read_b32 v119, a41
  v_accvgpr_read_b32 v120, a42
  v_accvgpr_read_b32 v121, a43
  s_waitcnt vmcnt(35)
  v_accvgpr_read_b32 v122, a44
  v_accvgpr_read_b32 v123, a45
  v_accvgpr_read_b32 v124, a46
  v_accvgpr_read_b32 v125, a47
  v_perm_b32 v37, v122, v118, s40
  v_perm_b32 v75, v122, v118, s41
  v_perm_b32 v197, v123, v119, s40
  v_perm_b32 v205, v123, v119, s41
  v_perm_b32 v91, v124, v120, s40
  v_perm_b32 v213, v124, v120, s41
  v_perm_b32 v221, v125, v121, s40
  v_perm_b32 v107, v125, v121, s41
  s_mov_b32 s18, 90112
  buffer_load_dwordx4 a[40:43], v58, s[56:59], s18 offen
  s_mov_b32 s18, 91136
  buffer_load_dwordx4 a[44:47], v58, s[56:59], s18 offen
  ds_read_b64_tr_b16 a[68:69], v57 offset:26624
  ds_read_b64_tr_b16 a[76:77], v126 offset:26624
  s_waitcnt vmcnt(35)
  v_accvgpr_read_b32 v118, a48
  v_accvgpr_read_b32 v119, a49
  v_accvgpr_read_b32 v120, a50
  v_accvgpr_read_b32 v121, a51
  s_waitcnt vmcnt(34)
  v_accvgpr_read_b32 v122, a52
  v_accvgpr_read_b32 v123, a53
  v_accvgpr_read_b32 v124, a54
  v_accvgpr_read_b32 v125, a55
  v_perm_b32 v38, v122, v118, s40
  v_perm_b32 v76, v122, v118, s41
  v_perm_b32 v198, v123, v119, s40
  v_perm_b32 v206, v123, v119, s41
  v_perm_b32 v92, v124, v120, s40
  v_perm_b32 v214, v124, v120, s41
  v_perm_b32 v222, v125, v121, s40
  v_perm_b32 v108, v125, v121, s41
  s_mov_b32 s18, 75776
  buffer_load_dwordx4 a[48:51], v58, s[56:59], s18 offen
  s_mov_b32 s18, 76800
  buffer_load_dwordx4 a[52:55], v58, s[56:59], s18 offen
  ds_read_b64_tr_b16 a[70:71], v57 offset:27648
  ds_read_b64_tr_b16 a[78:79], v126 offset:27648
  s_waitcnt vmcnt(35)
  v_accvgpr_read_b32 v118, a56
  v_accvgpr_read_b32 v119, a57
  v_accvgpr_read_b32 v120, a58
  v_accvgpr_read_b32 v121, a59
  s_waitcnt vmcnt(34)
  v_accvgpr_read_b32 v122, a60
  v_accvgpr_read_b32 v123, a61
  v_accvgpr_read_b32 v124, a62
  v_accvgpr_read_b32 v125, a63
  v_perm_b32 v39, v122, v118, s40
  v_perm_b32 v77, v122, v118, s41
  v_perm_b32 v199, v123, v119, s40
  v_perm_b32 v207, v123, v119, s41
  v_perm_b32 v93, v124, v120, s40
  v_perm_b32 v215, v124, v120, s41
  v_perm_b32 v223, v125, v121, s40
  v_perm_b32 v109, v125, v121, s41
  s_mov_b32 s18, 92160
  buffer_load_dwordx4 a[56:59], v58, s[56:59], s18 offen
  s_mov_b32 s18, 93184
  buffer_load_dwordx4 a[60:63], v58, s[56:59], s18 offen
  s_waitcnt vmcnt(32)
  s_waitcnt lgkmcnt(0)
  s_barrier
  s_add_u32 s18, s78, 0
  s_add_u32 m0, s42, 16384
  s_nop 0
  buffer_load_dwordx4 v56, s[52:55], s18 offen lds
  s_add_u32 s18, s78, 16384
  s_add_u32 m0, s42, 17408
  s_nop 0
  buffer_load_dwordx4 v56, s[52:55], s18 offen lds
  s_add_u32 s18, s78, 262144
  s_add_u32 m0, s42, 18432
  s_nop 0
  buffer_load_dwordx4 v56, s[52:55], s18 offen lds
  s_add_u32 s18, s78, 278528
  s_add_u32 m0, s42, 19456
  s_nop 0
  buffer_load_dwordx4 v56, s[52:55], s18 offen lds
  ds_read_b64_tr_b16 a[80:81], v57 offset:28672
  ds_read_b64_tr_b16 a[88:89], v126 offset:28672
  ds_read_b64_tr_b16 a[82:83], v57 offset:29696
  ds_read_b64_tr_b16 a[90:91], v126 offset:29696
  ds_read_b64_tr_b16 a[84:85], v57 offset:30720
  ds_read_b64_tr_b16 a[92:93], v126 offset:30720
  ds_read_b64_tr_b16 a[86:87], v57 offset:31744
  ds_read_b64_tr_b16 a[94:95], v126 offset:31744
  s_waitcnt vmcnt(32)
  s_waitcnt lgkmcnt(0)
  s_barrier
  s_add_u32 s18, s79, 0
  s_add_u32 m0, s42, 20480
  s_nop 0
  buffer_load_dwordx4 v56, s[52:55], s18 offen lds
  s_add_u32 s18, s79, 16384
  s_add_u32 m0, s42, 21504
  s_nop 0
  buffer_load_dwordx4 v56, s[52:55], s18 offen lds
  s_add_u32 s18, s79, 262144
  s_add_u32 m0, s42, 22528
  s_nop 0
  buffer_load_dwordx4 v56, s[52:55], s18 offen lds
  s_add_u32 s18, s79, 278528
  s_add_u32 m0, s42, 23552
  s_nop 0
  buffer_load_dwordx4 v56, s[52:55], s18 offen lds
  ds_read_b64_tr_b16 v[160:161], v57 offset:0
  ds_read_b64_tr_b16 v[168:169], v126 offset:0
  ds_read_b64_tr_b16 v[162:163], v57 offset:1024
  ds_read_b64_tr_b16 v[170:171], v126 offset:1024
  ds_read_b64_tr_b16 v[164:165], v57 offset:2048
  ds_read_b64_tr_b16 v[172:173], v126 offset:2048
  ds_read_b64_tr_b16 v[166:167], v57 offset:3072
  ds_read_b64_tr_b16 v[174:175], v126 offset:3072
  s_waitcnt vmcnt(32)
  s_waitcnt lgkmcnt(0)
  s_barrier
  s_add_u32 s18, s76, 0
  s_add_u32 m0, s42, 24576
  s_nop 0
  buffer_load_dwordx4 v56, s[52:55], s18 offen lds
  s_add_u32 s18, s76, 16384
  s_add_u32 m0, s42, 25600
  s_nop 0
  buffer_load_dwordx4 v56, s[52:55], s18 offen lds
  s_add_u32 s18, s76, 262144
  s_add_u32 m0, s42, 26624
  s_nop 0
  buffer_load_dwordx4 v56, s[52:55], s18 offen lds
  s_add_u32 s18, s76, 278528
  s_add_u32 m0, s42, 27648
  s_nop 0
  buffer_load_dwordx4 v56, s[52:55], s18 offen lds
  ds_read_b64_tr_b16 v[176:177], v57 offset:4096
  ds_read_b64_tr_b16 v[184:185], v126 offset:4096
  ds_read_b64_tr_b16 v[178:179], v57 offset:5120
  ds_read_b64_tr_b16 v[186:187], v126 offset:5120
  ds_read_b64_tr_b16 v[180:181], v57 offset:6144
  ds_read_b64_tr_b16 v[188:189], v126 offset:6144
  ds_read_b64_tr_b16 v[182:183], v57 offset:7168
  ds_read_b64_tr_b16 v[190:191], v126 offset:7168
  s_waitcnt vmcnt(32)
  s_waitcnt lgkmcnt(0)
  s_barrier
  s_add_u32 s18, s77, 0
  s_add_u32 m0, s42, 28672
  s_nop 0
  buffer_load_dwordx4 v56, s[52:55], s18 offen lds
  s_add_u32 s18, s77, 16384
  s_add_u32 m0, s42, 29696
  s_nop 0
  buffer_load_dwordx4 v56, s[52:55], s18 offen lds
  s_add_u32 s18, s77, 262144
  s_add_u32 m0, s42, 30720
  s_nop 0
  buffer_load_dwordx4 v56, s[52:55], s18 offen lds
  s_add_u32 s18, s77, 278528
  s_add_u32 m0, s42, 31744
  s_nop 0
  buffer_load_dwordx4 v56, s[52:55], s18 offen lds
  ds_read_b64_tr_b16 v[128:129], v57 offset:8192
  ds_read_b64_tr_b16 v[136:137], v126 offset:8192
  s_waitcnt vmcnt(35)
  v_accvgpr_read_b32 v118, a0
  v_accvgpr_read_b32 v119, a1
  v_accvgpr_read_b32 v120, a2
  v_accvgpr_read_b32 v121, a3
  s_waitcnt vmcnt(34)
  v_accvgpr_read_b32 v122, a4
  v_accvgpr_read_b32 v123, a5
  v_accvgpr_read_b32 v124, a6
  v_accvgpr_read_b32 v125, a7
  v_perm_b32 v62, v122, v118, s40
  v_perm_b32 v78, v122, v118, s41
  v_perm_b32 v224, v123, v119, s40
  v_perm_b32 v232, v123, v119, s41
  v_perm_b32 v94, v124, v120, s40
  v_perm_b32 v240, v124, v120, s41
  v_perm_b32 v248, v125, v121, s40
  v_perm_b32 v110, v125, v121, s41
  ds_read_b64_tr_b16 v[130:131], v57 offset:9216
  ds_read_b64_tr_b16 v[138:139], v126 offset:9216
  s_waitcnt vmcnt(33)
  v_accvgpr_read_b32 v118, a8
  v_accvgpr_read_b32 v119, a9
  v_accvgpr_read_b32 v120, a10
  v_accvgpr_read_b32 v121, a11
  s_waitcnt vmcnt(32)
  v_accvgpr_read_b32 v122, a12
  v_accvgpr_read_b32 v123, a13
  v_accvgpr_read_b32 v124, a14
  v_accvgpr_read_b32 v125, a15
  v_perm_b32 v63, v122, v118, s40
  v_perm_b32 v79, v122, v118, s41
  v_perm_b32 v225, v123, v119, s40
  v_perm_b32 v233, v123, v119, s41
  v_perm_b32 v95, v124, v120, s40
  v_perm_b32 v241, v124, v120, s41
  v_perm_b32 v249, v125, v121, s40
  v_perm_b32 v111, v125, v121, s41
  ds_read_b64_tr_b16 v[132:133], v57 offset:10240
  ds_read_b64_tr_b16 v[140:141], v126 offset:10240
  s_waitcnt vmcnt(31)
  v_accvgpr_read_b32 v118, a16
  v_accvgpr_read_b32 v119, a17
  v_accvgpr_read_b32 v120, a18
  v_accvgpr_read_b32 v121, a19
  s_waitcnt vmcnt(30)
  v_accvgpr_read_b32 v122, a20
  v_accvgpr_read_b32 v123, a21
  v_accvgpr_read_b32 v124, a22
  v_accvgpr_read_b32 v125, a23
  v_perm_b32 v64, v122, v118, s40
  v_perm_b32 v80, v122, v118, s41
  v_perm_b32 v226, v123, v119, s40
  v_perm_b32 v234, v123, v119, s41
  v_perm_b32 v96, v124, v120, s40
  v_perm_b32 v242, v124, v120, s41
  v_perm_b32 v250, v125, v121, s40
  v_perm_b32 v112, v125, v121, s41
  ds_read_b64_tr_b16 v[134:135], v57 offset:11264
  ds_read_b64_tr_b16 v[142:143], v126 offset:11264
  s_waitcnt vmcnt(29)
  v_accvgpr_read_b32 v118, a24
  v_accvgpr_read_b32 v119, a25
  v_accvgpr_read_b32 v120, a26
  v_accvgpr_read_b32 v121, a27
  s_waitcnt vmcnt(28)
  v_accvgpr_read_b32 v122, a28
  v_accvgpr_read_b32 v123, a29
  v_accvgpr_read_b32 v124, a30
  v_accvgpr_read_b32 v125, a31
  v_perm_b32 v65, v122, v118, s40
  v_perm_b32 v81, v122, v118, s41
  v_perm_b32 v227, v123, v119, s40
  v_perm_b32 v235, v123, v119, s41
  v_perm_b32 v97, v124, v120, s40
  v_perm_b32 v243, v124, v120, s41
  v_perm_b32 v251, v125, v121, s40
  v_perm_b32 v113, v125, v121, s41
  s_waitcnt vmcnt(24)
  s_waitcnt lgkmcnt(0)
  s_barrier
  s_add_u32 s18, s80, 0
  s_add_u32 m0, s42, 0
  s_nop 0
  buffer_load_dwordx4 v56, s[44:47], s18 offen lds
  s_add_u32 s18, s80, 16384
  s_add_u32 m0, s42, 1024
  s_nop 0
  buffer_load_dwordx4 v56, s[44:47], s18 offen lds
  s_add_u32 s18, s80, 262144
  s_add_u32 m0, s42, 2048
  s_nop 0
  buffer_load_dwordx4 v56, s[44:47], s18 offen lds
  s_add_u32 s18, s80, 278528
  s_add_u32 m0, s42, 3072
  s_nop 0
  buffer_load_dwordx4 v56, s[44:47], s18 offen lds
  ds_read_b64_tr_b16 v[144:145], v57 offset:12288
  ds_read_b64_tr_b16 v[152:153], v126 offset:12288
  s_waitcnt vmcnt(27)
  v_accvgpr_read_b32 v118, a32
  v_accvgpr_read_b32 v119, a33
  v_accvgpr_read_b32 v120, a34
  v_accvgpr_read_b32 v121, a35
  s_waitcnt vmcnt(26)
  v_accvgpr_read_b32 v122, a36
  v_accvgpr_read_b32 v123, a37
  v_accvgpr_read_b32 v124, a38
  v_accvgpr_read_b32 v125, a39
  v_perm_b32 v66, v122, v118, s40
  v_perm_b32 v82, v122, v118, s41
  v_perm_b32 v228, v123, v119, s40
  v_perm_b32 v236, v123, v119, s41
  v_perm_b32 v98, v124, v120, s40
  v_perm_b32 v244, v124, v120, s41
  v_perm_b32 v252, v125, v121, s40
  v_perm_b32 v114, v125, v121, s41
  ds_read_b64_tr_b16 v[146:147], v57 offset:13312
  ds_read_b64_tr_b16 v[154:155], v126 offset:13312
  s_waitcnt vmcnt(25)
  v_accvgpr_read_b32 v118, a40
  v_accvgpr_read_b32 v119, a41
  v_accvgpr_read_b32 v120, a42
  v_accvgpr_read_b32 v121, a43
  s_waitcnt vmcnt(24)
  v_accvgpr_read_b32 v122, a44
  v_accvgpr_read_b32 v123, a45
  v_accvgpr_read_b32 v124, a46
  v_accvgpr_read_b32 v125, a47
  v_perm_b32 v67, v122, v118, s40
  v_perm_b32 v83, v122, v118, s41
  v_perm_b32 v229, v123, v119, s40
  v_perm_b32 v237, v123, v119, s41
  v_perm_b32 v99, v124, v120, s40
  v_perm_b32 v245, v124, v120, s41
  v_perm_b32 v253, v125, v121, s40
  v_perm_b32 v115, v125, v121, s41
  ds_read_b64_tr_b16 v[148:149], v57 offset:14336
  ds_read_b64_tr_b16 v[156:157], v126 offset:14336
  s_waitcnt vmcnt(23)
  v_accvgpr_read_b32 v118, a48
  v_accvgpr_read_b32 v119, a49
  v_accvgpr_read_b32 v120, a50
  v_accvgpr_read_b32 v121, a51
  s_waitcnt vmcnt(22)
  v_accvgpr_read_b32 v122, a52
  v_accvgpr_read_b32 v123, a53
  v_accvgpr_read_b32 v124, a54
  v_accvgpr_read_b32 v125, a55
  v_perm_b32 v68, v122, v118, s40
  v_perm_b32 v84, v122, v118, s41
  v_perm_b32 v230, v123, v119, s40
  v_perm_b32 v238, v123, v119, s41
  v_perm_b32 v100, v124, v120, s40
  v_perm_b32 v246, v124, v120, s41
  v_perm_b32 v254, v125, v121, s40
  v_perm_b32 v116, v125, v121, s41
  ds_read_b64_tr_b16 v[150:151], v57 offset:15360
  ds_read_b64_tr_b16 v[158:159], v126 offset:15360
  s_waitcnt vmcnt(21)
  v_accvgpr_read_b32 v118, a56
  v_accvgpr_read_b32 v119, a57
  v_accvgpr_read_b32 v120, a58
  v_accvgpr_read_b32 v121, a59
  s_waitcnt vmcnt(20)
  v_accvgpr_read_b32 v122, a60
  v_accvgpr_read_b32 v123, a61
  v_accvgpr_read_b32 v124, a62
  v_accvgpr_read_b32 v125, a63
  v_perm_b32 v69, v122, v118, s40
  v_perm_b32 v85, v122, v118, s41
  v_perm_b32 v231, v123, v119, s40
  v_perm_b32 v239, v123, v119, s41
  v_perm_b32 v101, v124, v120, s40
  v_perm_b32 v247, v124, v120, s41
  v_perm_b32 v255, v125, v121, s40
  v_perm_b32 v117, v125, v121, s41
  s_waitcnt vmcnt(16)
  s_waitcnt lgkmcnt(0)
  s_barrier
  s_add_u32 s18, s81, 0
  s_add_u32 m0, s42, 4096
  s_nop 0
  buffer_load_dwordx4 v56, s[44:47], s18 offen lds
  s_add_u32 s18, s81, 16384
  s_add_u32 m0, s42, 5120
  s_nop 0
  buffer_load_dwordx4 v56, s[44:47], s18 offen lds
  s_add_u32 s18, s81, 262144
  s_add_u32 m0, s42, 6144
  s_nop 0
  buffer_load_dwordx4 v56, s[44:47], s18 offen lds
  s_add_u32 s18, s81, 278528
  s_add_u32 m0, s42, 7168
  s_nop 0
  buffer_load_dwordx4 v56, s[44:47], s18 offen lds
  ds_read_b64_tr_b16 a[224:225], v57 offset:16384
  ds_read_b64_tr_b16 a[232:233], v126 offset:16384
  ds_read_b64_tr_b16 a[226:227], v57 offset:17408
  ds_read_b64_tr_b16 a[234:235], v126 offset:17408
  ds_read_b64_tr_b16 a[228:229], v57 offset:18432
  ds_read_b64_tr_b16 a[236:237], v126 offset:18432
  ds_read_b64_tr_b16 a[230:231], v57 offset:19456
  ds_read_b64_tr_b16 a[238:239], v126 offset:19456
  s_waitcnt vmcnt(16)
  s_waitcnt lgkmcnt(0)
  s_barrier
  ds_read_b64_tr_b16 a[240:241], v57 offset:20480
  ds_read_b64_tr_b16 a[248:249], v126 offset:20480
  ds_read_b64_tr_b16 a[242:243], v57 offset:21504
  ds_read_b64_tr_b16 a[250:251], v126 offset:21504
  ds_read_b64_tr_b16 a[244:245], v57 offset:22528
  ds_read_b64_tr_b16 a[252:253], v126 offset:22528
  ds_read_b64_tr_b16 a[246:247], v57 offset:23552
  ds_read_b64_tr_b16 a[254:255], v126 offset:23552
  s_waitcnt vmcnt(12)
  s_waitcnt lgkmcnt(0)
  s_barrier
  ds_read_b64_tr_b16 a[192:193], v57 offset:24576
  ds_read_b64_tr_b16 a[200:201], v126 offset:24576
  s_getpc_b64 s[86:87]
L_pc2:
  s_add_u32 s86, s86, L_chain_fast-L_pc2
  s_addc_u32 s87, s87, 0
  s_lshl_b32 s18, s13, 11
  v_add_u32 v59, s18, v0
  global_load_dwordx4 v[118:121], v59, s[86:87]
  global_load_dwordx4 v[118:121], v59, s[86:87] offset:1024
  ds_read_b64_tr_b16 a[194:195], v57 offset:25600
  ds_read_b64_tr_b16 a[202:203], v126 offset:25600
  ds_read_b64_tr_b16 a[196:197], v57 offset:26624
  ds_read_b64_tr_b16 a[204:205], v126 offset:26624
  ds_read_b64_tr_b16 a[198:199], v57 offset:27648
  ds_read_b64_tr_b16 a[206:207], v126 offset:27648
  s_waitcnt vmcnt(10)
  s_waitcnt lgkmcnt(0)
  s_barrier
  s_add_u32 s18, s78, 0
  s_add_u32 m0, s42, 24576
  s_nop 0
  buffer_load_dwordx4 v56, s[44:47], s18 offen lds
  s_add_u32 s18, s78, 16384
  s_add_u32 m0, s42, 25600
  s_nop 0
  buffer_load_dwordx4 v56, s[44:47], s18 offen lds
  s_add_u32 s18, s78, 262144
  s_add_u32 m0, s42, 26624
  s_nop 0
  buffer_load_dwordx4 v56, s[44:47], s18 offen lds
  s_add_u32 s18, s78, 278528
  s_add_u32 m0, s42, 27648
  s_nop 0
  buffer_load_dwordx4 v56, s[44:47], s18 offen lds
  ds_read_b64_tr_b16 a[208:209], v57 offset:28672
  ds_read_b64_tr_b16 a[216:217], v126 offset:28672
  ds_read_b64_tr_b16 a[210:211], v57 offset:29696
  ds_read_b64_tr_b16 a[218:219], v126 offset:29696
  ds_read_b64_tr_b16 a[212:213], v57 offset:30720
  ds_read_b64_tr_b16 a[220:221], v126 offset:30720
  ds_read_b64_tr_b16 a[214:215], v57 offset:31744
  ds_read_b64_tr_b16 a[222:223], v126 offset:31744
  s_waitcnt vmcnt(10)
  s_waitcnt lgkmcnt(0)
  s_barrier
  s_add_u32 s18, s79, 0
  s_add_u32 m0, s42, 28672
  s_nop 0
  buffer_load_dwordx4 v56, s[44:47], s18 offen lds
  s_add_u32 s18, s79, 16384
  s_add_u32 m0, s42, 29696
  s_nop 0
  buffer_load_dwordx4 v56, s[44:47], s18 offen lds
  s_add_u32 s18, s79, 262144
  s_add_u32 m0, s42, 30720
  s_nop 0
  buffer_load_dwordx4 v56, s[44:47], s18 offen lds
  s_add_u32 s18, s79, 278528
  s_add_u32 m0, s42, 31744
  s_nop 0
  buffer_load_dwordx4 v56, s[44:47], s18 offen lds
  s_add_u32 s18, s82, 0
  s_add_u32 m0, s42, 16384
  s_nop 0
  buffer_load_dwordx4 v56, s[44:47], s18 offen lds
  s_add_u32 s18, s82, 16384
  s_add_u32 m0, s42, 17408
  s_nop 0
  buffer_load_dwordx4 v56, s[44:47], s18 offen lds
  s_add_u32 s18, s82, 262144
  s_add_u32 m0, s42, 18432
  s_nop 0
  buffer_load_dwordx4 v56, s[44:47], s18 offen lds
  s_add_u32 s18, s82, 278528
  s_add_u32 m0, s42, 19456
  s_nop 0
  buffer_load_dwordx4 v56, s[44:47], s18 offen lds
  s_add_u32 s18, s83, 0
  s_add_u32 m0, s42, 20480
  s_nop 0
  buffer_load_dwordx4 v56, s[44:47], s18 offen lds
  s_add_u32 s18, s83, 16384
  s_add_u32 m0, s42, 21504
  s_nop 0
  buffer_load_dwordx4 v56, s[44:47], s18 offen lds
  s_add_u32 s18, s83, 262144
  s_add_u32 m0, s42, 22528
  s_nop 0
  buffer_load_dwordx4 v56, s[44:47], s18 offen lds
  s_add_u32 s18, s83, 278528
  s_add_u32 m0, s42, 23552
  s_nop 0
  buffer_load_dwordx4 v56, s[44:47], s18 offen lds
  ds_read_b64_tr_b16 a[32:33], v57 offset:0
  ds_read_b64_tr_b16 a[40:41], v126 offset:0
  ds_read_b64_tr_b16 a[34:35], v57 offset:1024
  ds_read_b64_tr_b16 a[42:43], v126 offset:1024
  ds_read_b64_tr_b16 a[36:37], v57 offset:2048
  ds_read_b64_tr_b16 a[44:45], v126 offset:2048
  ds_read_b64_tr_b16 a[38:39], v57 offset:3072
  ds_read_b64_tr_b16 a[46:47], v126 offset:3072
  s_waitcnt vmcnt(18)
  s_waitcnt lgkmcnt(0)
  s_barrier
  ds_read_b64_tr_b16 a[48:49], v57 offset:4096
  ds_read_b64_tr_b16 a[56:57], v126 offset:4096
  ds_read_b64_tr_b16 a[50:51], v57 offset:5120
  ds_read_b64_tr_b16 a[58:59], v126 offset:5120
  ds_read_b64_tr_b16 a[52:53], v57 offset:6144
  ds_read_b64_tr_b16 a[60:61], v126 offset:6144
  ds_read_b64_tr_b16 a[54:55], v57 offset:7168
  ds_read_b64_tr_b16 a[62:63], v126 offset:7168
  s_waitcnt vmcnt(12)
  s_waitcnt lgkmcnt(0)
  s_barrier
  ds_read_b64_tr_b16 a[0:1], v57 offset:24576
  ds_read_b64_tr_b16 a[8:9], v126 offset:24576
  ds_read_b64_tr_b16 a[2:3], v57 offset:25600
  ds_read_b64_tr_b16 a[10:11], v126 offset:25600
  ds_read_b64_tr_b16 a[4:5], v57 offset:26624
  ds_read_b64_tr_b16 a[12:13], v126 offset:26624
  ds_read_b64_tr_b16 a[6:7], v57 offset:27648
  ds_read_b64_tr_b16 a[14:15], v126 offset:27648
  s_waitcnt vmcnt(8)
  s_waitcnt lgkmcnt(0)
  s_barrier
  s_add_u32 s18, s76, 0
  s_add_u32 m0, s42, 24576
  s_nop 0
  buffer_load_dwordx4 v56, s[44:47], s18 offen lds
  s_add_u32 s18, s76, 16384
  s_add_u32 m0, s42, 25600
  s_nop 0
  buffer_load_dwordx4 v56, s[44:47], s18 offen lds
  s_add_u32 s18, s76, 262144
  s_add_u32 m0, s42, 26624
  s_nop 0
  buffer_load_dwordx4 v56, s[44:47], s18 offen lds
  s_add_u32 s18, s76, 278528
  s_add_u32 m0, s42, 27648
  s_nop 0
  buffer_load_dwordx4 v56, s[44:47], s18 offen lds
  ds_read_b64_tr_b16 a[16:17], v57 offset:28672
  ds_read_b64_tr_b16 a[24:25], v126 offset:28672
  ds_read_b64_tr_b16 a[18:19], v57 offset:29696
  ds_read_b64_tr_b16 a[26:27], v126 offset:29696
  ds_read_b64_tr_b16 a[20:21], v57 offset:30720
  ds_read_b64_tr_b16 a[28:29], v126 offset:30720
  ds_read_b64_tr_b16 a[22:23], v57 offset:31744
  ds_read_b64_tr_b16 a[30:31], v126 offset:31744
  v_lshlrev_b32 v59, 1, v0
  v_and_b32 v59, 0xe0, v59
  buffer_load_dwordx2 v[24:25], v59, s[92:95], 0 offen sc1
  s_waitcnt vmcnt(9)
  s_waitcnt lgkmcnt(0)
  s_barrier
  s_add_u32 s18, s77, 0
  s_add_u32 m0, s42, 28672
  s_nop 0
  buffer_load_dwordx4 v56, s[44:47], s18 offen lds
  s_add_u32 s18, s77, 16384
  s_add_u32 m0, s42, 29696
  s_nop 0
  buffer_load_dwordx4 v56, s[44:47], s18 offen lds
  s_add_u32 s18, s77, 262144
  s_add_u32 m0, s42, 30720
  s_nop 0
  buffer_load_dwordx4 v56, s[44:47], s18 offen lds
  s_add_u32 s18, s77, 278528
  s_add_u32 m0, s42, 31744
  s_nop 0
  buffer_load_dwordx4 v56, s[44:47], s18 offen lds
  ds_read_b64_tr_b16 v[48:49], v57 offset:16384
  ds_read_b64_tr_b16 v[118:119], v126 offset:16384
  ds_read_b64_tr_b16 v[50:51], v57 offset:17408
  ds_read_b64_tr_b16 v[120:121], v126 offset:17408
  ds_read_b64_tr_b16 v[52:53], v57 offset:18432
  ds_read_b64_tr_b16 v[122:123], v126 offset:18432
  ds_read_b64_tr_b16 v[54:55], v57 offset:19456
  ds_read_b64_tr_b16 v[124:125], v126 offset:19456
  s_waitcnt lgkmcnt(5)
  ds_write_b128 v6, v[48:51] offset:8192
  s_waitcnt lgkmcnt(2)
  ds_write_b128 v6, v[52:55] offset:9216
  ds_write_b128 v6, v[118:121] offset:10240
  s_waitcnt lgkmcnt(3)
  ds_write_b128 v6, v[122:125] offset:11264
  s_waitcnt vmcnt(9)
  s_waitcnt lgkmcnt(0)
  s_barrier
  ds_read_b64_tr_b16 v[48:49], v57 offset:20480
  ds_read_b64_tr_b16 v[118:119], v126 offset:20480
  ds_read_b64_tr_b16 v[50:51], v57 offset:21504
  ds_read_b64_tr_b16 v[120:121], v126 offset:21504
  ds_read_b64_tr_b16 v[52:53], v57 offset:22528
  ds_read_b64_tr_b16 v[122:123], v126 offset:22528
  ds_read_b64_tr_b16 v[54:55], v57 offset:23552
  ds_read_b64_tr_b16 v[124:125], v126 offset:23552
  s_waitcnt lgkmcnt(5)
  ds_write_b128 v6, v[48:51] offset:12288
  s_waitcnt lgkmcnt(2)
  ds_write_b128 v6, v[52:55] offset:13312
  ds_write_b128 v6, v[118:121] offset:14336
  s_waitcnt lgkmcnt(3)
  ds_write_b128 v6, v[122:125] offset:15360
  s_waitcnt vmcnt(4)
  v_cmp_gt_u32 vcc, 32, v25
  v_readfirstlane_b32 s25, v24
  v_and_b32 v60, 0x70, v0
  s_cmp_eq_u64 vcc, 0
  s_cselect_b32 s43, 64, 0
  buffer_load_dword v58, v60, s[4:7], s33 offen sc1
  s_waitcnt lgkmcnt(0)
  s_barrier
  ds_read_b64_tr_b16 v[48:49], v57 offset:24576
  ds_read_b64_tr_b16 v[118:119], v126 offset:24576
  ds_read_b64_tr_b16 v[50:51], v57 offset:25600
  ds_read_b64_tr_b16 v[120:121], v126 offset:25600
  ds_read_b64_tr_b16 v[52:53], v57 offset:26624
  ds_read_b64_tr_b16 v[122:123], v126 offset:26624
  ds_read_b64_tr_b16 v[54:55], v57 offset:27648
  ds_read_b64_tr_b16 v[124:125], v126 offset:27648
  s_waitcnt lgkmcnt(5)
  ds_write_b128 v6, v[48:51] offset:0
  s_waitcnt lgkmcnt(2)
  ds_write_b128 v6, v[52:55] offset:1024
  ds_write_b128 v6, v[118:121] offset:2048
  s_waitcnt lgkmcnt(3)
  ds_write_b128 v6, v[122:125] offset:3072
  s_waitcnt vmcnt(1)
  s_waitcnt lgkmcnt(0)
  s_barrier
  ds_read_b64_tr_b16 v[48:49], v57 offset:28672
  ds_read_b64_tr_b16 v[118:119], v126 offset:28672
  ds_read_b64_tr_b16 v[50:51], v57 offset:29696
  ds_read_b64_tr_b16 v[120:121], v126 offset:29696
  ds_read_b64_tr_b16 v[52:53], v57 offset:30720
  ds_read_b64_tr_b16 v[122:123], v126 offset:30720
  ds_read_b64_tr_b16 v[54:55], v57 offset:31744
  ds_read_b64_tr_b16 v[124:125], v126 offset:31744
  s_waitcnt lgkmcnt(5)
  ds_write_b128 v6, v[48:51] offset:4096
  s_waitcnt lgkmcnt(2)
  ds_write_b128 v6, v[52:55] offset:5120
  ds_write_b128 v6, v[118:121] offset:6144
  s_waitcnt lgkmcnt(3)
  ds_write_b128 v6, v[122:125] offset:7168
  s_mov_b32 s15, 64
  s_waitcnt vmcnt(0)
  v_readlane_b32 s19, v58, 1
  s_nop 0
  s_cmp_lt_u32 s19, 10
  s_cselect_b32 s19, s19, 64
  s_mul_i32 s19, s19, 7
  s_add_u32 s19, s19, 0
  s_min_u32 s15, s15, s19
  v_readlane_b32 s19, v58, 2
  s_nop 0
  s_cmp_lt_u32 s19, 9
  s_cselect_b32 s19, s19, 64
  s_mul_i32 s19, s19, 7
  s_add_u32 s19, s19, 1
  s_min_u32 s15, s15, s19
  v_readlane_b32 s19, v58, 3
  s_nop 0
  s_cmp_lt_u32 s19, 9
  s_cselect_b32 s19, s19, 64
  s_mul_i32 s19, s19, 7
  s_add_u32 s19, s19, 2
  s_min_u32 s15, s15, s19
  v_readlane_b32 s19, v58, 4
  s_nop 0
  s_cmp_lt_u32 s19, 9
  s_cselect_b32 s19, s19, 64
  s_mul_i32 s19, s19, 7
  s_add_u32 s19, s19, 3
  s_min_u32 s15, s15, s19
  v_readlane_b32 s19, v58, 5
  s_nop 0
  s_cmp_lt_u32 s19, 9
  s_cselect_b32 s19, s19, 64
  s_mul_i32 s19, s19, 7
  s_add_u32 s19, s19, 4
  s_min_u32 s15, s15, s19
  v_readlane_b32 s19, v58, 6
  s_nop 0
  s_cmp_lt_u32 s19, 9
  s_cselect_b32 s19, s19, 64
  s_mul_i32 s19, s19, 7
  s_add_u32 s19, s19, 5
  s_min_u32 s15, s15, s19
  v_readlane_b32 s19, v58, 7
  s_nop 0
  s_cmp_lt_u32 s19, 9
  s_cselect_b32 s19, s19, 64
  s_mul_i32 s19, s19, 7
  s_add_u32 s19, s19, 6
  s_min_u32 s15, s15, s19
  s_min_u32 s15, s15, s43
  s_mov_b32 m0, s34
  buffer_load_dwordx4 v[24:27], v0, s[4:7], s37 offen sc1
  buffer_load_dwordx4 v0, s[4:7], s16 offen sc1 lds
  buffer_load_dwordx4 v[28:31], v0, s[4:7], s37 offen offset:1024 sc1
  buffer_load_dwordx4 v0, s[4:7], s16 offen offset:1024 sc1 lds
  s_add_u32 s16, s16, 8192
  s_add_u32 s37, s37, 8192
  s_waitcnt lgkmcnt(0)
  s_barrier
  s_waitcnt lgkmcnt(0)
  ds_write_b128 v6, v[32:35] offset:16384
  ds_write_b128 v6, v[36:39] offset:17408
  ds_write_b128 v6, v[62:65] offset:18432
  ds_write_b128 v6, v[66:69] offset:19456
  ds_write_b128 v6, v[70:73] offset:20480
  ds_write_b128 v6, v[74:77] offset:21504
  ds_write_b128 v6, v[78:81] offset:22528
  ds_write_b128 v6, v[82:85] offset:23552
  ds_write_b128 v6, v[86:89] offset:24576
  ds_write_b128 v6, v[90:93] offset:25600
  ds_write_b128 v6, v[94:97] offset:26624
  ds_write_b128 v6, v[98:101] offset:27648
  ds_write_b128 v6, v[102:105] offset:28672
  ds_write_b128 v6, v[106:109] offset:29696
  ds_write_b128 v6, v[110:113] offset:30720
  ds_write_b128 v6, v[114:117] offset:31744
  s_waitcnt lgkmcnt(0)
L_lw_done:
  s_waitcnt lgkmcnt(0)
  ds_read_b128 v[96:99], v6 offset:0
  ds_read_b128 v[100:103], v6 offset:1024
  ds_read_b128 v[104:107], v6 offset:2048
  ds_read_b128 v[108:111], v6 offset:3072
  ds_read_b128 v[112:115], v6 offset:4096
  ds_read_b128 v[116:119], v6 offset:5120
  ds_read_b128 v[120:123], v6 offset:6144
  ds_read_b128 v[124:127], v6 offset:7168
  v_mov_b64 v[72:73], 0
  v_mov_b64 v[74:75], 0
  v_mov_b64 v[76:77], 0
  v_mov_b64 v[78:79], 0
  v_mov_b64 v[80:81], 0
  v_mov_b64 v[82:83], 0
  v_mov_b64 v[84:85], 0
  v_mov_b64 v[86:87], 0
  v_mov_b64 v[88:89], 0
  v_mov_b64 v[90:91], 0
  v_mov_b64 v[92:93], 0
  v_mov_b64 v[94:95], 0
  s_waitcnt vmcnt(0) lgkmcnt(0)
  s_cmp_lg_u32 s15, 0
  s_cbranch_scc1 L_cd
  v_lshlrev_b32 v59, 1, v0
  v_and_b32 v59, 0xe0, v59
L_cw:
  buffer_load_dwordx2 v[54:55], v59, s[92:95], 0 offen sc1
  s_add_u32 s24, s24, 1
  s_cmp_gt_u32 s24, 0x100000
  s_cbranch_scc1 L_bail
  s_waitcnt vmcnt(0)
  v_cmp_gt_u32 vcc, 32, v55
  s_cbranch_vccnz L_cw
  v_readfirstlane_b32 s25, v54
  s_mov_b32 s14, -1
  s_add_u32 s18, s14, 1
  s_min_u32 s18, s18, 63
  s_cmp_lt_u32 s18, s15
  s_cbranch_scc1 L_kvok_i
L_kvpoll_i:
  v_and_b32 v64, 0x70, v0
  buffer_load_dword v65, v64, s[4:7], s33 offen sc1
  s_waitcnt vmcnt(0)
  s_mov_b32 s15, 64
  v_readlane_b32 s19, v65, 1
  s_nop 0
  s_cmp_lt_u32 s19, 10
  s_cselect_b32 s19, s19, 64
  s_mul_i32 s19, s19, 7
  s_add_u32 s19, s19, 0
  s_min_u32 s15, s15, s19
  v_readlane_b32 s19, v65, 2
  s_nop 0
  s_cmp_lt_u32 s19, 9
  s_cselect_b32 s19, s19, 64
  s_mul_i32 s19, s19, 7
  s_add_u32 s19, s19, 1
  s_min_u32 s15, s15, s19
  v_readlane_b32 s19, v65, 3
  s_nop 0
  s_cmp_lt_u32 s19, 9
  s_cselect_b32 s19, s19, 64
  s_mul_i32 s19, s19, 7
  s_add_u32 s19, s19, 2
  s_min_u32 s15, s15, s19
  v_readlane_b32 s19, v65, 4
  s_nop 0
  s_cmp_lt_u32 s19, 9
  s_cselect_b32 s19, s19, 64
  s_mul_i32 s19, s19, 7
  s_add_u32 s19, s19, 3
  s_min_u32 s15, s15, s19
  v_readlane_b32 s19, v65, 5
  s_nop 0
  s_cmp_lt_u32 s19, 9
  s_cselect_b32 s19, s19, 64
  s_mul_i32 s19, s19, 7
  s_add_u32 s19, s19, 4
  s_min_u32 s15, s15, s19
  v_readlane_b32 s19, v65, 6
  s_nop 0
  s_cmp_lt_u32 s19, 9
  s_cselect_b32 s19, s19, 64
  s_mul_i32 s19, s19, 7
  s_add_u32 s19, s19, 5
  s_min_u32 s15, s15, s19
  v_readlane_b32 s19, v65, 7
  s_nop 0
  s_cmp_lt_u32 s19, 9
  s_cselect_b32 s19, s19, 64
  s_mul_i32 s19, s19, 7
  s_add_u32 s19, s19, 6
  s_min_u32 s15, s15, s19
  s_add_u32 s24, s24, 1
  s_cmp_gt_u32 s24, 0x40000
  s_cbranch_scc1 L_bail
  s_cmp_lt_u32 s18, s15
  s_cbranch_scc0 L_kvpoll_i
L_kvok_i:
  s_mov_b32 s14, 0
  s_sub_u32 s16, s16, 8192
  s_sub_u32 s37, s37, 8192
  s_mov_b32 m0, s34
  buffer_load_dwordx4 v[24:27], v0, s[4:7], s37 offen sc1
  buffer_load_dwordx4 v0, s[4:7], s16 offen sc1 lds
  buffer_load_dwordx4 v[28:31], v0, s[4:7], s37 offen offset:1024 sc1
  buffer_load_dwordx4 v0, s[4:7], s16 offen offset:1024 sc1 lds
  s_add_u32 s16, s16, 8192
  s_add_u32 s37, s37, 8192
  s_waitcnt vmcnt(0)
L_cd:
  s_cmp_lt_u32 s25, 32
  s_cbranch_scc1 L_chain_slow
L_chain_fast:
  s_add_u32 s18, s14, 1
  s_min_u32 s18, s18, 63
  s_cmp_lt_u32 s18, s15
  s_cbranch_scc1 L_kvok_fast_j
L_kvpoll_fast_j:
  v_and_b32 v64, 0x70, v0
  buffer_load_dword v65, v64, s[4:7], s33 offen sc1
  s_waitcnt vmcnt(0)
  s_mov_b32 s15, 64
  v_readlane_b32 s19, v65, 1
  s_nop 0
  s_cmp_lt_u32 s19, 10
  s_cselect_b32 s19, s19, 64
  s_mul_i32 s19, s19, 7
  s_add_u32 s19, s19, 0
  s_min_u32 s15, s15, s19
  v_readlane_b32 s19, v65, 2
  s_nop 0
  s_cmp_lt_u32 s19, 9
  s_cselect_b32 s19, s19, 64
  s_mul_i32 s19, s19, 7
  s_add_u32 s19, s19, 1
  s_min_u32 s15, s15, s19
  v_readlane_b32 s19, v65, 3
  s_nop 0
  s_cmp_lt_u32 s19, 9
  s_cselect_b32 s19, s19, 64
  s_mul_i32 s19, s19, 7
  s_add_u32 s19, s19, 2
  s_min_u32 s15, s15, s19
  v_readlane_b32 s19, v65, 4
  s_nop 0
  s_cmp_lt_u32 s19, 9
  s_cselect_b32 s19, s19, 64
  s_mul_i32 s19, s19, 7
  s_add_u32 s19, s19, 3
  s_min_u32 s15, s15, s19
  v_readlane_b32 s19, v65, 5
  s_nop 0
  s_cmp_lt_u32 s19, 9
  s_cselect_b32 s19, s19, 64
  s_mul_i32 s19, s19, 7
  s_add_u32 s19, s19, 4
  s_min_u32 s15, s15, s19
  v_readlane_b32 s19, v65, 6
  s_nop 0
  s_cmp_lt_u32 s19, 9
  s_cselect_b32 s19, s19, 64
  s_mul_i32 s19, s19, 7
  s_add_u32 s19, s19, 5
  s_min_u32 s15, s15, s19
  v_readlane_b32 s19, v65, 7
  s_nop 0
  s_cmp_lt_u32 s19, 9
  s_cselect_b32 s19, s19, 64
  s_mul_i32 s19, s19, 7
  s_add_u32 s19, s19, 6
  s_min_u32 s15, s15, s19
  s_add_u32 s24, s24, 1
  s_cmp_gt_u32 s24, 0x40000
  s_cbranch_scc1 L_bail
  s_cmp_lt_u32 s18, s15
  s_cbranch_scc0 L_kvpoll_fast_j
L_kvok_fast_j:
  s_waitcnt vmcnt(0) lgkmcnt(0)
  s_branch L_in_fast
L_top_fast:
  s_bitcmp1_b32 s13, 0
  s_cbranch_scc1 L_ne_fast0
  s_nop 15
  s_nop 15
L_ne_fast0:
  s_cmp_lt_u32 s15, 64
  s_cbranch_scc1 L_up_fast0
  s_nop 15
  s_nop 15
  s_nop 15
L_ud_fast0:
  buffer_load_dwordx4 v[40:43], v0, s[4:7], s28 offen sc1
  buffer_load_dwordx4 v[44:47], v0, s[4:7], s28 offen offset:1024 sc1
  s_nop 15
  s_nop 15
  buffer_load_dwordx4 v[48:51], v0, s[4:7], s28 offen sc1
  buffer_load_dwordx4 v[52:55], v0, s[4:7], s28 offen offset:1024 sc1
L_in_fast:
.p2align 6
L_go_fast0:
  s_waitcnt vmcnt(3)
  ds_write_b128 v2, v[40:43]
  v_smfmac_f32_16x16x64_bf16 v[76:79], v[40:43], v[104:111], v1
  s_waitcnt vmcnt(2)
  ds_write_b128 v2, v[44:47] offset:1024
  v_max3_u32 v64, v40, v42, v44
  v_max_u32 v64, v64, v46
  v_cmp_eq_u32 vcc, -1, v64
  v_smfmac_f32_16x16x64_bf16 v[80:83], v[40:43], a[64:71], v1
  v_smfmac_f32_16x16x64_bf16 v[76:79], v[44:47], v[120:127], v1
  s_cbranch_vccnz L_mr_fast0
  v_smfmac_f32_16x16x64_bf16 v[72:75], v[40:43], v[96:103], v1
  s_waitcnt lgkmcnt(0)
  s_barrier
  v_smfmac_f32_16x16x64_bf16 v[88:91], v[40:43], a[192:199], v1
  s_waitcnt vmcnt(0)
  ds_read_b128 v[52:55], v3 offset:1024
  ds_read_b128 v[48:51], v3
  v_smfmac_f32_16x16x64_bf16 v[84:87], v[40:43], a[72:79], v1
  ds_read_b128 v[56:59], v4
  v_smfmac_f32_16x16x64_bf16 v[72:75], v[44:47], v[112:119], v1
  ds_read_b128 v[60:63], v4 offset:1024
  v_smfmac_f32_16x16x64_bf16 v[80:83], v[44:47], a[80:87], v1
  ds_read_b128 v[68:71], v5 offset:1024
  s_mov_b64 vcc, s[20:21]
  v_smfmac_f32_16x16x64_bf16 v[84:87], v[44:47], a[88:95], v1
  ds_read_b128 v[96:99], v6 offset:8192
  s_waitcnt lgkmcnt(4)
  v_smfmac_f32_16x16x64_bf16 v[76:79], v[48:51], a[8:15], v1
  ds_read_b128 v[120:123], v6 offset:14336
  ds_read_b128 v[116:119], v6 offset:13312
  v_smfmac_f32_16x16x64_bf16 v[72:75], v[48:51], a[0:7], v1
  ds_read_b128 v[100:103], v6 offset:9216
  v_smfmac_f32_16x16x64_bf16 v[92:95], v[40:43], a[200:207], v1
  ds_read_b128 v[64:67], v5
  s_waitcnt lgkmcnt(7)
  v_smfmac_f32_16x16x64_bf16 v[76:79], v[56:59], a[40:47], v1
  v_smfmac_f32_16x16x64_bf16 v[92:95], v[44:47], a[216:223], v1
  ds_read_b128 v[104:107], v6 offset:10240
  v_smfmac_f32_16x16x64_bf16 v[88:91], v[44:47], a[208:215], v1
  ds_read_b128 v[108:111], v6 offset:11264
  v_mov_b64 v[40:41], 0
  v_smfmac_f32_16x16x64_bf16 v[72:75], v[52:55], a[16:23], v1
  ds_read_b128 v[124:127], v6 offset:15360
  ds_read_b128 v[112:115], v6 offset:12288
  v_smfmac_f32_16x16x64_bf16 v[72:75], v[56:59], a[32:39], v1
  buffer_store_dwordx4 v[14:17], v0, s[4:7], s17 offen sc1
  s_mov_b32 m0, s35
  v_mov_b64 v[44:45], 0
  s_waitcnt lgkmcnt(10)
  v_smfmac_f32_16x16x64_bf16 v[72:75], v[60:63], a[48:55], v1
  s_mov_b32 s17, s38
  v_mov_b64 v[42:43], 0
  v_smfmac_f32_16x16x64_bf16 v[76:79], v[52:55], a[24:31], v1
  s_waitcnt lgkmcnt(4)
  v_smfmac_f32_16x16x64_bf16 v[72:75], v[64:67], v[96:103], v1
  s_waitcnt lgkmcnt(0)
  v_smfmac_f32_16x16x64_bf16 v[72:75], v[68:71], v[112:119], v1
  v_mov_b64 v[46:47], 0
  v_smfmac_f32_16x16x64_bf16 v[76:79], v[64:67], v[104:111], v1
  ds_read_b128 v[112:115], v0 offset:0
  ds_read_b128 v[116:119], v0 offset:1024
  v_smfmac_f32_16x16x64_bf16 v[76:79], v[60:63], a[56:63], v1
  v_smfmac_f32_16x16x64_bf16 v[76:79], v[68:71], v[120:127], v1
  buffer_load_dwordx4 v[32:35], v0, s[4:7], s37 offen sc1
  v_smfmac_f32_16x16x64_bf16 v[84:87], v[48:51], a[104:111], v1
  s_add_u32 s38, s38, 4096
  v_add_f32 v72, v72, v74
  v_smfmac_f32_16x16x64_bf16 v[80:83], v[48:51], a[96:103], v1
  v_add_f32 v73, v73, v75
  v_smfmac_f32_16x16x64_bf16 v[80:83], v[52:55], a[112:119], v1
  s_nop 0
  v_add_f32 v77, v77, v79
  v_add_f32 v76, v76, v78
  v_cvt_pk_bf16_f32 v72, v72, v73
  v_cvt_pk_bf16_f32 v74, v76, v77
  v_smfmac_f32_16x16x64_bf16 v[80:83], v[60:63], a[144:151], v1
  ds_write2st64_b32 v7, v72, v74 offset0:32 offset1:34
  v_smfmac_f32_16x16x64_bf16 v[84:87], v[52:55], a[120:127], v1
  buffer_load_dwordx4 v0, s[4:7], s16 offen sc1 lds
  v_smfmac_f32_16x16x64_bf16 v[80:83], v[64:67], a[160:167], v1
  v_smfmac_f32_16x16x64_bf16 v[84:87], v[56:59], a[136:143], v1
  ds_read_b128 v[124:127], v0 offset:3072
  ds_read_b128 v[120:123], v0 offset:2048
  v_smfmac_f32_16x16x64_bf16 v[84:87], v[60:63], a[152:159], v1
  s_waitcnt lgkmcnt(2)
  s_barrier
  ds_read_b64_tr_b16 v[102:103], v8 offset:8832
  v_smfmac_f32_16x16x64_bf16 v[84:87], v[68:71], a[184:191], v1
  ds_read_b64_tr_b16 v[98:99], v8 offset:8704
  ds_read_b64_tr_b16 v[108:109], v8 offset:8576
  v_smfmac_f32_16x16x64_bf16 v[80:83], v[68:71], a[176:183], v1
  ds_read_b64_tr_b16 v[96:97], v8 offset:8192
  v_smfmac_f32_16x16x64_bf16 v[88:91], v[48:51], a[224:231], v1
  ds_read_b64_tr_b16 v[110:111], v8 offset:9088
  v_smfmac_f32_16x16x64_bf16 v[80:83], v[56:59], a[128:135], v1
  buffer_load_dwordx4 v[36:39], v0, s[4:7], s37 offen offset:1024 sc1
  v_smfmac_f32_16x16x64_bf16 v[84:87], v[64:67], a[168:175], v1
  ds_read_b64_tr_b16 v[100:101], v8 offset:8320
  ds_read_b64_tr_b16 v[104:105], v8 offset:8448
  ds_read_b64_tr_b16 v[106:107], v8 offset:8960
  v_smfmac_f32_16x16x64_bf16 v[92:95], v[48:51], a[232:239], v1
  s_nop 1
  v_add_f32 v80, v80, v82
  s_waitcnt lgkmcnt(4)
  v_mfma_f32_16x16x32_bf16 v[72:75], v[112:115], v[96:99], 0
  ds_read_b128 v[112:115], v0 offset:4096
  v_add_f32 v81, v81, v83
  v_cvt_pk_bf16_f32 v15, v80, v81
  v_mfma_f32_16x16x32_bf16 v[76:79], v[116:119], v[96:99], 0
  ds_read_b128 v[116:119], v0 offset:5120
  v_add_f32 v84, v84, v86
  v_add_f32 v85, v85, v87
  v_cvt_pk_bf16_f32 v17, v84, v85
  s_waitcnt lgkmcnt(4)
  v_mfma_f32_16x16x32_bf16 v[72:75], v[120:123], v[100:103], v[72:75]
  ds_write2st64_b32 v7, v15, v17 offset0:0 offset1:2
  v_mfma_f32_16x16x32_bf16 v[76:79], v[124:127], v[100:103], v[76:79]
  buffer_load_dwordx4 v0, s[4:7], s16 offen offset:1024 sc1 lds
  v_mov_b64 v[82:83], 0
  v_smfmac_f32_16x16x64_bf16 v[92:95], v[52:55], a[248:255], v1
  ds_read_b128 v[120:123], v0 offset:6144
  ds_read_b128 v[124:127], v0 offset:7168
  v_smfmac_f32_16x16x64_bf16 v[88:91], v[52:55], a[240:247], v1
  s_add_u32 s16, s16, 8192
  s_waitcnt lgkmcnt(3)
  v_mfma_f32_16x16x32_bf16 v[76:79], v[116:119], v[104:107], v[76:79]
  s_waitcnt lgkmcnt(2)
  s_barrier
  ds_read_b64_tr_b16 v[116:117], v8 offset:128
  v_mfma_f32_16x16x32_bf16 v[72:75], v[112:115], v[104:107], v[72:75]
  ds_read_b64_tr_b16 v[114:115], v8 offset:512
  v_mov_b64 v[80:81], 0
  s_waitcnt lgkmcnt(3)
  v_mfma_f32_16x16x32_bf16 v[72:75], v[120:123], v[108:111], v[72:75]
  ds_read_b64_tr_b16 v[112:113], v8 offset:0
  s_waitcnt lgkmcnt(3)
  v_mfma_f32_16x16x32_bf16 v[76:79], v[124:127], v[108:111], v[76:79]
  ds_read_b64_tr_b16 v[118:119], v8 offset:640
  ds_read_b64_tr_b16 v[120:121], v8 offset:256
  v_smfmac_f32_16x16x64_bf16 v[88:91], v[56:59], v[128:135], v1
  ds_read_b64_tr_b16 v[122:123], v8 offset:768
  ds_read_b64_tr_b16 v[124:125], v8 offset:384
  v_smfmac_f32_16x16x64_bf16 v[92:95], v[56:59], v[136:143], v1
  ds_read_b128 v[48:51], v6 offset:16384
  s_waitcnt lgkmcnt(5)
  v_mfma_f32_16x16x32_bf16 v[84:87], v[112:115], v[96:99], 0
  ds_read_b64_tr_b16 v[126:127], v8 offset:896
  v_cndmask_b32_dpp v72, v76, v72, vcc quad_perm:[0,1,0,1] row_mask:0xf bank_mask:0xf
  v_cndmask_b32_dpp v73, v77, v73, vcc quad_perm:[0,1,0,1] row_mask:0xf bank_mask:0xf
  v_exp_f32 v76, v72
  v_smfmac_f32_16x16x64_bf16 v[92:95], v[60:63], v[152:159], v1
  ds_read_b128 v[56:59], v6 offset:20480
  v_cndmask_b32_dpp v74, v78, v74, vcc quad_perm:[0,1,0,1] row_mask:0xf bank_mask:0xf
  v_smfmac_f32_16x16x64_bf16 v[88:91], v[60:63], v[144:151], v1
  ds_read_b128 v[52:55], v6 offset:17408
  s_waitcnt lgkmcnt(7)
  v_mfma_f32_16x16x32_bf16 v[84:87], v[116:119], v[100:103], v[84:87]
  ds_read_b128 v[60:63], v6 offset:21504
  s_waitcnt lgkmcnt(6)
  v_mfma_f32_16x16x32_bf16 v[84:87], v[120:123], v[104:107], v[84:87]
  v_cndmask_b32_dpp v75, v79, v75, vcc quad_perm:[0,1,0,1] row_mask:0xf bank_mask:0xf
  v_exp_f32 v77, v73
  s_waitcnt lgkmcnt(3)
  v_mfma_f32_16x16x32_bf16 v[84:87], v[124:127], v[108:111], v[84:87]
  v_exp_f32 v79, v75
  v_smfmac_f32_16x16x64_bf16 v[88:91], v[68:71], v[176:183], v1
  v_cvt_pk_bf16_f32 v76, v76, v77
  v_exp_f32 v78, v74
  v_smfmac_f32_16x16x64_bf16 v[88:91], v[64:67], v[160:167], v1
  ds_read_b128 v[116:119], v6 offset:19456
  v_cvt_pk_bf16_f32 v77, v78, v79
  v_smfmac_f32_16x16x64_bf16 v[92:95], v[64:67], v[168:175], v1
  ds_read_b128 v[120:123], v6 offset:22528
  v_cndmask_b32_dpp v84, v85, v84, vcc quad_perm:[0,1,0,1] row_mask:0xf bank_mask:0xf
  v_mul_f32 v84, s22, v84
  v_smfmac_f32_16x16x64_bf16 v[92:95], v[68:71], v[184:191], v1
  ds_read_b128 v[124:127], v6 offset:23552
  ds_read_b128 v[100:103], v6 offset:25600
  v_add_f32 v89, v89, v91
  v_add_f32 v88, v88, v90
  v_smfmac_f32_16x16x32_bf16 v[80:83], v[76:77], v[20:23], v1
  v_exp_f32 v85, v84
  v_smfmac_f32_16x16x32_bf16 v[40:43], v[76:77], v[24:27], v1
  s_add_u32 s37, s37, 8192
  ds_read_b128 v[96:99], v6 offset:24576
  v_cvt_pk_bf16_f32 v18, v85, v85
  v_smfmac_f32_16x16x32_bf16 v[44:47], v[76:77], v[28:31], v1
  v_and_b32 v18, v13, v18
  v_cvt_pk_bf16_f32 v14, v88, v89
  v_add_f32 v92, v92, v94
  v_mfma_f32_16x16x16_bf16 v[80:83], v[18:19], v[20:21], v[80:83]
  v_mov_b64 v[90:91], 0
  v_add_f32 v93, v93, v95
  v_mfma_f32_16x16x16_bf16 v[40:43], v[18:19], v[14:15], v[40:43]
  ds_read_b128 v[64:67], v6 offset:26624
  v_cvt_pk_bf16_f32 v16, v92, v93
  v_mov_b64 v[88:89], 0
  s_nop 0
  v_mfma_f32_16x16x16_bf16 v[44:47], v[18:19], v[16:17], v[44:47]
  ds_read_b128 v[68:71], v6 offset:27648
  v_add_f32 v80, v80, v82
  v_rcp_f32 v80, v80
  v_add_f32 v81, v81, v83
  v_rcp_f32 v81, v81
  v_add_f32 v40, v40, v42
  v_add_f32 v41, v41, v43
  v_mul_f32 v41, v41, v81
  v_add_f32 v45, v45, v47
  v_add_f32 v44, v44, v46
  v_mul_f32 v45, v45, v81
  v_mul_f32 v44, v44, v80
  v_mul_f32 v40, v40, v80
  v_cvt_pk_bf16_f32 v83, v44, v45
  v_subrev_u32 v78, s39, v80
  v_cvt_pk_bf16_f32 v82, v40, v41
  v_subrev_u32 v79, s39, v81
  v_max_u32 v78, v78, v79
  ds_write_b64 v7, v[82:83] offset:8192
  v_cmp_lt_u32 vcc, s23, v78
  v_mov_b64 v[92:93], 0
  ds_read_b128 v[112:115], v6 offset:18432
  v_mov_b64 v[94:95], 0
  s_cbranch_vccnz L_sm_fast0
L_smr_fast0:
  v_mov_b64 v[76:77], 0
  v_mov_b64 v[86:87], 0
  v_mov_b64 v[74:75], 0
  v_mov_b64 v[82:83], 0
  v_mov_b64 v[84:85], 0
  s_waitcnt lgkmcnt(1)
  s_barrier
  ds_read_b64_tr_b16 v[24:25], v8 offset:8192
  v_mov_b64 v[78:79], 0
  ds_read_b64_tr_b16 v[26:27], v8 offset:8320
  ds_read_b64_tr_b16 v[28:29], v8 offset:8448
  v_mov_b64 v[44:45], 0
  ds_read_b64_tr_b16 v[30:31], v8 offset:8576
  v_mov_b64 v[42:43], 0
  v_mov_b64 v[72:73], 0
  v_mov_b64 v[80:81], 0
  s_waitcnt lgkmcnt(2)
  v_smfmac_f32_16x16x64_bf16 v[72:75], v[24:27], v[48:55], v1
  ds_read_b128 v[48:51], v6 offset:28672
  ds_read_b128 v[52:55], v6 offset:29696
  v_smfmac_f32_16x16x64_bf16 v[76:79], v[24:27], v[56:63], v1
  s_waitcnt lgkmcnt(2)
  v_smfmac_f32_16x16x64_bf16 v[76:79], v[28:31], v[120:127], v1
  v_smfmac_f32_16x16x64_bf16 v[72:75], v[28:31], v[112:119], v1
  ds_read_b128 v[60:63], v6 offset:31744
  v_mov_b64 v[40:41], 0
  v_smfmac_f32_16x16x64_bf16 v[80:83], v[24:27], v[192:199], v1
  ds_read_b128 v[56:59], v6 offset:30720
  v_smfmac_f32_16x16x64_bf16 v[80:83], v[28:31], v[224:231], v1
  s_nop 1
  v_add_f32 v76, v76, v78
  v_smfmac_f32_16x16x64_bf16 v[84:87], v[28:31], v[232:239], v1
  v_and_b32 v76, s36, v76
  v_or_b32 v76, s27, v76
  v_smfmac_f32_16x16x64_bf16 v[84:87], v[24:27], v[200:207], v1
  v_add_f32 v72, v72, v74
  v_smfmac_f32_16x16x64_bf16 v[88:91], v[24:27], v[96:103], v1
  v_add_f32 v77, v77, v79
  v_add_f32 v80, v80, v82
  v_smfmac_f32_16x16x64_bf16 v[92:95], v[28:31], v[240:247], v1
  v_cvt_pk_bf16_f32 v104, v72, v76
  v_smfmac_f32_16x16x64_bf16 v[92:95], v[24:27], v[208:215], v1
  s_nop 0
  v_add_f32 v84, v84, v86
  v_smfmac_f32_16x16x64_bf16 v[88:91], v[28:31], v[64:71], v1
  v_mov_b64 v[46:47], 0
  v_add_f32 v81, v81, v83
  v_add_f32 v85, v85, v87
  v_add_f32 v73, v73, v75
  v_cvt_pk_bf16_f32 v106, v73, v77
  v_smfmac_f32_16x16x64_bf16 v[40:43], v[24:27], v[216:223], v1
  v_cvt_pk_bf16_f32 v105, v80, v84
  v_cvt_pk_bf16_f32 v107, v81, v85
  s_waitcnt lgkmcnt(2)
  v_smfmac_f32_16x16x64_bf16 v[44:47], v[24:27], v[48:55], v1
  buffer_store_dwordx4 v[104:107], v10, s[4:7], s26 offen offset:0
  v_add_f32 v92, v92, v94
  v_add_f32 v88, v88, v90
  s_waitcnt lgkmcnt(0)
  v_smfmac_f32_16x16x64_bf16 v[44:47], v[28:31], v[56:63], v1
  v_add_f32 v93, v93, v95
  v_smfmac_f32_16x16x64_bf16 v[40:43], v[28:31], v[248:255], v1
  v_add_f32 v89, v89, v91
  v_cvt_pk_bf16_f32 v110, v89, v93
  v_and_b32 v92, s36, v92
  v_or_b32 v92, s27, v92
  v_cvt_pk_bf16_f32 v108, v88, v92
  s_nop 0
  v_add_f32 v44, v44, v46
  v_add_f32 v45, v45, v47
  v_add_f32 v41, v41, v43
  v_add_f32 v40, v40, v42
  v_cvt_pk_bf16_f32 v109, v40, v44
  v_cvt_pk_bf16_f32 v111, v41, v45
  buffer_store_dwordx4 v[108:111], v10, s[4:7], s26 offen offset:2048
  v_mov_b32 v68, -1
  ds_read_b128 v[56:59], v0 offset:28928
  s_add_u32 s14, s14, 1
  ds_read_b128 v[96:99], v6 offset:0
  ds_read_b128 v[100:103], v6 offset:1024
  ds_read_b128 v[104:107], v6 offset:2048
  ds_read_b128 v[108:111], v6 offset:3072
  ds_read_b128 v[112:115], v6 offset:4096
  ds_read_b128 v[116:119], v6 offset:5120
  ds_read_b128 v[120:123], v6 offset:6144
  ds_read_b128 v[124:127], v6 offset:7168
  v_mov_b64 v[72:73], 0
  v_mov_b64 v[74:75], 0
  v_mov_b64 v[76:77], 0
  v_mov_b64 v[78:79], 0
  v_mov_b64 v[80:81], 0
  v_mov_b64 v[82:83], 0
  v_mov_b64 v[84:85], 0
  v_mov_b64 v[86:87], 0
  v_mov_b64 v[88:89], 0
  v_mov_b64 v[90:91], 0
  v_mov_b64 v[92:93], 0
  v_mov_b64 v[94:95], 0
  s_waitcnt lgkmcnt(0)
  s_add_u32 s18, s14, 1
  s_min_u32 s18, s18, 63
  s_cmp_lt_u32 s18, s15
  s_cbranch_scc1 L_kvok_fast0
L_kvpoll_fast0:
  v_and_b32 v64, 0x70, v0
  buffer_load_dword v65, v64, s[4:7], s33 offen sc1
  s_waitcnt vmcnt(0)
  s_mov_b32 s15, 64
  v_readlane_b32 s19, v65, 1
  s_nop 0
  s_cmp_lt_u32 s19, 10
  s_cselect_b32 s19, s19, 64
  s_mul_i32 s19, s19, 7
  s_add_u32 s19, s19, 0
  s_min_u32 s15, s15, s19
  v_readlane_b32 s19, v65, 2
  s_nop 0
  s_cmp_lt_u32 s19, 9
  s_cselect_b32 s19, s19, 64
  s_mul_i32 s19, s19, 7
  s_add_u32 s19, s19, 1
  s_min_u32 s15, s15, s19
  v_readlane_b32 s19, v65, 3
  s_nop 0
  s_cmp_lt_u32 s19, 9
  s_cselect_b32 s19, s19, 64
  s_mul_i32 s19, s19, 7
  s_add_u32 s19, s19, 2
  s_min_u32 s15, s15, s19
  v_readlane_b32 s19, v65, 4
  s_nop 0
  s_cmp_lt_u32 s19, 9
  s_cselect_b32 s19, s19, 64
  s_mul_i32 s19, s19, 7
  s_add_u32 s19, s19, 3
  s_min_u32 s15, s15, s19
  v_readlane_b32 s19, v65, 5
  s_nop 0
  s_cmp_lt_u32 s19, 9
  s_cselect_b32 s19, s19, 64
  s_mul_i32 s19, s19, 7
  s_add_u32 s19, s19, 4
  s_min_u32 s15, s15, s19
  v_readlane_b32 s19, v65, 6
  s_nop 0
  s_cmp_lt_u32 s19, 9
  s_cselect_b32 s19, s19, 64
  s_mul_i32 s19, s19, 7
  s_add_u32 s19, s19, 5
  s_min_u32 s15, s15, s19
  v_readlane_b32 s19, v65, 7
  s_nop 0
  s_cmp_lt_u32 s19, 9
  s_cselect_b32 s19, s19, 64
  s_mul_i32 s19, s19, 7
  s_add_u32 s19, s19, 6
  s_min_u32 s15, s15, s19
  s_add_u32 s24, s24, 1
  s_cmp_gt_u32 s24, 0x40000
  s_cbranch_scc1 L_bail
  s_cmp_lt_u32 s18, s15
  s_cbranch_scc0 L_kvpoll_fast0
L_kvok_fast0:
  s_bitcmp1_b32 s13, 0
  s_cbranch_scc0 L_nd_fast0
  s_nop 15
  s_nop 15
L_nd_fast0:
  buffer_load_dwordx4 v[40:43], v11, s[4:7], s26 offen sc1
  buffer_load_dwordx4 v[44:47], v11, s[4:7], s26 offen offset:1024 sc1
  s_nop 15
  s_nop 15
  s_nop 7
L_pa_fast0:
  buffer_load_dwordx4 v[48:51], v11, s[4:7], s26 offen sc1
  buffer_load_dwordx4 v[52:55], v11, s[4:7], s26 offen offset:1024 sc1
  s_waitcnt vmcnt(3)
  v_mfma_f32_16x16x32_bf16 v[60:63], v[40:43], v[56:59], 0
  s_waitcnt vmcnt(2)
  v_mfma_f32_16x16x32_bf16 v[60:63], v[44:47], v[56:59], v[60:63]
  v_bitop3_b32 v66, v40, v44, s27 bitop3:42
  v_cmp_ne_u32 vcc, 0, v66
  s_nop 5
  v_add_f32 v60, v60, v62
  v_add_f32 v61, v61, v63
  s_nop 1
  v_permlane32_swap_b32 v60, v61
  v_add_f32 v60, v60, v61
  s_nop 1
  v_mov_b32_dpp v61, v60 quad_perm:[1,0,3,2] row_mask:0xf bank_mask:0xf
  v_cvt_pk_bf16_f32 v60, v60, v61
  s_cbranch_vccnz L_ra_fast0
L_da_fast0:
  buffer_store_dword v60, v12, s[4:7], s31 offen
  buffer_store_dword v68, v12, s[4:7], s30 offen
  s_bitcmp1_b32 s13, 0
  s_cbranch_scc1 L_ne_fast1
  s_nop 15
  s_nop 15
L_ne_fast1:
  s_nop 15
  s_nop 15
  s_nop 15
L_ud_fast1:
  buffer_load_dwordx4 v[40:43], v0, s[4:7], s29 offen sc1
  buffer_load_dwordx4 v[44:47], v0, s[4:7], s29 offen offset:1024 sc1
  s_nop 15
  s_nop 15
  buffer_load_dwordx4 v[48:51], v0, s[4:7], s29 offen sc1
  buffer_load_dwordx4 v[52:55], v0, s[4:7], s29 offen offset:1024 sc1
  s_cmp_eq_u32 s14, 63
  s_cbranch_scc1 L_final
.p2align 6
L_go_fast1:
  s_waitcnt vmcnt(3)
  ds_write_b128 v2, v[40:43]
  v_smfmac_f32_16x16x64_bf16 v[76:79], v[40:43], v[104:111], v1
  s_waitcnt vmcnt(2)
  ds_write_b128 v2, v[44:47] offset:1024
  v_max3_u32 v64, v40, v42, v44
  v_max_u32 v64, v64, v46
  v_cmp_eq_u32 vcc, -1, v64
  v_smfmac_f32_16x16x64_bf16 v[80:83], v[40:43], a[64:71], v1
  v_smfmac_f32_16x16x64_bf16 v[76:79], v[44:47], v[120:127], v1
  s_cbranch_vccnz L_mr_fast1
  v_smfmac_f32_16x16x64_bf16 v[72:75], v[40:43], v[96:103], v1
  s_waitcnt lgkmcnt(0)
  s_barrier
  v_smfmac_f32_16x16x64_bf16 v[88:91], v[40:43], a[192:199], v1
  s_waitcnt vmcnt(0)
  ds_read_b128 v[52:55], v3 offset:1024
  ds_read_b128 v[48:51], v3
  v_smfmac_f32_16x16x64_bf16 v[84:87], v[40:43], a[72:79], v1
  ds_read_b128 v[56:59], v4
  v_smfmac_f32_16x16x64_bf16 v[72:75], v[44:47], v[112:119], v1
  ds_read_b128 v[60:63], v4 offset:1024
  v_smfmac_f32_16x16x64_bf16 v[80:83], v[44:47], a[80:87], v1
  ds_read_b128 v[68:71], v5 offset:1024
  s_mov_b64 vcc, s[20:21]
  v_smfmac_f32_16x16x64_bf16 v[84:87], v[44:47], a[88:95], v1
  ds_read_b128 v[96:99], v6 offset:8192
  s_waitcnt lgkmcnt(4)
  v_smfmac_f32_16x16x64_bf16 v[76:79], v[48:51], a[8:15], v1
  ds_read_b128 v[120:123], v6 offset:14336
  ds_read_b128 v[116:119], v6 offset:13312
  v_smfmac_f32_16x16x64_bf16 v[72:75], v[48:51], a[0:7], v1
  ds_read_b128 v[100:103], v6 offset:9216
  v_smfmac_f32_16x16x64_bf16 v[92:95], v[40:43], a[200:207], v1
  ds_read_b128 v[64:67], v5
  s_waitcnt lgkmcnt(7)
  v_smfmac_f32_16x16x64_bf16 v[76:79], v[56:59], a[40:47], v1
  buffer_load_dword v9, v0, s[4:7], s33 offen sc1
  v_smfmac_f32_16x16x64_bf16 v[92:95], v[44:47], a[216:223], v1
  ds_read_b128 v[104:107], v6 offset:10240
  v_smfmac_f32_16x16x64_bf16 v[88:91], v[44:47], a[208:215], v1
  ds_read_b128 v[108:111], v6 offset:11264
  v_mov_b64 v[40:41], 0
  v_smfmac_f32_16x16x64_bf16 v[72:75], v[52:55], a[16:23], v1
  ds_read_b128 v[124:127], v6 offset:15360
  ds_read_b128 v[112:115], v6 offset:12288
  v_smfmac_f32_16x16x64_bf16 v[72:75], v[56:59], a[32:39], v1
  buffer_store_dwordx4 v[14:17], v0, s[4:7], s17 offen sc1
  s_mov_b32 m0, s34
  v_mov_b64 v[44:45], 0
  s_waitcnt lgkmcnt(10)
  v_smfmac_f32_16x16x64_bf16 v[72:75], v[60:63], a[48:55], v1
  s_mov_b32 s17, s38
  v_mov_b64 v[42:43], 0
  v_smfmac_f32_16x16x64_bf16 v[76:79], v[52:55], a[24:31], v1
  s_waitcnt lgkmcnt(4)
  v_smfmac_f32_16x16x64_bf16 v[72:75], v[64:67], v[96:103], v1
  s_waitcnt lgkmcnt(0)
  v_smfmac_f32_16x16x64_bf16 v[72:75], v[68:71], v[112:119], v1
  v_mov_b64 v[46:47], 0
  v_smfmac_f32_16x16x64_bf16 v[76:79], v[64:67], v[104:111], v1
  ds_read_b128 v[112:115], v0 offset:8192
  ds_read_b128 v[116:119], v0 offset:9216
  v_smfmac_f32_16x16x64_bf16 v[76:79], v[60:63], a[56:63], v1
  v_smfmac_f32_16x16x64_bf16 v[76:79], v[68:71], v[120:127], v1
  buffer_load_dwordx4 v[24:27], v0, s[4:7], s37 offen sc1
  v_smfmac_f32_16x16x64_bf16 v[84:87], v[48:51], a[104:111], v1
  s_add_u32 s38, s38, 4096
  v_add_f32 v72, v72, v74
  v_smfmac_f32_16x16x64_bf16 v[80:83], v[48:51], a[96:103], v1
  v_add_f32 v73, v73, v75
  v_smfmac_f32_16x16x64_bf16 v[80:83], v[52:55], a[112:119], v1
  s_nop 0
  v_add_f32 v77, v77, v79
  v_add_f32 v76, v76, v78
  v_cvt_pk_bf16_f32 v72, v72, v73
  v_cvt_pk_bf16_f32 v74, v76, v77
  v_smfmac_f32_16x16x64_bf16 v[80:83], v[60:63], a[144:151], v1
  ds_write2st64_b32 v7, v72, v74 offset0:32 offset1:34
  v_smfmac_f32_16x16x64_bf16 v[84:87], v[52:55], a[120:127], v1
  buffer_load_dwordx4 v0, s[4:7], s16 offen sc1 lds
  v_smfmac_f32_16x16x64_bf16 v[80:83], v[64:67], a[160:167], v1
  v_smfmac_f32_16x16x64_bf16 v[84:87], v[56:59], a[136:143], v1
  ds_read_b128 v[124:127], v0 offset:11264
  ds_read_b128 v[120:123], v0 offset:10240
  v_smfmac_f32_16x16x64_bf16 v[84:87], v[60:63], a[152:159], v1
  s_waitcnt lgkmcnt(2)
  s_barrier
  ds_read_b64_tr_b16 v[102:103], v8 offset:8832
  v_smfmac_f32_16x16x64_bf16 v[84:87], v[68:71], a[184:191], v1
  ds_read_b64_tr_b16 v[98:99], v8 offset:8704
  ds_read_b64_tr_b16 v[108:109], v8 offset:8576
  v_smfmac_f32_16x16x64_bf16 v[80:83], v[68:71], a[176:183], v1
  ds_read_b64_tr_b16 v[96:97], v8 offset:8192
  v_smfmac_f32_16x16x64_bf16 v[88:91], v[48:51], a[224:231], v1
  ds_read_b64_tr_b16 v[110:111], v8 offset:9088
  v_smfmac_f32_16x16x64_bf16 v[80:83], v[56:59], a[128:135], v1
  buffer_load_dwordx4 v[28:31], v0, s[4:7], s37 offen offset:1024 sc1
  v_smfmac_f32_16x16x64_bf16 v[84:87], v[64:67], a[168:175], v1
  ds_read_b64_tr_b16 v[100:101], v8 offset:8320
  ds_read_b64_tr_b16 v[104:105], v8 offset:8448
  ds_read_b64_tr_b16 v[106:107], v8 offset:8960
  v_smfmac_f32_16x16x64_bf16 v[92:95], v[48:51], a[232:239], v1
  s_nop 1
  v_add_f32 v80, v80, v82
  s_waitcnt lgkmcnt(4)
  v_mfma_f32_16x16x32_bf16 v[72:75], v[112:115], v[96:99], 0
  ds_read_b128 v[112:115], v0 offset:12288
  v_add_f32 v81, v81, v83
  v_cvt_pk_bf16_f32 v15, v80, v81
  v_mfma_f32_16x16x32_bf16 v[76:79], v[116:119], v[96:99], 0
  ds_read_b128 v[116:119], v0 offset:13312
  v_add_f32 v84, v84, v86
  v_add_f32 v85, v85, v87
  v_cvt_pk_bf16_f32 v17, v84, v85
  s_waitcnt lgkmcnt(4)
  v_mfma_f32_16x16x32_bf16 v[72:75], v[120:123], v[100:103], v[72:75]
  ds_write2st64_b32 v7, v15, v17 offset0:0 offset1:2
  v_mfma_f32_16x16x32_bf16 v[76:79], v[124:127], v[100:103], v[76:79]
  buffer_load_dwordx4 v0, s[4:7], s16 offen offset:1024 sc1 lds
  v_mov_b64 v[82:83], 0
  v_smfmac_f32_16x16x64_bf16 v[92:95], v[52:55], a[248:255], v1
  ds_read_b128 v[120:123], v0 offset:14336
  ds_read_b128 v[124:127], v0 offset:15360
  v_smfmac_f32_16x16x64_bf16 v[88:91], v[52:55], a[240:247], v1
  s_add_u32 s16, s16, 8192
  s_waitcnt lgkmcnt(3)
  v_mfma_f32_16x16x32_bf16 v[76:79], v[116:119], v[104:107], v[76:79]
  s_waitcnt lgkmcnt(2)
  s_barrier
  ds_read_b64_tr_b16 v[116:117], v8 offset:128
  v_mfma_f32_16x16x32_bf16 v[72:75], v[112:115], v[104:107], v[72:75]
  ds_read_b64_tr_b16 v[114:115], v8 offset:512
  v_mov_b64 v[80:81], 0
  s_waitcnt lgkmcnt(3)
  v_mfma_f32_16x16x32_bf16 v[72:75], v[120:123], v[108:111], v[72:75]
  ds_read_b64_tr_b16 v[112:113], v8 offset:0
  s_waitcnt lgkmcnt(3)
  v_mfma_f32_16x16x32_bf16 v[76:79], v[124:127], v[108:111], v[76:79]
  ds_read_b64_tr_b16 v[118:119], v8 offset:640
  ds_read_b64_tr_b16 v[120:121], v8 offset:256
  v_smfmac_f32_16x16x64_bf16 v[88:91], v[56:59], v[128:135], v1
  ds_read_b64_tr_b16 v[122:123], v8 offset:768
  ds_read_b64_tr_b16 v[124:125], v8 offset:384
  v_smfmac_f32_16x16x64_bf16 v[92:95], v[56:59], v[136:143], v1
  ds_read_b128 v[48:51], v6 offset:16384
  s_waitcnt lgkmcnt(5)
  v_mfma_f32_16x16x32_bf16 v[84:87], v[112:115], v[96:99], 0
  ds_read_b64_tr_b16 v[126:127], v8 offset:896
  v_cndmask_b32_dpp v72, v76, v72, vcc quad_perm:[0,1,0,1] row_mask:0xf bank_mask:0xf
  v_cndmask_b32_dpp v73, v77, v73, vcc quad_perm:[0,1,0,1] row_mask:0xf bank_mask:0xf
  v_exp_f32 v76, v72
  v_smfmac_f32_16x16x64_bf16 v[92:95], v[60:63], v[152:159], v1
  ds_read_b128 v[56:59], v6 offset:20480
  v_cndmask_b32_dpp v74, v78, v74, vcc quad_perm:[0,1,0,1] row_mask:0xf bank_mask:0xf
  v_smfmac_f32_16x16x64_bf16 v[88:91], v[60:63], v[144:151], v1
  ds_read_b128 v[52:55], v6 offset:17408
  s_waitcnt lgkmcnt(7)
  v_mfma_f32_16x16x32_bf16 v[84:87], v[116:119], v[100:103], v[84:87]
  ds_read_b128 v[60:63], v6 offset:21504
  s_waitcnt lgkmcnt(6)
  v_mfma_f32_16x16x32_bf16 v[84:87], v[120:123], v[104:107], v[84:87]
  v_cndmask_b32_dpp v75, v79, v75, vcc quad_perm:[0,1,0,1] row_mask:0xf bank_mask:0xf
  v_exp_f32 v77, v73
  s_waitcnt lgkmcnt(3)
  v_mfma_f32_16x16x32_bf16 v[84:87], v[124:127], v[108:111], v[84:87]
  v_exp_f32 v79, v75
  v_smfmac_f32_16x16x64_bf16 v[88:91], v[68:71], v[176:183], v1
  v_cvt_pk_bf16_f32 v76, v76, v77
  v_exp_f32 v78, v74
  v_smfmac_f32_16x16x64_bf16 v[88:91], v[64:67], v[160:167], v1
  ds_read_b128 v[116:119], v6 offset:19456
  v_cvt_pk_bf16_f32 v77, v78, v79
  v_smfmac_f32_16x16x64_bf16 v[92:95], v[64:67], v[168:175], v1
  ds_read_b128 v[120:123], v6 offset:22528
  v_cndmask_b32_dpp v84, v85, v84, vcc quad_perm:[0,1,0,1] row_mask:0xf bank_mask:0xf
  v_mul_f32 v84, s22, v84
  v_smfmac_f32_16x16x64_bf16 v[92:95], v[68:71], v[184:191], v1
  ds_read_b128 v[124:127], v6 offset:23552
  ds_read_b128 v[100:103], v6 offset:25600
  v_add_f32 v89, v89, v91
  v_add_f32 v88, v88, v90
  v_smfmac_f32_16x16x32_bf16 v[80:83], v[76:77], v[20:23], v1
  v_exp_f32 v85, v84
  v_smfmac_f32_16x16x32_bf16 v[40:43], v[76:77], v[32:35], v1
  s_add_u32 s37, s37, 8192
  ds_read_b128 v[96:99], v6 offset:24576
  v_cvt_pk_bf16_f32 v18, v85, v85
  v_smfmac_f32_16x16x32_bf16 v[44:47], v[76:77], v[36:39], v1
  v_and_b32 v18, v13, v18
  v_cvt_pk_bf16_f32 v14, v88, v89
  v_add_f32 v92, v92, v94
  v_mfma_f32_16x16x16_bf16 v[80:83], v[18:19], v[20:21], v[80:83]
  v_mov_b64 v[90:91], 0
  v_add_f32 v93, v93, v95
  v_mfma_f32_16x16x16_bf16 v[40:43], v[18:19], v[14:15], v[40:43]
  ds_read_b128 v[64:67], v6 offset:26624
  v_cvt_pk_bf16_f32 v16, v92, v93
  v_mov_b64 v[88:89], 0
  s_nop 0
  v_mfma_f32_16x16x16_bf16 v[44:47], v[18:19], v[16:17], v[44:47]
  ds_read_b128 v[68:71], v6 offset:27648
  v_add_f32 v80, v80, v82
  v_rcp_f32 v80, v80
  v_add_f32 v81, v81, v83
  v_rcp_f32 v81, v81
  v_add_f32 v40, v40, v42
  v_add_f32 v41, v41, v43
  v_mul_f32 v41, v41, v81
  v_add_f32 v45, v45, v47
  v_add_f32 v44, v44, v46
  v_mul_f32 v45, v45, v81
  v_mul_f32 v44, v44, v80
  v_mul_f32 v40, v40, v80
  v_cvt_pk_bf16_f32 v83, v44, v45
  v_subrev_u32 v78, s39, v80
  v_cvt_pk_bf16_f32 v82, v40, v41
  v_subrev_u32 v79, s39, v81
  v_max_u32 v78, v78, v79
  ds_write_b64 v7, v[82:83] offset:8192
  v_cmp_lt_u32 vcc, s23, v78
  v_mov_b64 v[92:93], 0
  ds_read_b128 v[112:115], v6 offset:18432
  v_mov_b64 v[94:95], 0
  s_cbranch_vccnz L_sm_fast1
L_smr_fast1:
  v_mov_b64 v[76:77], 0
  v_mov_b64 v[86:87], 0
  v_mov_b64 v[74:75], 0
  v_mov_b64 v[82:83], 0
  v_mov_b64 v[84:85], 0
  s_waitcnt lgkmcnt(1)
  s_barrier
  ds_read_b64_tr_b16 v[32:33], v8 offset:8192
  v_mov_b64 v[78:79], 0
  ds_read_b64_tr_b16 v[34:35], v8 offset:8320
  ds_read_b64_tr_b16 v[36:37], v8 offset:8448
  v_mov_b64 v[44:45], 0
  ds_read_b64_tr_b16 v[38:39], v8 offset:8576
  v_mov_b64 v[42:43], 0
  v_mov_b64 v[72:73], 0
  v_mov_b64 v[80:81], 0
  s_waitcnt lgkmcnt(2)
  v_smfmac_f32_16x16x64_bf16 v[72:75], v[32:35], v[48:55], v1
  ds_read_b128 v[48:51], v6 offset:28672
  ds_read_b128 v[52:55], v6 offset:29696
  v_smfmac_f32_16x16x64_bf16 v[76:79], v[32:35], v[56:63], v1
  s_waitcnt lgkmcnt(2)
  v_smfmac_f32_16x16x64_bf16 v[76:79], v[36:39], v[120:127], v1
  v_smfmac_f32_16x16x64_bf16 v[72:75], v[36:39], v[112:119], v1
  ds_read_b128 v[60:63], v6 offset:31744
  v_mov_b64 v[40:41], 0
  v_smfmac_f32_16x16x64_bf16 v[80:83], v[32:35], v[192:199], v1
  ds_read_b128 v[56:59], v6 offset:30720
  v_smfmac_f32_16x16x64_bf16 v[80:83], v[36:39], v[224:231], v1
  s_nop 1
  v_add_f32 v76, v76, v78
  v_smfmac_f32_16x16x64_bf16 v[84:87], v[36:39], v[232:239], v1
  v_add_u32 v76, s27, v76
  v_and_b32 v76, s36, v76
  v_smfmac_f32_16x16x64_bf16 v[84:87], v[32:35], v[200:207], v1
  v_add_f32 v72, v72, v74
  v_smfmac_f32_16x16x64_bf16 v[88:91], v[32:35], v[96:103], v1
  v_add_f32 v77, v77, v79
  v_add_f32 v80, v80, v82
  v_smfmac_f32_16x16x64_bf16 v[92:95], v[36:39], v[240:247], v1
  v_cvt_pk_bf16_f32 v104, v72, v76
  v_smfmac_f32_16x16x64_bf16 v[92:95], v[32:35], v[208:215], v1
  s_nop 0
  v_add_f32 v84, v84, v86
  v_smfmac_f32_16x16x64_bf16 v[88:91], v[36:39], v[64:71], v1
  v_mov_b64 v[46:47], 0
  v_add_f32 v81, v81, v83
  v_add_f32 v85, v85, v87
  v_add_f32 v73, v73, v75
  v_cvt_pk_bf16_f32 v106, v73, v77
  v_smfmac_f32_16x16x64_bf16 v[40:43], v[32:35], v[216:223], v1
  v_cvt_pk_bf16_f32 v105, v80, v84
  v_cvt_pk_bf16_f32 v107, v81, v85
  s_waitcnt lgkmcnt(2)
  v_smfmac_f32_16x16x64_bf16 v[44:47], v[32:35], v[48:55], v1
  buffer_store_dwordx4 v[104:107], v10, s[4:7], s26 offen offset:0
  v_add_f32 v92, v92, v94
  v_add_f32 v88, v88, v90
  s_waitcnt lgkmcnt(0)
  v_smfmac_f32_16x16x64_bf16 v[44:47], v[36:39], v[56:63], v1
  v_add_f32 v93, v93, v95
  v_smfmac_f32_16x16x64_bf16 v[40:43], v[36:39], v[248:255], v1
  v_add_f32 v89, v89, v91
  v_cvt_pk_bf16_f32 v110, v89, v93
  v_add_u32 v92, s27, v92
  v_and_b32 v92, s36, v92
  v_cvt_pk_bf16_f32 v108, v88, v92
  s_nop 0
  v_add_f32 v44, v44, v46
  v_add_f32 v45, v45, v47
  v_add_f32 v41, v41, v43
  v_add_f32 v40, v40, v42
  v_cvt_pk_bf16_f32 v109, v40, v44
  v_cvt_pk_bf16_f32 v111, v41, v45
  buffer_store_dwordx4 v[108:111], v10, s[4:7], s26 offen offset:2048
  v_mov_b32 v68, -1
  ds_read_b128 v[56:59], v0 offset:28928
  s_add_u32 s14, s14, 1
  ds_read_b128 v[96:99], v6 offset:0
  ds_read_b128 v[100:103], v6 offset:1024
  ds_read_b128 v[104:107], v6 offset:2048
  ds_read_b128 v[108:111], v6 offset:3072
  ds_read_b128 v[112:115], v6 offset:4096
  ds_read_b128 v[116:119], v6 offset:5120
  ds_read_b128 v[120:123], v6 offset:6144
  ds_read_b128 v[124:127], v6 offset:7168
  v_mov_b64 v[72:73], 0
  v_mov_b64 v[74:75], 0
  v_mov_b64 v[76:77], 0
  v_mov_b64 v[78:79], 0
  v_mov_b64 v[80:81], 0
  v_mov_b64 v[82:83], 0
  v_mov_b64 v[84:85], 0
  v_mov_b64 v[86:87], 0
  v_mov_b64 v[88:89], 0
  v_mov_b64 v[90:91], 0
  v_mov_b64 v[92:93], 0
  v_mov_b64 v[94:95], 0
  s_waitcnt lgkmcnt(0)
  s_add_u32 s18, s14, 1
  s_min_u32 s18, s18, 63
  s_cmp_lt_u32 s18, s15
  s_cbranch_scc1 L_kvok_fast1
L_kvpoll_fast1:
  v_and_b32 v64, 0x70, v0
  buffer_load_dword v65, v64, s[4:7], s33 offen sc1
  s_waitcnt vmcnt(0)
  s_mov_b32 s15, 64
  v_readlane_b32 s19, v65, 1
  s_nop 0
  s_cmp_lt_u32 s19, 10
  s_cselect_b32 s19, s19, 64
  s_mul_i32 s19, s19, 7
  s_add_u32 s19, s19, 0
  s_min_u32 s15, s15, s19
  v_readlane_b32 s19, v65, 2
  s_nop 0
  s_cmp_lt_u32 s19, 9
  s_cselect_b32 s19, s19, 64
  s_mul_i32 s19, s19, 7
  s_add_u32 s19, s19, 1
  s_min_u32 s15, s15, s19
  v_readlane_b32 s19, v65, 3
  s_nop 0
  s_cmp_lt_u32 s19, 9
  s_cselect_b32 s19, s19, 64
  s_mul_i32 s19, s19, 7
  s_add_u32 s19, s19, 2
  s_min_u32 s15, s15, s19
  v_readlane_b32 s19, v65, 4
  s_nop 0
  s_cmp_lt_u32 s19, 9
  s_cselect_b32 s19, s19, 64
  s_mul_i32 s19, s19, 7
  s_add_u32 s19, s19, 3
  s_min_u32 s15, s15, s19
  v_readlane_b32 s19, v65, 5
  s_nop 0
  s_cmp_lt_u32 s19, 9
  s_cselect_b32 s19, s19, 64
  s_mul_i32 s19, s19, 7
  s_add_u32 s19, s19, 4
  s_min_u32 s15, s15, s19
  v_readlane_b32 s19, v65, 6
  s_nop 0
  s_cmp_lt_u32 s19, 9
  s_cselect_b32 s19, s19, 64
  s_mul_i32 s19, s19, 7
  s_add_u32 s19, s19, 5
  s_min_u32 s15, s15, s19
  v_readlane_b32 s19, v65, 7
  s_nop 0
  s_cmp_lt_u32 s19, 9
  s_cselect_b32 s19, s19, 64
  s_mul_i32 s19, s19, 7
  s_add_u32 s19, s19, 6
  s_min_u32 s15, s15, s19
  s_add_u32 s24, s24, 1
  s_cmp_gt_u32 s24, 0x40000
  s_cbranch_scc1 L_bail
  s_cmp_lt_u32 s18, s15
  s_cbranch_scc0 L_kvpoll_fast1
L_kvok_fast1:
  s_bitcmp1_b32 s13, 0
  s_cbranch_scc0 L_nd_fast1
  s_nop 15
  s_nop 15
L_nd_fast1:
  buffer_load_dwordx4 v[40:43], v11, s[4:7], s26 offen sc1
  buffer_load_dwordx4 v[44:47], v11, s[4:7], s26 offen offset:1024 sc1
  s_nop 15
  s_nop 15
  s_nop 7
L_pa_fast1:
  buffer_load_dwordx4 v[48:51], v11, s[4:7], s26 offen sc1
  buffer_load_dwordx4 v[52:55], v11, s[4:7], s26 offen offset:1024 sc1
  s_waitcnt vmcnt(3)
  v_mfma_f32_16x16x32_bf16 v[60:63], v[40:43], v[56:59], 0
  s_waitcnt vmcnt(2)
  v_mfma_f32_16x16x32_bf16 v[60:63], v[44:47], v[56:59], v[60:63]
  v_bitop3_b32 v66, v40, v44, s27 bitop3:168
  v_cmp_ne_u32 vcc, 0, v66
  s_nop 5
  v_add_f32 v60, v60, v62
  v_add_f32 v61, v61, v63
  s_nop 1
  v_permlane32_swap_b32 v60, v61
  v_add_f32 v60, v60, v61
  s_nop 1
  v_mov_b32_dpp v61, v60 quad_perm:[1,0,3,2] row_mask:0xf bank_mask:0xf
  v_cvt_pk_bf16_f32 v60, v60, v61
  s_cbranch_vccnz L_ra_fast1
L_da_fast1:
  buffer_store_dword v60, v12, s[4:7], s30 offen
  buffer_store_dword v68, v12, s[4:7], s31 offen
  s_branch L_top_fast
L_final:
L_go_fin:
  s_waitcnt vmcnt(2)
  v_max3_u32 v64, v40, v42, v44
  v_max_u32 v64, v64, v46
  v_cmp_eq_u32 vcc, -1, v64
  s_cbranch_vccnz L_mr_fin
  s_waitcnt vmcnt(0)
  ds_write_b128 v2, v[40:43]
  ds_write_b128 v2, v[44:47] offset:1024
  v_smfmac_f32_16x16x64_bf16 v[80:83], v[40:43], a[64:71], v1
  v_smfmac_f32_16x16x64_bf16 v[84:87], v[40:43], a[72:79], v1
  buffer_store_dwordx4 v[14:17], v0, s[4:7], s17 offen sc1
  s_mov_b32 s17, s38
  s_add_u32 s38, s38, 4096
  v_smfmac_f32_16x16x64_bf16 v[80:83], v[44:47], a[80:87], v1
  v_smfmac_f32_16x16x64_bf16 v[84:87], v[44:47], a[88:95], v1
  v_smfmac_f32_16x16x64_bf16 v[88:91], v[40:43], a[192:199], v1
  v_smfmac_f32_16x16x64_bf16 v[92:95], v[40:43], a[200:207], v1
  s_waitcnt lgkmcnt(0)
  s_barrier
  ds_read_b128 v[48:51], v3
  ds_read_b128 v[52:55], v3 offset:1024
  ds_read_b128 v[56:59], v4
  ds_read_b128 v[60:63], v4 offset:1024
  ds_read_b128 v[64:67], v5
  ds_read_b128 v[68:71], v5 offset:1024
  v_smfmac_f32_16x16x64_bf16 v[88:91], v[44:47], a[208:215], v1
  v_smfmac_f32_16x16x64_bf16 v[92:95], v[44:47], a[216:223], v1
  s_waitcnt lgkmcnt(5)
  v_smfmac_f32_16x16x64_bf16 v[80:83], v[48:51], a[96:103], v1
  v_smfmac_f32_16x16x64_bf16 v[84:87], v[48:51], a[104:111], v1
  s_waitcnt lgkmcnt(4)
  v_smfmac_f32_16x16x64_bf16 v[80:83], v[52:55], a[112:119], v1
  v_smfmac_f32_16x16x64_bf16 v[84:87], v[52:55], a[120:127], v1
  s_waitcnt lgkmcnt(3)
  v_smfmac_f32_16x16x64_bf16 v[80:83], v[56:59], a[128:135], v1
  v_smfmac_f32_16x16x64_bf16 v[84:87], v[56:59], a[136:143], v1
  s_waitcnt lgkmcnt(2)
  v_smfmac_f32_16x16x64_bf16 v[80:83], v[60:63], a[144:151], v1
  v_smfmac_f32_16x16x64_bf16 v[84:87], v[60:63], a[152:159], v1
  s_waitcnt lgkmcnt(1)
  v_smfmac_f32_16x16x64_bf16 v[80:83], v[64:67], a[160:167], v1
  v_smfmac_f32_16x16x64_bf16 v[84:87], v[64:67], a[168:175], v1
  s_waitcnt lgkmcnt(0)
  v_smfmac_f32_16x16x64_bf16 v[80:83], v[68:71], a[176:183], v1
  v_smfmac_f32_16x16x64_bf16 v[84:87], v[68:71], a[184:191], v1
  v_smfmac_f32_16x16x64_bf16 v[88:91], v[48:51], a[224:231], v1
  v_smfmac_f32_16x16x64_bf16 v[92:95], v[48:51], a[232:239], v1
  v_smfmac_f32_16x16x64_bf16 v[88:91], v[52:55], a[240:247], v1
  v_smfmac_f32_16x16x64_bf16 v[92:95], v[52:55], a[248:255], v1
  s_nop 2
  v_add_f32 v80, v80, v82
  v_add_f32 v81, v81, v83
  v_add_f32 v84, v84, v86
  v_add_f32 v85, v85, v87
  v_cvt_pk_bf16_f32 v15, v80, v81
  v_cvt_pk_bf16_f32 v17, v84, v85
  v_smfmac_f32_16x16x64_bf16 v[88:91], v[56:59], v[128:135], v1
  v_smfmac_f32_16x16x64_bf16 v[92:95], v[56:59], v[136:143], v1
  v_smfmac_f32_16x16x64_bf16 v[88:91], v[60:63], v[144:151], v1
  v_smfmac_f32_16x16x64_bf16 v[92:95], v[60:63], v[152:159], v1
  v_smfmac_f32_16x16x64_bf16 v[88:91], v[64:67], v[160:167], v1
  v_smfmac_f32_16x16x64_bf16 v[92:95], v[64:67], v[168:175], v1
  v_smfmac_f32_16x16x64_bf16 v[88:91], v[68:71], v[176:183], v1
  v_smfmac_f32_16x16x64_bf16 v[92:95], v[68:71], v[184:191], v1
  s_nop 6
  v_add_f32 v88, v88, v90
  v_add_f32 v89, v89, v91
  v_cvt_pk_bf16_f32 v14, v88, v89
  v_add_f32 v92, v92, v94
  v_add_f32 v93, v93, v95
  v_cvt_pk_bf16_f32 v16, v92, v93
  buffer_store_dwordx4 v[14:17], v0, s[4:7], s17 offen sc1
  s_endpgm
L_up_fast0:
  s_mov_b32 s18, s15
  s_mov_b32 s15, 64
  v_readlane_b32 s19, v9, 1
  s_nop 0
  s_cmp_lt_u32 s19, 10
  s_cselect_b32 s19, s19, 64
  s_mul_i32 s19, s19, 7
  s_add_u32 s19, s19, 0
  s_min_u32 s15, s15, s19
  v_readlane_b32 s19, v9, 2
  s_nop 0
  s_cmp_lt_u32 s19, 9
  s_cselect_b32 s19, s19, 64
  s_mul_i32 s19, s19, 7
  s_add_u32 s19, s19, 1
  s_min_u32 s15, s15, s19
  v_readlane_b32 s19, v9, 3
  s_nop 0
  s_cmp_lt_u32 s19, 9
  s_cselect_b32 s19, s19, 64
  s_mul_i32 s19, s19, 7
  s_add_u32 s19, s19, 2
  s_min_u32 s15, s15, s19
  v_readlane_b32 s19, v9, 4
  s_nop 0
  s_cmp_lt_u32 s19, 9
  s_cselect_b32 s19, s19, 64
  s_mul_i32 s19, s19, 7
  s_add_u32 s19, s19, 3
  s_min_u32 s15, s15, s19
  v_readlane_b32 s19, v9, 5
  s_nop 0
  s_cmp_lt_u32 s19, 9
  s_cselect_b32 s19, s19, 64
  s_mul_i32 s19, s19, 7
  s_add_u32 s19, s19, 4
  s_min_u32 s15, s15, s19
  v_readlane_b32 s19, v9, 6
  s_nop 0
  s_cmp_lt_u32 s19, 9
  s_cselect_b32 s19, s19, 64
  s_mul_i32 s19, s19, 7
  s_add_u32 s19, s19, 5
  s_min_u32 s15, s15, s19
  v_readlane_b32 s19, v9, 7
  s_nop 0
  s_cmp_lt_u32 s19, 9
  s_cselect_b32 s19, s19, 64
  s_mul_i32 s19, s19, 7
  s_add_u32 s19, s19, 6
  s_min_u32 s15, s15, s19
  s_max_u32 s15, s15, s18
  s_branch L_ud_fast0
L_mr_fast0:
  v_mov_b64 v[72:73], 0
  v_mov_b64 v[74:75], 0
  s_nop 4
  v_mov_b64 v[76:77], 0
  v_mov_b64 v[78:79], 0
  v_mov_b64 v[80:81], 0
  v_mov_b64 v[82:83], 0
  v_mov_b64 v[84:85], 0
  v_mov_b64 v[86:87], 0
  v_mov_b64 v[88:89], 0
  v_mov_b64 v[90:91], 0
  v_mov_b64 v[92:93], 0
  v_mov_b64 v[94:95], 0
  s_waitcnt lgkmcnt(0)
  s_waitcnt vmcnt(0)
  v_max3_u32 v64, v48, v50, v52
  v_max_u32 v64, v64, v54
  v_cmp_eq_u32 vcc, -1, v64
  v_mov_b64 v[40:41], v[48:49]
  v_mov_b64 v[42:43], v[50:51]
  v_mov_b64 v[44:45], v[52:53]
  v_mov_b64 v[46:47], v[54:55]
  s_cbranch_vccz L_go_fast0
L_mq_fast0:
  buffer_load_dwordx4 v[40:43], v0, s[4:7], s28 offen sc1
  buffer_load_dwordx4 v[44:47], v0, s[4:7], s28 offen offset:1024 sc1
  s_add_u32 s24, s24, 1
  s_cmp_gt_u32 s24, 0x100000
  s_cbranch_scc1 L_bail
  s_waitcnt vmcnt(0)
  v_max3_u32 v64, v40, v42, v44
  v_max_u32 v64, v64, v46
  v_cmp_eq_u32 vcc, -1, v64
  s_cbranch_vccnz L_mq_fast0
  s_branch L_go_fast0
L_sm_fast0:
  v_max3_f32 v86, v72, v73, v74
  v_max3_f32 v86, v86, v75, v84
  s_nop 1
  v_max_f32_dpp v86, v86, v86 quad_perm:[2,3,0,1] row_mask:0xf bank_mask:0xf
  v_mov_b32 v87, v86
  s_nop 1
  v_permlane16_swap_b32 v86, v87
  v_max_f32 v86, v86, v87
  v_mov_b32 v87, v86
  s_nop 1
  v_permlane32_swap_b32 v86, v87
  v_max_f32 v86, v86, v87
  v_sub_f32 v76, v72, v86
  v_sub_f32 v77, v73, v86
  v_sub_f32 v78, v74, v86
  v_sub_f32 v79, v75, v86
  v_sub_f32 v85, v84, v86
  v_exp_f32 v76, v76
  v_exp_f32 v77, v77
  v_exp_f32 v78, v78
  v_exp_f32 v79, v79
  v_exp_f32 v85, v85
  s_waitcnt lgkmcnt(0)
  v_mov_b64 v[40:41], 0
  v_mov_b64 v[42:43], 0
  v_mov_b64 v[44:45], 0
  v_mov_b64 v[46:47], 0
  v_mov_b64 v[80:81], 0
  v_mov_b64 v[82:83], 0
  v_cvt_pk_bf16_f32 v76, v76, v77
  v_cvt_pk_bf16_f32 v77, v78, v79
  v_cvt_pk_bf16_f32 v18, v85, v85
  v_and_b32 v18, v13, v18
  v_smfmac_f32_16x16x32_bf16 v[80:83], v[76:77], v[20:23], v1
  v_smfmac_f32_16x16x32_bf16 v[40:43], v[76:77], v[24:27], v1
  v_smfmac_f32_16x16x32_bf16 v[44:47], v[76:77], v[28:31], v1
  s_nop 3
  v_mfma_f32_16x16x16_bf16 v[80:83], v[18:19], v[20:21], v[80:83]
  v_mfma_f32_16x16x16_bf16 v[40:43], v[18:19], v[14:15], v[40:43]
  v_mfma_f32_16x16x16_bf16 v[44:47], v[18:19], v[16:17], v[44:47]
  s_nop 5
  v_add_f32 v80, v80, v82
  v_add_f32 v81, v81, v83
  v_rcp_f32 v80, v80
  v_rcp_f32 v81, v81
  v_add_f32 v40, v40, v42
  v_add_f32 v41, v41, v43
  v_mul_f32 v40, v40, v80
  v_mul_f32 v41, v41, v81
  v_add_f32 v44, v44, v46
  v_add_f32 v45, v45, v47
  v_mul_f32 v44, v44, v80
  v_mul_f32 v45, v45, v81
  v_cvt_pk_bf16_f32 v82, v40, v41
  v_cvt_pk_bf16_f32 v83, v44, v45
  ds_write_b64 v7, v[82:83] offset:8192
  s_waitcnt lgkmcnt(0)
  s_branch L_smr_fast0
L_ra_fast0:
  buffer_load_dwordx4 v[40:43], v11, s[4:7], s26 offen sc1
  buffer_load_dwordx4 v[44:47], v11, s[4:7], s26 offen offset:1024 sc1
  s_waitcnt vmcnt(3)
  v_mfma_f32_16x16x32_bf16 v[60:63], v[48:51], v[56:59], 0
  s_waitcnt vmcnt(2)
  v_mfma_f32_16x16x32_bf16 v[60:63], v[52:55], v[56:59], v[60:63]
  v_bitop3_b32 v66, v48, v52, s27 bitop3:42
  v_cmp_ne_u32 vcc, 0, v66
  s_nop 5
  v_add_f32 v60, v60, v62
  v_add_f32 v61, v61, v63
  s_nop 1
  v_permlane32_swap_b32 v60, v61
  v_add_f32 v60, v60, v61
  s_nop 1
  v_mov_b32_dpp v61, v60 quad_perm:[1,0,3,2] row_mask:0xf bank_mask:0xf
  v_cvt_pk_bf16_f32 v60, v60, v61
  s_cbranch_vccz L_da_fast0
  s_add_u32 s24, s24, 1
  s_cmp_lt_u32 s24, 0x100000
  s_cbranch_scc1 L_pa_fast0
  s_branch L_bail
L_mr_fast1:
  v_mov_b64 v[72:73], 0
  v_mov_b64 v[74:75], 0
  s_nop 4
  v_mov_b64 v[76:77], 0
  v_mov_b64 v[78:79], 0
  v_mov_b64 v[80:81], 0
  v_mov_b64 v[82:83], 0
  v_mov_b64 v[84:85], 0
  v_mov_b64 v[86:87], 0
  v_mov_b64 v[88:89], 0
  v_mov_b64 v[90:91], 0
  v_mov_b64 v[92:93], 0
  v_mov_b64 v[94:95], 0
  s_waitcnt lgkmcnt(0)
  s_waitcnt vmcnt(0)
  v_max3_u32 v64, v48, v50, v52
  v_max_u32 v64, v64, v54
  v_cmp_eq_u32 vcc, -1, v64
  v_mov_b64 v[40:41], v[48:49]
  v_mov_b64 v[42:43], v[50:51]
  v_mov_b64 v[44:45], v[52:53]
  v_mov_b64 v[46:47], v[54:55]
  s_cbranch_vccz L_go_fast1
L_mq_fast1:
  buffer_load_dwordx4 v[40:43], v0, s[4:7], s29 offen sc1
  buffer_load_dwordx4 v[44:47], v0, s[4:7], s29 offen offset:1024 sc1
  s_add_u32 s24, s24, 1
  s_cmp_gt_u32 s24, 0x100000
  s_cbranch_scc1 L_bail
  s_waitcnt vmcnt(0)
  v_max3_u32 v64, v40, v42, v44
  v_max_u32 v64, v64, v46
  v_cmp_eq_u32 vcc, -1, v64
  s_cbranch_vccnz L_mq_fast1
  s_branch L_go_fast1
L_sm_fast1:
  v_max3_f32 v86, v72, v73, v74
  v_max3_f32 v86, v86, v75, v84
  s_nop 1
  v_max_f32_dpp v86, v86, v86 quad_perm:[2,3,0,1] row_mask:0xf bank_mask:0xf
  v_mov_b32 v87, v86
  s_nop 1
  v_permlane16_swap_b32 v86, v87
  v_max_f32 v86, v86, v87
  v_mov_b32 v87, v86
  s_nop 1
  v_permlane32_swap_b32 v86, v87
  v_max_f32 v86, v86, v87
  v_sub_f32 v76, v72, v86
  v_sub_f32 v77, v73, v86
  v_sub_f32 v78, v74, v86
  v_sub_f32 v79, v75, v86
  v_sub_f32 v85, v84, v86
  v_exp_f32 v76, v76
  v_exp_f32 v77, v77
  v_exp_f32 v78, v78
  v_exp_f32 v79, v79
  v_exp_f32 v85, v85
  s_waitcnt lgkmcnt(0)
  v_mov_b64 v[40:41], 0
  v_mov_b64 v[42:43], 0
  v_mov_b64 v[44:45], 0
  v_mov_b64 v[46:47], 0
  v_mov_b64 v[80:81], 0
  v_mov_b64 v[82:83], 0
  v_cvt_pk_bf16_f32 v76, v76, v77
  v_cvt_pk_bf16_f32 v77, v78, v79
  v_cvt_pk_bf16_f32 v18, v85, v85
  v_and_b32 v18, v13, v18
  v_smfmac_f32_16x16x32_bf16 v[80:83], v[76:77], v[20:23], v1
  v_smfmac_f32_16x16x32_bf16 v[40:43], v[76:77], v[32:35], v1
  v_smfmac_f32_16x16x32_bf16 v[44:47], v[76:77], v[36:39], v1
  s_nop 3
  v_mfma_f32_16x16x16_bf16 v[80:83], v[18:19], v[20:21], v[80:83]
  v_mfma_f32_16x16x16_bf16 v[40:43], v[18:19], v[14:15], v[40:43]
  v_mfma_f32_16x16x16_bf16 v[44:47], v[18:19], v[16:17], v[44:47]
  s_nop 5
  v_add_f32 v80, v80, v82
  v_add_f32 v81, v81, v83
  v_rcp_f32 v80, v80
  v_rcp_f32 v81, v81
  v_add_f32 v40, v40, v42
  v_add_f32 v41, v41, v43
  v_mul_f32 v40, v40, v80
  v_mul_f32 v41, v41, v81
  v_add_f32 v44, v44, v46
  v_add_f32 v45, v45, v47
  v_mul_f32 v44, v44, v80
  v_mul_f32 v45, v45, v81
  v_cvt_pk_bf16_f32 v82, v40, v41
  v_cvt_pk_bf16_f32 v83, v44, v45
  ds_write_b64 v7, v[82:83] offset:8192
  s_waitcnt lgkmcnt(0)
  s_branch L_smr_fast1
L_ra_fast1:
  buffer_load_dwordx4 v[40:43], v11, s[4:7], s26 offen sc1
  buffer_load_dwordx4 v[44:47], v11, s[4:7], s26 offen offset:1024 sc1
  s_waitcnt vmcnt(3)
  v_mfma_f32_16x16x32_bf16 v[60:63], v[48:51], v[56:59], 0
  s_waitcnt vmcnt(2)
  v_mfma_f32_16x16x32_bf16 v[60:63], v[52:55], v[56:59], v[60:63]
  v_bitop3_b32 v66, v48, v52, s27 bitop3:168
  v_cmp_ne_u32 vcc, 0, v66
  s_nop 5
  v_add_f32 v60, v60, v62
  v_add_f32 v61, v61, v63
  s_nop 1
  v_permlane32_swap_b32 v60, v61
  v_add_f32 v60, v60, v61
  s_nop 1
  v_mov_b32_dpp v61, v60 quad_perm:[1,0,3,2] row_mask:0xf bank_mask:0xf
  v_cvt_pk_bf16_f32 v60, v60, v61
  s_cbranch_vccz L_da_fast1
  s_add_u32 s24, s24, 1
  s_cmp_lt_u32 s24, 0x100000
  s_cbranch_scc1 L_pa_fast1
  s_branch L_bail
L_mr_fin:
  v_mov_b64 v[72:73], 0
  v_mov_b64 v[74:75], 0
  v_mov_b64 v[76:77], 0
  v_mov_b64 v[78:79], 0
  v_mov_b64 v[80:81], 0
  v_mov_b64 v[82:83], 0
  v_mov_b64 v[84:85], 0
  v_mov_b64 v[86:87], 0
  v_mov_b64 v[88:89], 0
  v_mov_b64 v[90:91], 0
  v_mov_b64 v[92:93], 0
  v_mov_b64 v[94:95], 0
  s_waitcnt lgkmcnt(0)
  s_waitcnt vmcnt(0)
  v_max3_u32 v64, v48, v50, v52
  v_max_u32 v64, v64, v54
  v_cmp_eq_u32 vcc, -1, v64
  v_mov_b64 v[40:41], v[48:49]
  v_mov_b64 v[42:43], v[50:51]
  v_mov_b64 v[44:45], v[52:53]
  v_mov_b64 v[46:47], v[54:55]
  s_cbranch_vccz L_go_fin
L_mq_fin:
  buffer_load_dwordx4 v[40:43], v0, s[4:7], s29 offen sc1
  buffer_load_dwordx4 v[44:47], v0, s[4:7], s29 offen offset:1024 sc1
  s_add_u32 s24, s24, 1
  s_cmp_gt_u32 s24, 0x100000
  s_cbranch_scc1 L_bail
  s_waitcnt vmcnt(0)
  v_max3_u32 v64, v40, v42, v44
  v_max_u32 v64, v64, v46
  v_cmp_eq_u32 vcc, -1, v64
  s_cbranch_vccnz L_mq_fin
  s_branch L_go_fin
L_chain_slow:
  s_add_u32 s18, s14, 1
  s_min_u32 s18, s18, 63
  s_cmp_lt_u32 s18, s15
  s_cbranch_scc1 L_kvok_slow_j
L_kvpoll_slow_j:
  v_and_b32 v64, 0x70, v0
  buffer_load_dword v65, v64, s[4:7], s33 offen sc1
  s_waitcnt vmcnt(0)
  s_mov_b32 s15, 64
  v_readlane_b32 s19, v65, 1
  s_nop 0
  s_cmp_lt_u32 s19, 10
  s_cselect_b32 s19, s19, 64
  s_mul_i32 s19, s19, 7
  s_add_u32 s19, s19, 0
  s_min_u32 s15, s15, s19
  v_readlane_b32 s19, v65, 2
  s_nop 0
  s_cmp_lt_u32 s19, 9
  s_cselect_b32 s19, s19, 64
  s_mul_i32 s19, s19, 7
  s_add_u32 s19, s19, 1
  s_min_u32 s15, s15, s19
  v_readlane_b32 s19, v65, 3
  s_nop 0
  s_cmp_lt_u32 s19, 9
  s_cselect_b32 s19, s19, 64
  s_mul_i32 s19, s19, 7
  s_add_u32 s19, s19, 2
  s_min_u32 s15, s15, s19
  v_readlane_b32 s19, v65, 4
  s_nop 0
  s_cmp_lt_u32 s19, 9
  s_cselect_b32 s19, s19, 64
  s_mul_i32 s19, s19, 7
  s_add_u32 s19, s19, 3
  s_min_u32 s15, s15, s19
  v_readlane_b32 s19, v65, 5
  s_nop 0
  s_cmp_lt_u32 s19, 9
  s_cselect_b32 s19, s19, 64
  s_mul_i32 s19, s19, 7
  s_add_u32 s19, s19, 4
  s_min_u32 s15, s15, s19
  v_readlane_b32 s19, v65, 6
  s_nop 0
  s_cmp_lt_u32 s19, 9
  s_cselect_b32 s19, s19, 64
  s_mul_i32 s19, s19, 7
  s_add_u32 s19, s19, 5
  s_min_u32 s15, s15, s19
  v_readlane_b32 s19, v65, 7
  s_nop 0
  s_cmp_lt_u32 s19, 9
  s_cselect_b32 s19, s19, 64
  s_mul_i32 s19, s19, 7
  s_add_u32 s19, s19, 6
  s_min_u32 s15, s15, s19
  s_add_u32 s24, s24, 1
  s_cmp_gt_u32 s24, 0x40000
  s_cbranch_scc1 L_bail
  s_cmp_lt_u32 s18, s15
  s_cbranch_scc0 L_kvpoll_slow_j
L_kvok_slow_j:
  s_waitcnt vmcnt(0) lgkmcnt(0)
  s_branch L_in_slow
L_top_slow:
  s_bitcmp1_b32 s13, 0
  s_cbranch_scc1 L_ne_slow0
  s_nop 15
  s_nop 15
L_ne_slow0:
  s_cmp_lt_u32 s15, 64
  s_cbranch_scc1 L_up_slow0
  s_nop 15
  s_nop 15
  s_nop 15
L_ud_slow0:
  buffer_load_dwordx4 v[40:43], v0, s[4:7], s28 offen sc1
  buffer_load_dwordx4 v[44:47], v0, s[4:7], s28 offen offset:1024 sc1
  s_nop 15
  s_nop 15
  buffer_load_dwordx4 v[48:51], v0, s[4:7], s28 offen sc1
  buffer_load_dwordx4 v[52:55], v0, s[4:7], s28 offen offset:1024 sc1
L_in_slow:
.p2align 6
L_go_slow0:
  s_waitcnt vmcnt(3)
  ds_write_b128 v2, v[40:43]
  v_smfmac_f32_16x16x64_bf16 v[76:79], v[40:43], v[104:111], v1
  s_waitcnt vmcnt(2)
  ds_write_b128 v2, v[44:47] offset:1024
  v_max3_u32 v64, v40, v42, v44
  v_max_u32 v64, v64, v46
  v_cmp_eq_u32 vcc, -1, v64
  v_smfmac_f32_16x16x64_bf16 v[80:83], v[40:43], a[64:71], v1
  v_smfmac_f32_16x16x64_bf16 v[76:79], v[44:47], v[120:127], v1
  s_cbranch_vccnz L_mr_slow0
  v_smfmac_f32_16x16x64_bf16 v[72:75], v[40:43], v[96:103], v1
  s_waitcnt lgkmcnt(0)
  s_barrier
  v_smfmac_f32_16x16x64_bf16 v[88:91], v[40:43], a[192:199], v1
  s_waitcnt vmcnt(0)
  ds_read_b128 v[52:55], v3 offset:1024
  ds_read_b128 v[48:51], v3
  v_smfmac_f32_16x16x64_bf16 v[84:87], v[40:43], a[72:79], v1
  ds_read_b128 v[56:59], v4
  v_smfmac_f32_16x16x64_bf16 v[72:75], v[44:47], v[112:119], v1
  ds_read_b128 v[60:63], v4 offset:1024
  v_smfmac_f32_16x16x64_bf16 v[80:83], v[44:47], a[80:87], v1
  ds_read_b128 v[68:71], v5 offset:1024
  s_mov_b64 vcc, s[20:21]
  v_smfmac_f32_16x16x64_bf16 v[84:87], v[44:47], a[88:95], v1
  ds_read_b128 v[96:99], v6 offset:8192
  s_waitcnt lgkmcnt(4)
  v_smfmac_f32_16x16x64_bf16 v[76:79], v[48:51], a[8:15], v1
  ds_read_b128 v[120:123], v6 offset:14336
  ds_read_b128 v[116:119], v6 offset:13312
  v_smfmac_f32_16x16x64_bf16 v[72:75], v[48:51], a[0:7], v1
  ds_read_b128 v[100:103], v6 offset:9216
  v_smfmac_f32_16x16x64_bf16 v[92:95], v[40:43], a[200:207], v1
  ds_read_b128 v[64:67], v5
  s_waitcnt lgkmcnt(7)
  v_smfmac_f32_16x16x64_bf16 v[76:79], v[56:59], a[40:47], v1
  v_smfmac_f32_16x16x64_bf16 v[92:95], v[44:47], a[216:223], v1
  ds_read_b128 v[104:107], v6 offset:10240
  v_smfmac_f32_16x16x64_bf16 v[88:91], v[44:47], a[208:215], v1
  ds_read_b128 v[108:111], v6 offset:11264
  v_mov_b64 v[40:41], 0
  v_smfmac_f32_16x16x64_bf16 v[72:75], v[52:55], a[16:23], v1
  ds_read_b128 v[124:127], v6 offset:15360
  ds_read_b128 v[112:115], v6 offset:12288
  v_smfmac_f32_16x16x64_bf16 v[72:75], v[56:59], a[32:39], v1
  buffer_store_dwordx4 v[14:17], v0, s[4:7], s17 offen sc1
  s_mov_b32 m0, s35
  v_mov_b64 v[44:45], 0
  s_waitcnt lgkmcnt(10)
  v_smfmac_f32_16x16x64_bf16 v[72:75], v[60:63], a[48:55], v1
  s_mov_b32 s17, s38
  v_mov_b64 v[42:43], 0
  v_smfmac_f32_16x16x64_bf16 v[76:79], v[52:55], a[24:31], v1
  s_waitcnt lgkmcnt(4)
  v_smfmac_f32_16x16x64_bf16 v[72:75], v[64:67], v[96:103], v1
  s_waitcnt lgkmcnt(0)
  v_smfmac_f32_16x16x64_bf16 v[72:75], v[68:71], v[112:119], v1
  v_mov_b64 v[46:47], 0
  v_smfmac_f32_16x16x64_bf16 v[76:79], v[64:67], v[104:111], v1
  ds_read_b128 v[112:115], v0 offset:0
  ds_read_b128 v[116:119], v0 offset:1024
  v_smfmac_f32_16x16x64_bf16 v[76:79], v[60:63], a[56:63], v1
  v_smfmac_f32_16x16x64_bf16 v[76:79], v[68:71], v[120:127], v1
  buffer_load_dwordx4 v[32:35], v0, s[4:7], s37 offen sc1
  v_smfmac_f32_16x16x64_bf16 v[84:87], v[48:51], a[104:111], v1
  s_add_u32 s38, s38, 4096
  v_add_f32 v72, v72, v74
  v_smfmac_f32_16x16x64_bf16 v[80:83], v[48:51], a[96:103], v1
  v_add_f32 v73, v73, v75
  v_smfmac_f32_16x16x64_bf16 v[80:83], v[52:55], a[112:119], v1
  s_nop 0
  v_add_f32 v77, v77, v79
  v_add_f32 v76, v76, v78
  v_cvt_pk_bf16_f32 v72, v72, v73
  v_cvt_pk_bf16_f32 v74, v76, v77
  v_smfmac_f32_16x16x64_bf16 v[80:83], v[60:63], a[144:151], v1
  ds_write2st64_b32 v7, v72, v74 offset0:32 offset1:34
  v_smfmac_f32_16x16x64_bf16 v[84:87], v[52:55], a[120:127], v1
  buffer_load_dwordx4 v0, s[4:7], s16 offen sc1 lds
  v_smfmac_f32_16x16x64_bf16 v[80:83], v[64:67], a[160:167], v1
  v_smfmac_f32_16x16x64_bf16 v[84:87], v[56:59], a[136:143], v1
  ds_read_b128 v[124:127], v0 offset:3072
  ds_read_b128 v[120:123], v0 offset:2048
  v_smfmac_f32_16x16x64_bf16 v[84:87], v[60:63], a[152:159], v1
  s_waitcnt lgkmcnt(2)
  s_barrier
  ds_read_b64_tr_b16 v[102:103], v8 offset:8832
  v_smfmac_f32_16x16x64_bf16 v[84:87], v[68:71], a[184:191], v1
  ds_read_b64_tr_b16 v[98:99], v8 offset:8704
  ds_read_b64_tr_b16 v[108:109], v8 offset:8576
  v_smfmac_f32_16x16x64_bf16 v[80:83], v[68:71], a[176:183], v1
  ds_read_b64_tr_b16 v[96:97], v8 offset:8192
  v_smfmac_f32_16x16x64_bf16 v[88:91], v[48:51], a[224:231], v1
  ds_read_b64_tr_b16 v[110:111], v8 offset:9088
  v_smfmac_f32_16x16x64_bf16 v[80:83], v[56:59], a[128:135], v1
  buffer_load_dwordx4 v[36:39], v0, s[4:7], s37 offen offset:1024 sc1
  v_smfmac_f32_16x16x64_bf16 v[84:87], v[64:67], a[168:175], v1
  ds_read_b64_tr_b16 v[100:101], v8 offset:8320
  ds_read_b64_tr_b16 v[104:105], v8 offset:8448
  ds_read_b64_tr_b16 v[106:107], v8 offset:8960
  v_smfmac_f32_16x16x64_bf16 v[92:95], v[48:51], a[232:239], v1
  s_nop 1
  v_add_f32 v80, v80, v82
  s_waitcnt lgkmcnt(4)
  v_mfma_f32_16x16x32_bf16 v[72:75], v[112:115], v[96:99], 0
  ds_read_b128 v[112:115], v0 offset:4096
  v_add_f32 v81, v81, v83
  v_cvt_pk_bf16_f32 v15, v80, v81
  v_mfma_f32_16x16x32_bf16 v[76:79], v[116:119], v[96:99], 0
  ds_read_b128 v[116:119], v0 offset:5120
  v_add_f32 v84, v84, v86
  v_add_f32 v85, v85, v87
  v_cvt_pk_bf16_f32 v17, v84, v85
  s_waitcnt lgkmcnt(4)
  v_mfma_f32_16x16x32_bf16 v[72:75], v[120:123], v[100:103], v[72:75]
  ds_write2st64_b32 v7, v15, v17 offset0:0 offset1:2
  v_mfma_f32_16x16x32_bf16 v[76:79], v[124:127], v[100:103], v[76:79]
  buffer_load_dwordx4 v0, s[4:7], s16 offen offset:1024 sc1 lds
  v_mov_b64 v[82:83], 0
  v_smfmac_f32_16x16x64_bf16 v[92:95], v[52:55], a[248:255], v1
  ds_read_b128 v[120:123], v0 offset:6144
  ds_read_b128 v[124:127], v0 offset:7168
  v_smfmac_f32_16x16x64_bf16 v[88:91], v[52:55], a[240:247], v1
  s_add_u32 s16, s16, 8192
  s_waitcnt lgkmcnt(3)
  v_mfma_f32_16x16x32_bf16 v[76:79], v[116:119], v[104:107], v[76:79]
  s_waitcnt lgkmcnt(2)
  s_barrier
  ds_read_b64_tr_b16 v[116:117], v8 offset:128
  v_mfma_f32_16x16x32_bf16 v[72:75], v[112:115], v[104:107], v[72:75]
  ds_read_b64_tr_b16 v[114:115], v8 offset:512
  v_mov_b64 v[80:81], 0
  s_waitcnt lgkmcnt(3)
  v_mfma_f32_16x16x32_bf16 v[72:75], v[120:123], v[108:111], v[72:75]
  ds_read_b64_tr_b16 v[112:113], v8 offset:0
  s_waitcnt lgkmcnt(3)
  v_mfma_f32_16x16x32_bf16 v[76:79], v[124:127], v[108:111], v[76:79]
  ds_read_b64_tr_b16 v[118:119], v8 offset:640
  ds_read_b64_tr_b16 v[120:121], v8 offset:256
  v_smfmac_f32_16x16x64_bf16 v[88:91], v[56:59], v[128:135], v1
  ds_read_b64_tr_b16 v[122:123], v8 offset:768
  ds_read_b64_tr_b16 v[124:125], v8 offset:384
  v_smfmac_f32_16x16x64_bf16 v[92:95], v[56:59], v[136:143], v1
  ds_read_b128 v[48:51], v6 offset:16384
  s_waitcnt lgkmcnt(5)
  v_mfma_f32_16x16x32_bf16 v[84:87], v[112:115], v[96:99], 0
  ds_read_b64_tr_b16 v[126:127], v8 offset:896
  v_cndmask_b32_dpp v72, v76, v72, vcc quad_perm:[0,1,0,1] row_mask:0xf bank_mask:0xf
  v_cndmask_b32_dpp v73, v77, v73, vcc quad_perm:[0,1,0,1] row_mask:0xf bank_mask:0xf
  v_exp_f32 v76, v72
  v_smfmac_f32_16x16x64_bf16 v[92:95], v[60:63], v[152:159], v1
  ds_read_b128 v[56:59], v6 offset:20480
  v_cndmask_b32_dpp v74, v78, v74, vcc quad_perm:[0,1,0,1] row_mask:0xf bank_mask:0xf
  v_smfmac_f32_16x16x64_bf16 v[88:91], v[60:63], v[144:151], v1
  ds_read_b128 v[52:55], v6 offset:17408
  s_waitcnt lgkmcnt(7)
  v_mfma_f32_16x16x32_bf16 v[84:87], v[116:119], v[100:103], v[84:87]
  ds_read_b128 v[60:63], v6 offset:21504
  s_waitcnt lgkmcnt(6)
  v_mfma_f32_16x16x32_bf16 v[84:87], v[120:123], v[104:107], v[84:87]
  v_cndmask_b32_dpp v75, v79, v75, vcc quad_perm:[0,1,0,1] row_mask:0xf bank_mask:0xf
  v_exp_f32 v77, v73
  s_waitcnt lgkmcnt(3)
  v_mfma_f32_16x16x32_bf16 v[84:87], v[124:127], v[108:111], v[84:87]
  v_exp_f32 v79, v75
  v_smfmac_f32_16x16x64_bf16 v[88:91], v[68:71], v[176:183], v1
  v_cvt_pk_bf16_f32 v76, v76, v77
  v_exp_f32 v78, v74
  v_smfmac_f32_16x16x64_bf16 v[88:91], v[64:67], v[160:167], v1
  ds_read_b128 v[116:119], v6 offset:19456
  v_cvt_pk_bf16_f32 v77, v78, v79
  v_smfmac_f32_16x16x64_bf16 v[92:95], v[64:67], v[168:175], v1
  ds_read_b128 v[120:123], v6 offset:22528
  v_cndmask_b32_dpp v84, v85, v84, vcc quad_perm:[0,1,0,1] row_mask:0xf bank_mask:0xf
  v_mul_f32 v84, s22, v84
  v_smfmac_f32_16x16x64_bf16 v[92:95], v[68:71], v[184:191], v1
  ds_read_b128 v[124:127], v6 offset:23552
  ds_read_b128 v[100:103], v6 offset:25600
  v_add_f32 v89, v89, v91
  v_add_f32 v88, v88, v90
  v_smfmac_f32_16x16x32_bf16 v[80:83], v[76:77], v[20:23], v1
  v_exp_f32 v85, v84
  v_smfmac_f32_16x16x32_bf16 v[40:43], v[76:77], v[24:27], v1
  s_add_u32 s37, s37, 8192
  ds_read_b128 v[96:99], v6 offset:24576
  v_cvt_pk_bf16_f32 v18, v85, v85
  v_smfmac_f32_16x16x32_bf16 v[44:47], v[76:77], v[28:31], v1
  v_and_b32 v18, v13, v18
  v_cvt_pk_bf16_f32 v14, v88, v89
  v_add_f32 v92, v92, v94
  v_mfma_f32_16x16x16_bf16 v[80:83], v[18:19], v[20:21], v[80:83]
  v_mov_b64 v[90:91], 0
  v_add_f32 v93, v93, v95
  v_mfma_f32_16x16x16_bf16 v[40:43], v[18:19], v[14:15], v[40:43]
  ds_read_b128 v[64:67], v6 offset:26624
  v_cvt_pk_bf16_f32 v16, v92, v93
  v_mov_b64 v[88:89], 0
  s_nop 0
  v_mfma_f32_16x16x16_bf16 v[44:47], v[18:19], v[16:17], v[44:47]
  ds_read_b128 v[68:71], v6 offset:27648
  v_add_f32 v80, v80, v82
  v_rcp_f32 v80, v80
  v_add_f32 v81, v81, v83
  v_rcp_f32 v81, v81
  v_add_f32 v40, v40, v42
  v_add_f32 v41, v41, v43
  v_mul_f32 v41, v41, v81
  v_add_f32 v45, v45, v47
  v_add_f32 v44, v44, v46
  v_mul_f32 v45, v45, v81
  v_mul_f32 v44, v44, v80
  v_mul_f32 v40, v40, v80
  v_cvt_pk_bf16_f32 v83, v44, v45
  v_subrev_u32 v78, s39, v80
  v_cvt_pk_bf16_f32 v82, v40, v41
  v_subrev_u32 v79, s39, v81
  v_max_u32 v78, v78, v79
  ds_write_b64 v7, v[82:83] offset:8192
  v_cmp_lt_u32 vcc, s23, v78
  v_mov_b64 v[92:93], 0
  ds_read_b128 v[112:115], v6 offset:18432
  v_mov_b64 v[94:95], 0
  s_cbranch_vccnz L_sm_slow0
L_smr_slow0:
  v_mov_b64 v[76:77], 0
  v_mov_b64 v[86:87], 0
  v_mov_b64 v[74:75], 0
  v_mov_b64 v[82:83], 0
  v_mov_b64 v[84:85], 0
  s_waitcnt lgkmcnt(1)
  s_barrier
  ds_read_b64_tr_b16 v[24:25], v8 offset:8192
  v_mov_b64 v[78:79], 0
  ds_read_b64_tr_b16 v[26:27], v8 offset:8320
  ds_read_b64_tr_b16 v[28:29], v8 offset:8448
  v_mov_b64 v[44:45], 0
  ds_read_b64_tr_b16 v[30:31], v8 offset:8576
  v_mov_b64 v[42:43], 0
  v_mov_b64 v[72:73], 0
  v_mov_b64 v[80:81], 0
  s_waitcnt lgkmcnt(2)
  v_smfmac_f32_16x16x64_bf16 v[72:75], v[24:27], v[48:55], v1
  ds_read_b128 v[48:51], v6 offset:28672
  ds_read_b128 v[52:55], v6 offset:29696
  v_smfmac_f32_16x16x64_bf16 v[76:79], v[24:27], v[56:63], v1
  s_waitcnt lgkmcnt(2)
  v_smfmac_f32_16x16x64_bf16 v[76:79], v[28:31], v[120:127], v1
  v_smfmac_f32_16x16x64_bf16 v[72:75], v[28:31], v[112:119], v1
  ds_read_b128 v[60:63], v6 offset:31744
  v_mov_b64 v[40:41], 0
  v_smfmac_f32_16x16x64_bf16 v[80:83], v[24:27], v[192:199], v1
  ds_read_b128 v[56:59], v6 offset:30720
  v_smfmac_f32_16x16x64_bf16 v[80:83], v[28:31], v[224:231], v1
  s_nop 1
  v_add_f32 v76, v76, v78
  v_smfmac_f32_16x16x64_bf16 v[84:87], v[28:31], v[232:239], v1
  v_and_b32 v76, s36, v76
  v_or_b32 v76, s27, v76
  v_smfmac_f32_16x16x64_bf16 v[84:87], v[24:27], v[200:207], v1
  v_add_f32 v72, v72, v74
  v_smfmac_f32_16x16x64_bf16 v[88:91], v[24:27], v[96:103], v1
  v_add_f32 v77, v77, v79
  v_add_f32 v80, v80, v82
  v_smfmac_f32_16x16x64_bf16 v[92:95], v[28:31], v[240:247], v1
  v_cvt_pk_bf16_f32 v104, v72, v76
  v_smfmac_f32_16x16x64_bf16 v[92:95], v[24:27], v[208:215], v1
  s_nop 0
  v_add_f32 v84, v84, v86
  v_smfmac_f32_16x16x64_bf16 v[88:91], v[28:31], v[64:71], v1
  v_mov_b64 v[46:47], 0
  v_add_f32 v81, v81, v83
  v_add_f32 v85, v85, v87
  v_add_f32 v73, v73, v75
  v_cvt_pk_bf16_f32 v106, v73, v77
  v_smfmac_f32_16x16x64_bf16 v[40:43], v[24:27], v[216:223], v1
  v_cvt_pk_bf16_f32 v105, v80, v84
  v_cvt_pk_bf16_f32 v107, v81, v85
  s_waitcnt lgkmcnt(2)
  v_smfmac_f32_16x16x64_bf16 v[44:47], v[24:27], v[48:55], v1
  buffer_store_dwordx4 v[104:107], v10, s[4:7], s26 offen offset:0 sc1
  v_add_f32 v92, v92, v94
  v_add_f32 v88, v88, v90
  s_waitcnt lgkmcnt(0)
  v_smfmac_f32_16x16x64_bf16 v[44:47], v[28:31], v[56:63], v1
  v_add_f32 v93, v93, v95
  v_smfmac_f32_16x16x64_bf16 v[40:43], v[28:31], v[248:255], v1
  v_add_f32 v89, v89, v91
  v_cvt_pk_bf16_f32 v110, v89, v93
  v_and_b32 v92, s36, v92
  v_or_b32 v92, s27, v92
  v_cvt_pk_bf16_f32 v108, v88, v92
  s_nop 0
  v_add_f32 v44, v44, v46
  v_add_f32 v45, v45, v47
  v_add_f32 v41, v41, v43
  v_add_f32 v40, v40, v42
  v_cvt_pk_bf16_f32 v109, v40, v44
  v_cvt_pk_bf16_f32 v111, v41, v45
  buffer_store_dwordx4 v[108:111], v10, s[4:7], s26 offen offset:2048 sc1
  v_mov_b32 v68, -1
  ds_read_b128 v[56:59], v0 offset:28928
  s_add_u32 s14, s14, 1
  ds_read_b128 v[96:99], v6 offset:0
  ds_read_b128 v[100:103], v6 offset:1024
  ds_read_b128 v[104:107], v6 offset:2048
  ds_read_b128 v[108:111], v6 offset:3072
  ds_read_b128 v[112:115], v6 offset:4096
  ds_read_b128 v[116:119], v6 offset:5120
  ds_read_b128 v[120:123], v6 offset:6144
  ds_read_b128 v[124:127], v6 offset:7168
  v_mov_b64 v[72:73], 0
  v_mov_b64 v[74:75], 0
  v_mov_b64 v[76:77], 0
  v_mov_b64 v[78:79], 0
  v_mov_b64 v[80:81], 0
  v_mov_b64 v[82:83], 0
  v_mov_b64 v[84:85], 0
  v_mov_b64 v[86:87], 0
  v_mov_b64 v[88:89], 0
  v_mov_b64 v[90:91], 0
  v_mov_b64 v[92:93], 0
  v_mov_b64 v[94:95], 0
  s_waitcnt lgkmcnt(0)
  s_add_u32 s18, s14, 1
  s_min_u32 s18, s18, 63
  s_cmp_lt_u32 s18, s15
  s_cbranch_scc1 L_kvok_slow0
L_kvpoll_slow0:
  v_and_b32 v64, 0x70, v0
  buffer_load_dword v65, v64, s[4:7], s33 offen sc1
  s_waitcnt vmcnt(0)
  s_mov_b32 s15, 64
  v_readlane_b32 s19, v65, 1
  s_nop 0
  s_cmp_lt_u32 s19, 10
  s_cselect_b32 s19, s19, 64
  s_mul_i32 s19, s19, 7
  s_add_u32 s19, s19, 0
  s_min_u32 s15, s15, s19
  v_readlane_b32 s19, v65, 2
  s_nop 0
  s_cmp_lt_u32 s19, 9
  s_cselect_b32 s19, s19, 64
  s_mul_i32 s19, s19, 7
  s_add_u32 s19, s19, 1
  s_min_u32 s15, s15, s19
  v_readlane_b32 s19, v65, 3
  s_nop 0
  s_cmp_lt_u32 s19, 9
  s_cselect_b32 s19, s19, 64
  s_mul_i32 s19, s19, 7
  s_add_u32 s19, s19, 2
  s_min_u32 s15, s15, s19
  v_readlane_b32 s19, v65, 4
  s_nop 0
  s_cmp_lt_u32 s19, 9
  s_cselect_b32 s19, s19, 64
  s_mul_i32 s19, s19, 7
  s_add_u32 s19, s19, 3
  s_min_u32 s15, s15, s19
  v_readlane_b32 s19, v65, 5
  s_nop 0
  s_cmp_lt_u32 s19, 9
  s_cselect_b32 s19, s19, 64
  s_mul_i32 s19, s19, 7
  s_add_u32 s19, s19, 4
  s_min_u32 s15, s15, s19
  v_readlane_b32 s19, v65, 6
  s_nop 0
  s_cmp_lt_u32 s19, 9
  s_cselect_b32 s19, s19, 64
  s_mul_i32 s19, s19, 7
  s_add_u32 s19, s19, 5
  s_min_u32 s15, s15, s19
  v_readlane_b32 s19, v65, 7
  s_nop 0
  s_cmp_lt_u32 s19, 9
  s_cselect_b32 s19, s19, 64
  s_mul_i32 s19, s19, 7
  s_add_u32 s19, s19, 6
  s_min_u32 s15, s15, s19
  s_add_u32 s24, s24, 1
  s_cmp_gt_u32 s24, 0x40000
  s_cbranch_scc1 L_bail
  s_cmp_lt_u32 s18, s15
  s_cbranch_scc0 L_kvpoll_slow0
L_kvok_slow0:
  s_bitcmp1_b32 s13, 0
  s_cbranch_scc0 L_nd_slow0
  s_nop 15
  s_nop 15
L_nd_slow0:
  buffer_load_dwordx4 v[40:43], v11, s[4:7], s26 offen sc1
  buffer_load_dwordx4 v[44:47], v11, s[4:7], s26 offen offset:1024 sc1
  s_nop 15
  s_nop 15
  s_nop 7
L_pa_slow0:
  buffer_load_dwordx4 v[48:51], v11, s[4:7], s26 offen sc1
  buffer_load_dwordx4 v[52:55], v11, s[4:7], s26 offen offset:1024 sc1
  s_waitcnt vmcnt(3)
  v_mfma_f32_16x16x32_bf16 v[60:63], v[40:43], v[56:59], 0
  s_waitcnt vmcnt(2)
  v_mfma_f32_16x16x32_bf16 v[60:63], v[44:47], v[56:59], v[60:63]
  v_bitop3_b32 v66, v40, v44, s27 bitop3:42
  v_cmp_ne_u32 vcc, 0, v66
  s_nop 5
  v_add_f32 v60, v60, v62
  v_add_f32 v61, v61, v63
  s_nop 1
  v_permlane32_swap_b32 v60, v61
  v_add_f32 v60, v60, v61
  s_nop 1
  v_mov_b32_dpp v61, v60 quad_perm:[1,0,3,2] row_mask:0xf bank_mask:0xf
  v_cvt_pk_bf16_f32 v60, v60, v61
  s_cbranch_vccnz L_ra_slow0
L_da_slow0:
  buffer_store_dword v60, v12, s[4:7], s31 offen sc1
  buffer_store_dword v68, v12, s[4:7], s30 offen sc1
  s_bitcmp1_b32 s13, 0
  s_cbranch_scc1 L_ne_slow1
  s_nop 15
  s_nop 15
L_ne_slow1:
  s_nop 15
  s_nop 15
  s_nop 15
L_ud_slow1:
  buffer_load_dwordx4 v[40:43], v0, s[4:7], s29 offen sc1
  buffer_load_dwordx4 v[44:47], v0, s[4:7], s29 offen offset:1024 sc1
  s_nop 15
  s_nop 15
  buffer_load_dwordx4 v[48:51], v0, s[4:7], s29 offen sc1
  buffer_load_dwordx4 v[52:55], v0, s[4:7], s29 offen offset:1024 sc1
  s_cmp_eq_u32 s14, 63
  s_cbranch_scc1 L_final
.p2align 6
L_go_slow1:
  s_waitcnt vmcnt(3)
  ds_write_b128 v2, v[40:43]
  v_smfmac_f32_16x16x64_bf16 v[76:79], v[40:43], v[104:111], v1
  s_waitcnt vmcnt(2)
  ds_write_b128 v2, v[44:47] offset:1024
  v_max3_u32 v64, v40, v42, v44
  v_max_u32 v64, v64, v46
  v_cmp_eq_u32 vcc, -1, v64
  v_smfmac_f32_16x16x64_bf16 v[80:83], v[40:43], a[64:71], v1
  v_smfmac_f32_16x16x64_bf16 v[76:79], v[44:47], v[120:127], v1
  s_cbranch_vccnz L_mr_slow1
  v_smfmac_f32_16x16x64_bf16 v[72:75], v[40:43], v[96:103], v1
  s_waitcnt lgkmcnt(0)
  s_barrier
  v_smfmac_f32_16x16x64_bf16 v[88:91], v[40:43], a[192:199], v1
  s_waitcnt vmcnt(0)
  ds_read_b128 v[52:55], v3 offset:1024
  ds_read_b128 v[48:51], v3
  v_smfmac_f32_16x16x64_bf16 v[84:87], v[40:43], a[72:79], v1
  ds_read_b128 v[56:59], v4
  v_smfmac_f32_16x16x64_bf16 v[72:75], v[44:47], v[112:119], v1
  ds_read_b128 v[60:63], v4 offset:1024
  v_smfmac_f32_16x16x64_bf16 v[80:83], v[44:47], a[80:87], v1
  ds_read_b128 v[68:71], v5 offset:1024
  s_mov_b64 vcc, s[20:21]
  v_smfmac_f32_16x16x64_bf16 v[84:87], v[44:47], a[88:95], v1
  ds_read_b128 v[96:99], v6 offset:8192
  s_waitcnt lgkmcnt(4)
  v_smfmac_f32_16x16x64_bf16 v[76:79], v[48:51], a[8:15], v1
  ds_read_b128 v[120:123], v6 offset:14336
  ds_read_b128 v[116:119], v6 offset:13312
  v_smfmac_f32_16x16x64_bf16 v[72:75], v[48:51], a[0:7], v1
  ds_read_b128 v[100:103], v6 offset:9216
  v_smfmac_f32_16x16x64_bf16 v[92:95], v[40:43], a[200:207], v1
  ds_read_b128 v[64:67], v5
  s_waitcnt lgkmcnt(7)
  v_smfmac_f32_16x16x64_bf16 v[76:79], v[56:59], a[40:47], v1
  buffer_load_dword v9, v0, s[4:7], s33 offen sc1
  v_smfmac_f32_16x16x64_bf16 v[92:95], v[44:47], a[216:223], v1
  ds_read_b128 v[104:107], v6 offset:10240
  v_smfmac_f32_16x16x64_bf16 v[88:91], v[44:47], a[208:215], v1
  ds_read_b128 v[108:111], v6 offset:11264
  v_mov_b64 v[40:41], 0
  v_smfmac_f32_16x16x64_bf16 v[72:75], v[52:55], a[16:23], v1
  ds_read_b128 v[124:127], v6 offset:15360
  ds_read_b128 v[112:115], v6 offset:12288
  v_smfmac_f32_16x16x64_bf16 v[72:75], v[56:59], a[32:39], v1
  buffer_store_dwordx4 v[14:17], v0, s[4:7], s17 offen sc1
  s_mov_b32 m0, s34
  v_mov_b64 v[44:45], 0
  s_waitcnt lgkmcnt(10)
  v_smfmac_f32_16x16x64_bf16 v[72:75], v[60:63], a[48:55], v1
  s_mov_b32 s17, s38
  v_mov_b64 v[42:43], 0
  v_smfmac_f32_16x16x64_bf16 v[76:79], v[52:55], a[24:31], v1
  s_waitcnt lgkmcnt(4)
  v_smfmac_f32_16x16x64_bf16 v[72:75], v[64:67], v[96:103], v1
  s_waitcnt lgkmcnt(0)
  v_smfmac_f32_16x16x64_bf16 v[72:75], v[68:71], v[112:119], v1
  v_mov_b64 v[46:47], 0
  v_smfmac_f32_16x16x64_bf16 v[76:79], v[64:67], v[104:111], v1
  ds_read_b128 v[112:115], v0 offset:8192
  ds_read_b128 v[116:119], v0 offset:9216
  v_smfmac_f32_16x16x64_bf16 v[76:79], v[60:63], a[56:63], v1
  v_smfmac_f32_16x16x64_bf16 v[76:79], v[68:71], v[120:127], v1
  buffer_load_dwordx4 v[24:27], v0, s[4:7], s37 offen sc1
  v_smfmac_f32_16x16x64_bf16 v[84:87], v[48:51], a[104:111], v1
  s_add_u32 s38, s38, 4096
  v_add_f32 v72, v72, v74
  v_smfmac_f32_16x16x64_bf16 v[80:83], v[48:51], a[96:103], v1
  v_add_f32 v73, v73, v75
  v_smfmac_f32_16x16x64_bf16 v[80:83], v[52:55], a[112:119], v1
  s_nop 0
  v_add_f32 v77, v77, v79
  v_add_f32 v76, v76, v78
  v_cvt_pk_bf16_f32 v72, v72, v73
  v_cvt_pk_bf16_f32 v74, v76, v77
  v_smfmac_f32_16x16x64_bf16 v[80:83], v[60:63], a[144:151], v1
  ds_write2st64_b32 v7, v72, v74 offset0:32 offset1:34
  v_smfmac_f32_16x16x64_bf16 v[84:87], v[52:55], a[120:127], v1
  buffer_load_dwordx4 v0, s[4:7], s16 offen sc1 lds
  v_smfmac_f32_16x16x64_bf16 v[80:83], v[64:67], a[160:167], v1
  v_smfmac_f32_16x16x64_bf16 v[84:87], v[56:59], a[136:143], v1
  ds_read_b128 v[124:127], v0 offset:11264
  ds_read_b128 v[120:123], v0 offset:10240
  v_smfmac_f32_16x16x64_bf16 v[84:87], v[60:63], a[152:159], v1
  s_waitcnt lgkmcnt(2)
  s_barrier
  ds_read_b64_tr_b16 v[102:103], v8 offset:8832
  v_smfmac_f32_16x16x64_bf16 v[84:87], v[68:71], a[184:191], v1
  ds_read_b64_tr_b16 v[98:99], v8 offset:8704
  ds_read_b64_tr_b16 v[108:109], v8 offset:8576
  v_smfmac_f32_16x16x64_bf16 v[80:83], v[68:71], a[176:183], v1
  ds_read_b64_tr_b16 v[96:97], v8 offset:8192
  v_smfmac_f32_16x16x64_bf16 v[88:91], v[48:51], a[224:231], v1
  ds_read_b64_tr_b16 v[110:111], v8 offset:9088
  v_smfmac_f32_16x16x64_bf16 v[80:83], v[56:59], a[128:135], v1
  buffer_load_dwordx4 v[28:31], v0, s[4:7], s37 offen offset:1024 sc1
  v_smfmac_f32_16x16x64_bf16 v[84:87], v[64:67], a[168:175], v1
  ds_read_b64_tr_b16 v[100:101], v8 offset:8320
  ds_read_b64_tr_b16 v[104:105], v8 offset:8448
  ds_read_b64_tr_b16 v[106:107], v8 offset:8960
  v_smfmac_f32_16x16x64_bf16 v[92:95], v[48:51], a[232:239], v1
  s_nop 1
  v_add_f32 v80, v80, v82
  s_waitcnt lgkmcnt(4)
  v_mfma_f32_16x16x32_bf16 v[72:75], v[112:115], v[96:99], 0
  ds_read_b128 v[112:115], v0 offset:12288
  v_add_f32 v81, v81, v83
  v_cvt_pk_bf16_f32 v15, v80, v81
  v_mfma_f32_16x16x32_bf16 v[76:79], v[116:119], v[96:99], 0
  ds_read_b128 v[116:119], v0 offset:13312
  v_add_f32 v84, v84, v86
  v_add_f32 v85, v85, v87
  v_cvt_pk_bf16_f32 v17, v84, v85
  s_waitcnt lgkmcnt(4)
  v_mfma_f32_16x16x32_bf16 v[72:75], v[120:123], v[100:103], v[72:75]
  ds_write2st64_b32 v7, v15, v17 offset0:0 offset1:2
  v_mfma_f32_16x16x32_bf16 v[76:79], v[124:127], v[100:103], v[76:79]
  buffer_load_dwordx4 v0, s[4:7], s16 offen offset:1024 sc1 lds
  v_mov_b64 v[82:83], 0
  v_smfmac_f32_16x16x64_bf16 v[92:95], v[52:55], a[248:255], v1
  ds_read_b128 v[120:123], v0 offset:14336
  ds_read_b128 v[124:127], v0 offset:15360
  v_smfmac_f32_16x16x64_bf16 v[88:91], v[52:55], a[240:247], v1
  s_add_u32 s16, s16, 8192
  s_waitcnt lgkmcnt(3)
  v_mfma_f32_16x16x32_bf16 v[76:79], v[116:119], v[104:107], v[76:79]
  s_waitcnt lgkmcnt(2)
  s_barrier
  ds_read_b64_tr_b16 v[116:117], v8 offset:128
  v_mfma_f32_16x16x32_bf16 v[72:75], v[112:115], v[104:107], v[72:75]
  ds_read_b64_tr_b16 v[114:115], v8 offset:512
  v_mov_b64 v[80:81], 0
  s_waitcnt lgkmcnt(3)
  v_mfma_f32_16x16x32_bf16 v[72:75], v[120:123], v[108:111], v[72:75]
  ds_read_b64_tr_b16 v[112:113], v8 offset:0
  s_waitcnt lgkmcnt(3)
  v_mfma_f32_16x16x32_bf16 v[76:79], v[124:127], v[108:111], v[76:79]
  ds_read_b64_tr_b16 v[118:119], v8 offset:640
  ds_read_b64_tr_b16 v[120:121], v8 offset:256
  v_smfmac_f32_16x16x64_bf16 v[88:91], v[56:59], v[128:135], v1
  ds_read_b64_tr_b16 v[122:123], v8 offset:768
  ds_read_b64_tr_b16 v[124:125], v8 offset:384
  v_smfmac_f32_16x16x64_bf16 v[92:95], v[56:59], v[136:143], v1
  ds_read_b128 v[48:51], v6 offset:16384
  s_waitcnt lgkmcnt(5)
  v_mfma_f32_16x16x32_bf16 v[84:87], v[112:115], v[96:99], 0
  ds_read_b64_tr_b16 v[126:127], v8 offset:896
  v_cndmask_b32_dpp v72, v76, v72, vcc quad_perm:[0,1,0,1] row_mask:0xf bank_mask:0xf
  v_cndmask_b32_dpp v73, v77, v73, vcc quad_perm:[0,1,0,1] row_mask:0xf bank_mask:0xf
  v_exp_f32 v76, v72
  v_smfmac_f32_16x16x64_bf16 v[92:95], v[60:63], v[152:159], v1
  ds_read_b128 v[56:59], v6 offset:20480
  v_cndmask_b32_dpp v74, v78, v74, vcc quad_perm:[0,1,0,1] row_mask:0xf bank_mask:0xf
  v_smfmac_f32_16x16x64_bf16 v[88:91], v[60:63], v[144:151], v1
  ds_read_b128 v[52:55], v6 offset:17408
  s_waitcnt lgkmcnt(7)
  v_mfma_f32_16x16x32_bf16 v[84:87], v[116:119], v[100:103], v[84:87]
  ds_read_b128 v[60:63], v6 offset:21504
  s_waitcnt lgkmcnt(6)
  v_mfma_f32_16x16x32_bf16 v[84:87], v[120:123], v[104:107], v[84:87]
  v_cndmask_b32_dpp v75, v79, v75, vcc quad_perm:[0,1,0,1] row_mask:0xf bank_mask:0xf
  v_exp_f32 v77, v73
  s_waitcnt lgkmcnt(3)
  v_mfma_f32_16x16x32_bf16 v[84:87], v[124:127], v[108:111], v[84:87]
  v_exp_f32 v79, v75
  v_smfmac_f32_16x16x64_bf16 v[88:91], v[68:71], v[176:183], v1
  v_cvt_pk_bf16_f32 v76, v76, v77
  v_exp_f32 v78, v74
  v_smfmac_f32_16x16x64_bf16 v[88:91], v[64:67], v[160:167], v1
  ds_read_b128 v[116:119], v6 offset:19456
  v_cvt_pk_bf16_f32 v77, v78, v79
  v_smfmac_f32_16x16x64_bf16 v[92:95], v[64:67], v[168:175], v1
  ds_read_b128 v[120:123], v6 offset:22528
  v_cndmask_b32_dpp v84, v85, v84, vcc quad_perm:[0,1,0,1] row_mask:0xf bank_mask:0xf
  v_mul_f32 v84, s22, v84
  v_smfmac_f32_16x16x64_bf16 v[92:95], v[68:71], v[184:191], v1
  ds_read_b128 v[124:127], v6 offset:23552
  ds_read_b128 v[100:103], v6 offset:25600
  v_add_f32 v89, v89, v91
  v_add_f32 v88, v88, v90
  v_smfmac_f32_16x16x32_bf16 v[80:83], v[76:77], v[20:23], v1
  v_exp_f32 v85, v84
  v_smfmac_f32_16x16x32_bf16 v[40:43], v[76:77], v[32:35], v1
  s_add_u32 s37, s37, 8192
  ds_read_b128 v[96:99], v6 offset:24576
  v_cvt_pk_bf16_f32 v18, v85, v85
  v_smfmac_f32_16x16x32_bf16 v[44:47], v[76:77], v[36:39], v1
  v_and_b32 v18, v13, v18
  v_cvt_pk_bf16_f32 v14, v88, v89
  v_add_f32 v92, v92, v94
  v_mfma_f32_16x16x16_bf16 v[80:83], v[18:19], v[20:21], v[80:83]
  v_mov_b64 v[90:91], 0
  v_add_f32 v93, v93, v95
  v_mfma_f32_16x16x16_bf16 v[40:43], v[18:19], v[14:15], v[40:43]
  ds_read_b128 v[64:67], v6 offset:26624
  v_cvt_pk_bf16_f32 v16, v92, v93
  v_mov_b64 v[88:89], 0
  s_nop 0
  v_mfma_f32_16x16x16_bf16 v[44:47], v[18:19], v[16:17], v[44:47]
  ds_read_b128 v[68:71], v6 offset:27648
  v_add_f32 v80, v80, v82
  v_rcp_f32 v80, v80
  v_add_f32 v81, v81, v83
  v_rcp_f32 v81, v81
  v_add_f32 v40, v40, v42
  v_add_f32 v41, v41, v43
  v_mul_f32 v41, v41, v81
  v_add_f32 v45, v45, v47
  v_add_f32 v44, v44, v46
  v_mul_f32 v45, v45, v81
  v_mul_f32 v44, v44, v80
  v_mul_f32 v40, v40, v80
  v_cvt_pk_bf16_f32 v83, v44, v45
  v_subrev_u32 v78, s39, v80
  v_cvt_pk_bf16_f32 v82, v40, v41
  v_subrev_u32 v79, s39, v81
  v_max_u32 v78, v78, v79
  ds_write_b64 v7, v[82:83] offset:8192
  v_cmp_lt_u32 vcc, s23, v78
  v_mov_b64 v[92:93], 0
  ds_read_b128 v[112:115], v6 offset:18432
  v_mov_b64 v[94:95], 0
  s_cbranch_vccnz L_sm_slow1
L_smr_slow1:
  v_mov_b64 v[76:77], 0
  v_mov_b64 v[86:87], 0
  v_mov_b64 v[74:75], 0
  v_mov_b64 v[82:83], 0
  v_mov_b64 v[84:85], 0
  s_waitcnt lgkmcnt(1)
  s_barrier
  ds_read_b64_tr_b16 v[32:33], v8 offset:8192
  v_mov_b64 v[78:79], 0
  ds_read_b64_tr_b16 v[34:35], v8 offset:8320
  ds_read_b64_tr_b16 v[36:37], v8 offset:8448
  v_mov_b64 v[44:45], 0
  ds_read_b64_tr_b16 v[38:39], v8 offset:8576
  v_mov_b64 v[42:43], 0
  v_mov_b64 v[72:73], 0
  v_mov_b64 v[80:81], 0
  s_waitcnt lgkmcnt(2)
  v_smfmac_f32_16x16x64_bf16 v[72:75], v[32:35], v[48:55], v1
  ds_read_b128 v[48:51], v6 offset:28672
  ds_read_b128 v[52:55], v6 offset:29696
  v_smfmac_f32_16x16x64_bf16 v[76:79], v[32:35], v[56:63], v1
  s_waitcnt lgkmcnt(2)
  v_smfmac_f32_16x16x64_bf16 v[76:79], v[36:39], v[120:127], v1
  v_smfmac_f32_16x16x64_bf16 v[72:75], v[36:39], v[112:119], v1
  ds_read_b128 v[60:63], v6 offset:31744
  v_mov_b64 v[40:41], 0
  v_smfmac_f32_16x16x64_bf16 v[80:83], v[32:35], v[192:199], v1
  ds_read_b128 v[56:59], v6 offset:30720
  v_smfmac_f32_16x16x64_bf16 v[80:83], v[36:39], v[224:231], v1
  s_nop 1
  v_add_f32 v76, v76, v78
  v_smfmac_f32_16x16x64_bf16 v[84:87], v[36:39], v[232:239], v1
  v_add_u32 v76, s27, v76
  v_and_b32 v76, s36, v76
  v_smfmac_f32_16x16x64_bf16 v[84:87], v[32:35], v[200:207], v1
  v_add_f32 v72, v72, v74
  v_smfmac_f32_16x16x64_bf16 v[88:91], v[32:35], v[96:103], v1
  v_add_f32 v77, v77, v79
  v_add_f32 v80, v80, v82
  v_smfmac_f32_16x16x64_bf16 v[92:95], v[36:39], v[240:247], v1
  v_cvt_pk_bf16_f32 v104, v72, v76
  v_smfmac_f32_16x16x64_bf16 v[92:95], v[32:35], v[208:215], v1
  s_nop 0
  v_add_f32 v84, v84, v86
  v_smfmac_f32_16x16x64_bf16 v[88:91], v[36:39], v[64:71], v1
  v_mov_b64 v[46:47], 0
  v_add_f32 v81, v81, v83
  v_add_f32 v85, v85, v87
  v_add_f32 v73, v73, v75
  v_cvt_pk_bf16_f32 v106, v73, v77
  v_smfmac_f32_16x16x64_bf16 v[40:43], v[32:35], v[216:223], v1
  v_cvt_pk_bf16_f32 v105, v80, v84
  v_cvt_pk_bf16_f32 v107, v81, v85
  s_waitcnt lgkmcnt(2)
  v_smfmac_f32_16x16x64_bf16 v[44:47], v[32:35], v[48:55], v1
  buffer_store_dwordx4 v[104:107], v10, s[4:7], s26 offen offset:0 sc1
  v_add_f32 v92, v92, v94
  v_add_f32 v88, v88, v90
  s_waitcnt lgkmcnt(0)
  v_smfmac_f32_16x16x64_bf16 v[44:47], v[36:39], v[56:63], v1
  v_add_f32 v93, v93, v95
  v_smfmac_f32_16x16x64_bf16 v[40:43], v[36:39], v[248:255], v1
  v_add_f32 v89, v89, v91
  v_cvt_pk_bf16_f32 v110, v89, v93
  v_add_u32 v92, s27, v92
  v_and_b32 v92, s36, v92
  v_cvt_pk_bf16_f32 v108, v88, v92
  s_nop 0
  v_add_f32 v44, v44, v46
  v_add_f32 v45, v45, v47
  v_add_f32 v41, v41, v43
  v_add_f32 v40, v40, v42
  v_cvt_pk_bf16_f32 v109, v40, v44
  v_cvt_pk_bf16_f32 v111, v41, v45
  buffer_store_dwordx4 v[108:111], v10, s[4:7], s26 offen offset:2048 sc1
  v_mov_b32 v68, -1
  ds_read_b128 v[56:59], v0 offset:28928
  s_add_u32 s14, s14, 1
  ds_read_b128 v[96:99], v6 offset:0
  ds_read_b128 v[100:103], v6 offset:1024
  ds_read_b128 v[104:107], v6 offset:2048
  ds_read_b128 v[108:111], v6 offset:3072
  ds_read_b128 v[112:115], v6 offset:4096
  ds_read_b128 v[116:119], v6 offset:5120
  ds_read_b128 v[120:123], v6 offset:6144
  ds_read_b128 v[124:127], v6 offset:7168
  v_mov_b64 v[72:73], 0
  v_mov_b64 v[74:75], 0
  v_mov_b64 v[76:77], 0
  v_mov_b64 v[78:79], 0
  v_mov_b64 v[80:81], 0
  v_mov_b64 v[82:83], 0
  v_mov_b64 v[84:85], 0
  v_mov_b64 v[86:87], 0
  v_mov_b64 v[88:89], 0
  v_mov_b64 v[90:91], 0
  v_mov_b64 v[92:93], 0
  v_mov_b64 v[94:95], 0
  s_waitcnt lgkmcnt(0)
  s_add_u32 s18, s14, 1
  s_min_u32 s18, s18, 63
  s_cmp_lt_u32 s18, s15
  s_cbranch_scc1 L_kvok_slow1
L_kvpoll_slow1:
  v_and_b32 v64, 0x70, v0
  buffer_load_dword v65, v64, s[4:7], s33 offen sc1
  s_waitcnt vmcnt(0)
  s_mov_b32 s15, 64
  v_readlane_b32 s19, v65, 1
  s_nop 0
  s_cmp_lt_u32 s19, 10
  s_cselect_b32 s19, s19, 64
  s_mul_i32 s19, s19, 7
  s_add_u32 s19, s19, 0
  s_min_u32 s15, s15, s19
  v_readlane_b32 s19, v65, 2
  s_nop 0
  s_cmp_lt_u32 s19, 9
  s_cselect_b32 s19, s19, 64
  s_mul_i32 s19, s19, 7
  s_add_u32 s19, s19, 1
  s_min_u32 s15, s15, s19
  v_readlane_b32 s19, v65, 3
  s_nop 0
  s_cmp_lt_u32 s19, 9
  s_cselect_b32 s19, s19, 64
  s_mul_i32 s19, s19, 7
  s_add_u32 s19, s19, 2
  s_min_u32 s15, s15, s19
  v_readlane_b32 s19, v65, 4
  s_nop 0
  s_cmp_lt_u32 s19, 9
  s_cselect_b32 s19, s19, 64
  s_mul_i32 s19, s19, 7
  s_add_u32 s19, s19, 3
  s_min_u32 s15, s15, s19
  v_readlane_b32 s19, v65, 5
  s_nop 0
  s_cmp_lt_u32 s19, 9
  s_cselect_b32 s19, s19, 64
  s_mul_i32 s19, s19, 7
  s_add_u32 s19, s19, 4
  s_min_u32 s15, s15, s19
  v_readlane_b32 s19, v65, 6
  s_nop 0
  s_cmp_lt_u32 s19, 9
  s_cselect_b32 s19, s19, 64
  s_mul_i32 s19, s19, 7
  s_add_u32 s19, s19, 5
  s_min_u32 s15, s15, s19
  v_readlane_b32 s19, v65, 7
  s_nop 0
  s_cmp_lt_u32 s19, 9
  s_cselect_b32 s19, s19, 64
  s_mul_i32 s19, s19, 7
  s_add_u32 s19, s19, 6
  s_min_u32 s15, s15, s19
  s_add_u32 s24, s24, 1
  s_cmp_gt_u32 s24, 0x40000
  s_cbranch_scc1 L_bail
  s_cmp_lt_u32 s18, s15
  s_cbranch_scc0 L_kvpoll_slow1
L_kvok_slow1:
  s_bitcmp1_b32 s13, 0
  s_cbranch_scc0 L_nd_slow1
  s_nop 15
  s_nop 15
L_nd_slow1:
  buffer_load_dwordx4 v[40:43], v11, s[4:7], s26 offen sc1
  buffer_load_dwordx4 v[44:47], v11, s[4:7], s26 offen offset:1024 sc1
  s_nop 15
  s_nop 15
  s_nop 7
L_pa_slow1:
  buffer_load_dwordx4 v[48:51], v11, s[4:7], s26 offen sc1
  buffer_load_dwordx4 v[52:55], v11, s[4:7], s26 offen offset:1024 sc1
  s_waitcnt vmcnt(3)
  v_mfma_f32_16x16x32_bf16 v[60:63], v[40:43], v[56:59], 0
  s_waitcnt vmcnt(2)
  v_mfma_f32_16x16x32_bf16 v[60:63], v[44:47], v[56:59], v[60:63]
  v_bitop3_b32 v66, v40, v44, s27 bitop3:168
  v_cmp_ne_u32 vcc, 0, v66
  s_nop 5
  v_add_f32 v60, v60, v62
  v_add_f32 v61, v61, v63
  s_nop 1
  v_permlane32_swap_b32 v60, v61
  v_add_f32 v60, v60, v61
  s_nop 1
  v_mov_b32_dpp v61, v60 quad_perm:[1,0,3,2] row_mask:0xf bank_mask:0xf
  v_cvt_pk_bf16_f32 v60, v60, v61
  s_cbranch_vccnz L_ra_slow1
L_da_slow1:
  buffer_store_dword v60, v12, s[4:7], s30 offen sc1
  buffer_store_dword v68, v12, s[4:7], s31 offen sc1
  s_branch L_top_slow
L_up_slow0:
  s_mov_b32 s18, s15
  s_mov_b32 s15, 64
  v_readlane_b32 s19, v9, 1
  s_nop 0
  s_cmp_lt_u32 s19, 10
  s_cselect_b32 s19, s19, 64
  s_mul_i32 s19, s19, 7
  s_add_u32 s19, s19, 0
  s_min_u32 s15, s15, s19
  v_readlane_b32 s19, v9, 2
  s_nop 0
  s_cmp_lt_u32 s19, 9
  s_cselect_b32 s19, s19, 64
  s_mul_i32 s19, s19, 7
  s_add_u32 s19, s19, 1
  s_min_u32 s15, s15, s19
  v_readlane_b32 s19, v9, 3
  s_nop 0
  s_cmp_lt_u32 s19, 9
  s_cselect_b32 s19, s19, 64
  s_mul_i32 s19, s19, 7
  s_add_u32 s19, s19, 2
  s_min_u32 s15, s15, s19
  v_readlane_b32 s19, v9, 4
  s_nop 0
  s_cmp_lt_u32 s19, 9
  s_cselect_b32 s19, s19, 64
  s_mul_i32 s19, s19, 7
  s_add_u32 s19, s19, 3
  s_min_u32 s15, s15, s19
  v_readlane_b32 s19, v9, 5
  s_nop 0
  s_cmp_lt_u32 s19, 9
  s_cselect_b32 s19, s19, 64
  s_mul_i32 s19, s19, 7
  s_add_u32 s19, s19, 4
  s_min_u32 s15, s15, s19
  v_readlane_b32 s19, v9, 6
  s_nop 0
  s_cmp_lt_u32 s19, 9
  s_cselect_b32 s19, s19, 64
  s_mul_i32 s19, s19, 7
  s_add_u32 s19, s19, 5
  s_min_u32 s15, s15, s19
  v_readlane_b32 s19, v9, 7
  s_nop 0
  s_cmp_lt_u32 s19, 9
  s_cselect_b32 s19, s19, 64
  s_mul_i32 s19, s19, 7
  s_add_u32 s19, s19, 6
  s_min_u32 s15, s15, s19
  s_max_u32 s15, s15, s18
  s_branch L_ud_slow0
L_mr_slow0:
  v_mov_b64 v[72:73], 0
  v_mov_b64 v[74:75], 0
  s_nop 4
  v_mov_b64 v[76:77], 0
  v_mov_b64 v[78:79], 0
  v_mov_b64 v[80:81], 0
  v_mov_b64 v[82:83], 0
  v_mov_b64 v[84:85], 0
  v_mov_b64 v[86:87], 0
  v_mov_b64 v[88:89], 0
  v_mov_b64 v[90:91], 0
  v_mov_b64 v[92:93], 0
  v_mov_b64 v[94:95], 0
  s_waitcnt lgkmcnt(0)
  s_waitcnt vmcnt(0)
  v_max3_u32 v64, v48, v50, v52
  v_max_u32 v64, v64, v54
  v_cmp_eq_u32 vcc, -1, v64
  v_mov_b64 v[40:41], v[48:49]
  v_mov_b64 v[42:43], v[50:51]
  v_mov_b64 v[44:45], v[52:53]
  v_mov_b64 v[46:47], v[54:55]
  s_cbranch_vccz L_go_slow0
L_mq_slow0:
  buffer_load_dwordx4 v[40:43], v0, s[4:7], s28 offen sc1
  buffer_load_dwordx4 v[44:47], v0, s[4:7], s28 offen offset:1024 sc1
  s_add_u32 s24, s24, 1
  s_cmp_gt_u32 s24, 0x100000
  s_cbranch_scc1 L_bail
  s_waitcnt vmcnt(0)
  v_max3_u32 v64, v40, v42, v44
  v_max_u32 v64, v64, v46
  v_cmp_eq_u32 vcc, -1, v64
  s_cbranch_vccnz L_mq_slow0
  s_branch L_go_slow0
L_sm_slow0:
  v_max3_f32 v86, v72, v73, v74
  v_max3_f32 v86, v86, v75, v84
  s_nop 1
  v_max_f32_dpp v86, v86, v86 quad_perm:[2,3,0,1] row_mask:0xf bank_mask:0xf
  v_mov_b32 v87, v86
  s_nop 1
  v_permlane16_swap_b32 v86, v87
  v_max_f32 v86, v86, v87
  v_mov_b32 v87, v86
  s_nop 1
  v_permlane32_swap_b32 v86, v87
  v_max_f32 v86, v86, v87
  v_sub_f32 v76, v72, v86
  v_sub_f32 v77, v73, v86
  v_sub_f32 v78, v74, v86
  v_sub_f32 v79, v75, v86
  v_sub_f32 v85, v84, v86
  v_exp_f32 v76, v76
  v_exp_f32 v77, v77
  v_exp_f32 v78, v78
  v_exp_f32 v79, v79
  v_exp_f32 v85, v85
  s_waitcnt lgkmcnt(0)
  v_mov_b64 v[40:41], 0
  v_mov_b64 v[42:43], 0
  v_mov_b64 v[44:45], 0
  v_mov_b64 v[46:47], 0
  v_mov_b64 v[80:81], 0
  v_mov_b64 v[82:83], 0
  v_cvt_pk_bf16_f32 v76, v76, v77
  v_cvt_pk_bf16_f32 v77, v78, v79
  v_cvt_pk_bf16_f32 v18, v85, v85
  v_and_b32 v18, v13, v18
  v_smfmac_f32_16x16x32_bf16 v[80:83], v[76:77], v[20:23], v1
  v_smfmac_f32_16x16x32_bf16 v[40:43], v[76:77], v[24:27], v1
  v_smfmac_f32_16x16x32_bf16 v[44:47], v[76:77], v[28:31], v1
  s_nop 3
  v_mfma_f32_16x16x16_bf16 v[80:83], v[18:19], v[20:21], v[80:83]
  v_mfma_f32_16x16x16_bf16 v[40:43], v[18:19], v[14:15], v[40:43]
  v_mfma_f32_16x16x16_bf16 v[44:47], v[18:19], v[16:17], v[44:47]
  s_nop 5
  v_add_f32 v80, v80, v82
  v_add_f32 v81, v81, v83
  v_rcp_f32 v80, v80
  v_rcp_f32 v81, v81
  v_add_f32 v40, v40, v42
  v_add_f32 v41, v41, v43
  v_mul_f32 v40, v40, v80
  v_mul_f32 v41, v41, v81
  v_add_f32 v44, v44, v46
  v_add_f32 v45, v45, v47
  v_mul_f32 v44, v44, v80
  v_mul_f32 v45, v45, v81
  v_cvt_pk_bf16_f32 v82, v40, v41
  v_cvt_pk_bf16_f32 v83, v44, v45
  ds_write_b64 v7, v[82:83] offset:8192
  s_waitcnt lgkmcnt(0)
  s_branch L_smr_slow0
L_ra_slow0:
  buffer_load_dwordx4 v[40:43], v11, s[4:7], s26 offen sc1
  buffer_load_dwordx4 v[44:47], v11, s[4:7], s26 offen offset:1024 sc1
  s_waitcnt vmcnt(3)
  v_mfma_f32_16x16x32_bf16 v[60:63], v[48:51], v[56:59], 0
  s_waitcnt vmcnt(2)
  v_mfma_f32_16x16x32_bf16 v[60:63], v[52:55], v[56:59], v[60:63]
  v_bitop3_b32 v66, v48, v52, s27 bitop3:42
  v_cmp_ne_u32 vcc, 0, v66
  s_nop 5
  v_add_f32 v60, v60, v62
  v_add_f32 v61, v61, v63
  s_nop 1
  v_permlane32_swap_b32 v60, v61
  v_add_f32 v60, v60, v61
  s_nop 1
  v_mov_b32_dpp v61, v60 quad_perm:[1,0,3,2] row_mask:0xf bank_mask:0xf
  v_cvt_pk_bf16_f32 v60, v60, v61
  s_cbranch_vccz L_da_slow0
  s_add_u32 s24, s24, 1
  s_cmp_lt_u32 s24, 0x100000
  s_cbranch_scc1 L_pa_slow0
  s_branch L_bail
L_mr_slow1:
  v_mov_b64 v[72:73], 0
  v_mov_b64 v[74:75], 0
  s_nop 4
  v_mov_b64 v[76:77], 0
  v_mov_b64 v[78:79], 0
  v_mov_b64 v[80:81], 0
  v_mov_b64 v[82:83], 0
  v_mov_b64 v[84:85], 0
  v_mov_b64 v[86:87], 0
  v_mov_b64 v[88:89], 0
  v_mov_b64 v[90:91], 0
  v_mov_b64 v[92:93], 0
  v_mov_b64 v[94:95], 0
  s_waitcnt lgkmcnt(0)
  s_waitcnt vmcnt(0)
  v_max3_u32 v64, v48, v50, v52
  v_max_u32 v64, v64, v54
  v_cmp_eq_u32 vcc, -1, v64
  v_mov_b64 v[40:41], v[48:49]
  v_mov_b64 v[42:43], v[50:51]
  v_mov_b64 v[44:45], v[52:53]
  v_mov_b64 v[46:47], v[54:55]
  s_cbranch_vccz L_go_slow1
L_mq_slow1:
  buffer_load_dwordx4 v[40:43], v0, s[4:7], s29 offen sc1
  buffer_load_dwordx4 v[44:47], v0, s[4:7], s29 offen offset:1024 sc1
  s_add_u32 s24, s24, 1
  s_cmp_gt_u32 s24, 0x100000
  s_cbranch_scc1 L_bail
  s_waitcnt vmcnt(0)
  v_max3_u32 v64, v40, v42, v44
  v_max_u32 v64, v64, v46
  v_cmp_eq_u32 vcc, -1, v64
  s_cbranch_vccnz L_mq_slow1
  s_branch L_go_slow1
L_sm_slow1:
  v_max3_f32 v86, v72, v73, v74
  v_max3_f32 v86, v86, v75, v84
  s_nop 1
  v_max_f32_dpp v86, v86, v86 quad_perm:[2,3,0,1] row_mask:0xf bank_mask:0xf
  v_mov_b32 v87, v86
  s_nop 1
  v_permlane16_swap_b32 v86, v87
  v_max_f32 v86, v86, v87
  v_mov_b32 v87, v86
  s_nop 1
  v_permlane32_swap_b32 v86, v87
  v_max_f32 v86, v86, v87
  v_sub_f32 v76, v72, v86
  v_sub_f32 v77, v73, v86
  v_sub_f32 v78, v74, v86
  v_sub_f32 v79, v75, v86
  v_sub_f32 v85, v84, v86
  v_exp_f32 v76, v76
  v_exp_f32 v77, v77
  v_exp_f32 v78, v78
  v_exp_f32 v79, v79
  v_exp_f32 v85, v85
  s_waitcnt lgkmcnt(0)
  v_mov_b64 v[40:41], 0
  v_mov_b64 v[42:43], 0
  v_mov_b64 v[44:45], 0
  v_mov_b64 v[46:47], 0
  v_mov_b64 v[80:81], 0
  v_mov_b64 v[82:83], 0
  v_cvt_pk_bf16_f32 v76, v76, v77
  v_cvt_pk_bf16_f32 v77, v78, v79
  v_cvt_pk_bf16_f32 v18, v85, v85
  v_and_b32 v18, v13, v18
  v_smfmac_f32_16x16x32_bf16 v[80:83], v[76:77], v[20:23], v1
  v_smfmac_f32_16x16x32_bf16 v[40:43], v[76:77], v[32:35], v1
  v_smfmac_f32_16x16x32_bf16 v[44:47], v[76:77], v[36:39], v1
  s_nop 3
  v_mfma_f32_16x16x16_bf16 v[80:83], v[18:19], v[20:21], v[80:83]
  v_mfma_f32_16x16x16_bf16 v[40:43], v[18:19], v[14:15], v[40:43]
  v_mfma_f32_16x16x16_bf16 v[44:47], v[18:19], v[16:17], v[44:47]
  s_nop 5
  v_add_f32 v80, v80, v82
  v_add_f32 v81, v81, v83
  v_rcp_f32 v80, v80
  v_rcp_f32 v81, v81
  v_add_f32 v40, v40, v42
  v_add_f32 v41, v41, v43
  v_mul_f32 v40, v40, v80
  v_mul_f32 v41, v41, v81
  v_add_f32 v44, v44, v46
  v_add_f32 v45, v45, v47
  v_mul_f32 v44, v44, v80
  v_mul_f32 v45, v45, v81
  v_cvt_pk_bf16_f32 v82, v40, v41
  v_cvt_pk_bf16_f32 v83, v44, v45
  ds_write_b64 v7, v[82:83] offset:8192
  s_waitcnt lgkmcnt(0)
  s_branch L_smr_slow1
L_ra_slow1:
  buffer_load_dwordx4 v[40:43], v11, s[4:7], s26 offen sc1
  buffer_load_dwordx4 v[44:47], v11, s[4:7], s26 offen offset:1024 sc1
  s_waitcnt vmcnt(3)
  v_mfma_f32_16x16x32_bf16 v[60:63], v[48:51], v[56:59], 0
  s_waitcnt vmcnt(2)
  v_mfma_f32_16x16x32_bf16 v[60:63], v[52:55], v[56:59], v[60:63]
  v_bitop3_b32 v66, v48, v52, s27 bitop3:168
  v_cmp_ne_u32 vcc, 0, v66
  s_nop 5
  v_add_f32 v60, v60, v62
  v_add_f32 v61, v61, v63
  s_nop 1
  v_permlane32_swap_b32 v60, v61
  v_add_f32 v60, v60, v61
  s_nop 1
  v_mov_b32_dpp v61, v60 quad_perm:[1,0,3,2] row_mask:0xf bank_mask:0xf
  v_cvt_pk_bf16_f32 v60, v60, v61
  s_cbranch_vccz L_da_slow1
  s_add_u32 s24, s24, 1
  s_cmp_lt_u32 s24, 0x100000
  s_cbranch_scc1 L_pa_slow1
  s_branch L_bail
L_bail:
  s_endpgm

.section .rodata,"a"
.p2align 6
.amdhsa_kernel sequential_preLN__memory_aug_recurrent_mem_tr__glu_gated_swiglu__prompt_kernel
  .amdhsa_next_free_vgpr 512
  .amdhsa_next_free_sgpr 102
  .amdhsa_accum_offset 256
  .amdhsa_group_segment_fixed_size 0
  .amdhsa_kernarg_size 112
  .amdhsa_user_sgpr_count 2
  .amdhsa_user_sgpr_kernarg_segment_ptr 1
  .amdhsa_system_sgpr_workgroup_id_x 1
  .amdhsa_float_denorm_mode_32 3
.end_amdhsa_kernel
```
